```python
import torch

def _softmax(x, axis=-1):
    return torch.softmax(x, dim=axis)
def _gelu(x):
    return torch.nn.functional.gelu(x, approximate="tanh")
def _silu(x):
    return torch.nn.functional.silu(x)
def _sigmoid(x):
    return torch.sigmoid(x)
def _layernorm(x, axis=-1, eps=1e-5):
    m = x.mean(dim=axis, keepdim=True)
    v = x.var(dim=axis, keepdim=True, unbiased=False)
    return (x - m) / torch.sqrt(v + eps)
def _scatter_add(tgt, idx, src, axis=0):
    return tgt.clone().index_add_(axis, idx, src)
def _segment_sum(src, seg, n):
    out = torch.zeros((n,) + src.shape[1:], dtype=src.dtype)
    return out.index_add_(0, seg, src)
def _pad(x, pw):
    flat = tuple(v for pair in reversed(pw) for v in pair)
    return torch.nn.functional.pad(x, flat)

kernel_name = 'gated_mix__linear_kernel_hedgehog__softmax_full_mha__prompt'

def setup_inputs():

    _w = (lambda a: (lambda t: t.to(torch.bfloat16) if t.is_floating_point() else t)(torch.as_tensor(a)))
    def _A_setup():
        B, S, D, H = 1, 2048, 640, 32
        Dh = D // H
        return {
            "x": _w((lambda *s: torch.randn(*s, dtype=torch.bfloat16) * 0.05)(B, S, D)),
            "wqkv": _w((lambda *s: torch.randn(*s, dtype=torch.bfloat16) * 1.6)(D, 3 * D)),
            "w_phi": _w((lambda *s: torch.randn(*s, dtype=torch.bfloat16) * 1.6)(H, Dh, Dh) * (Dh ** -0.5)),
            "wo": _w((lambda *s: torch.randn(*s, dtype=torch.bfloat16) * 0.05)(D, D)),
        }
    _A_in = _A_setup()

    def _B_setup():
        B, S, D = 1, 2048, 640
        return {
            "x": _w((lambda *s: torch.randn(*s, dtype=torch.bfloat16) * 0.05)(B, S, D)),
            "wqkv": _w((lambda *s: torch.randn(*s, dtype=torch.bfloat16) * 0.8)(D, 3 * D)),
            "wo": _w((lambda *s: torch.randn(*s, dtype=torch.bfloat16) * 0.05)(D, D)),
        }
    _B_in = _B_setup()

    return {
        "A_x": _A_in["x"],
        "A_wqkv": _A_in["wqkv"],
        "A_w_phi": _A_in["w_phi"],
        "A_wo": _A_in["wo"],
        "B_x": _B_in["x"],
        "B_wqkv": _B_in["wqkv"],
        "B_wo": _B_in["wo"],
        "gate_w": _w((lambda *s: torch.randn(*s, dtype=torch.bfloat16) * 0.05)(640) * 16.0),
    }

def reference(A_x, A_wqkv, A_w_phi, A_wo, B_x, B_wqkv, B_wo, gate_w):
    def _A_ref(x, wqkv, w_phi, wo):
        B, S, D = x.shape
        H = 32; Dh = D // H
        qkv = (lambda x, *d: x.permute(*d))((x @ wqkv).reshape(B, S, 3, H, Dh), 2, 0, 3, 1, 4)
        q, k, v = qkv[0], qkv[1], qkv[2]
        pq = torch.einsum("bhsd,hdf->bhsf", q, w_phi)
        pk = torch.einsum("bhsd,hdf->bhsf", k, w_phi)
        phi_q = torch.concatenate([_softmax(pq, axis=-1), _softmax(-pq, axis=-1)], axis=-1)
        phi_k = torch.concatenate([_softmax(pk, axis=-1), _softmax(-pk, axis=-1)], axis=-1)
        kv = torch.einsum("bhsf,bhsd->bhfd", phi_k, v)
        z  = torch.einsum("bhsf->bhf", phi_k)
        num = torch.einsum("bhqf,bhfd->bhqd", phi_q, kv)
        den = torch.einsum("bhqf,bhf->bhq", phi_q, z)[..., None] + 1e-6
        o = num / den
        return (lambda x, *d: x.permute(*d))(o, 0, 2, 1, 3).reshape(B, S, D) @ wo

    def _B_ref(x, wqkv, wo):
        B, S, D = x.shape
        H = 32; Dh = D // H
        qkv = (lambda x, *d: x.permute(*d))((x @ wqkv).reshape(B, S, 3, H, Dh), 2, 0, 3, 1, 4)
        q, k, v = qkv[0], qkv[1], qkv[2]
        scale = Dh ** -0.5
        scores = torch.einsum("bhqd,bhkd->bhqk", q, k) * scale
        p = _softmax(scores, axis=-1)
        o = torch.einsum("bhqk,bhkd->bhqd", p, v)
        return (lambda x, *d: x.permute(*d))(o, 0, 2, 1, 3).reshape(B, S, D) @ wo

    x = A_x
    g = _sigmoid((x * gate_w).sum(-1, keepdims=True))
    a = _A_ref(x, A_wqkv, A_w_phi, A_wo)
    b = _B_ref(x, B_wqkv, B_wo)
    return g * a + (1 - g) * b
```

```asm
; @launch grid=(256,1,1) block=(512,1,1) lds=163840
.amdgcn_target "amdgcn-amd-amdhsa--gfx950"
.text
.globl gated_mix__linear_kernel_hedgehog__softmax_full_mha__prompt_kernel
.p2align 8
.type gated_mix__linear_kernel_hedgehog__softmax_full_mha__prompt_kernel,@function
gated_mix__linear_kernel_hedgehog__softmax_full_mha__prompt_kernel:
    s_cmp_ge_u32 s2, 256
    s_cbranch_scc1 L_end
    s_load_dwordx2 s[4:5], s[0:1], 0
    s_load_dwordx2 s[8:9], s[0:1], 40
    s_load_dwordx2 s[12:13], s[0:1], 8
    s_load_dwordx2 s[16:17], s[0:1], 16
    s_load_dwordx2 s[20:21], s[0:1], 56
    s_load_dwordx2 s[28:29], s[0:1], 72
    s_load_dwordx2 s[24:25], s[0:1], 80
    s_load_dwordx2 s[68:69], s[0:1], 24
    s_load_dwordx2 s[72:73], s[0:1], 48
    s_load_dwordx2 s[76:77], s[0:1], 64
    v_and_b32 v1, 63, v0
    v_lshrrev_b32 v64, 6, v0
    s_nop 0
    v_readfirstlane_b32 s34, v64
    s_and_b32 s42, s2, 7
    s_lshr_b32 s43, s2, 3
    s_and_b32 s35, s42, 1
    s_lshl_b32 s35, s35, 3
    s_lshr_b32 s44, s43, 2
    s_add_u32 s35, s35, s44
    s_lshr_b32 s36, s42, 1
    s_lshr_b32 s44, s42, 3
    s_xor_b32 s36, s36, s44
    s_lshl_b32 s36, s36, 2
    s_and_b32 s44, s43, 3
    s_add_u32 s36, s36, s44
    v_lshrrev_b32 v64, 3, v1
    v_mul_u32_u24 v64, 1280, v64
    v_and_b32 v65, 7, v1
    v_lshrrev_b32 v66, 4, v1
    v_xor_b32 v65, v65, v66
    v_lshl_add_u32 v2, v65, 4, v64
    v_xor_b32 v3, 64, v2
    v_add_u32 v3, 10240, v3
    v_and_b32 v65, 15, v1
    v_lshlrev_b32 v67, 2, v66
    v_xor_b32 v65, v65, v67
    v_mul_u32_u24 v66, 3840, v66
    v_lshl_add_u32 v0, v65, 4, v66
    s_lshl_b32 s38, s35, 3
    s_add_u32 s38, s38, s34
    s_mul_i32 s38, s38, 20480
    s_mul_i32 s39, s34, 30720
    s_lshl_b32 s45, s36, 8
    s_add_u32 s39, s39, s45
    s_lshl_b32 s46, s34, 11
    s_waitcnt lgkmcnt(0)
    s_mov_b32 s6, 2621440
    s_mov_b32 s7, 0x20000
    s_mov_b32 s10, 2457600
    s_mov_b32 s11, 0x20000
    s_add_u32 s60, s36, s35
    s_and_b32 s60, s60, 3
    s_lshl_b32 s60, s60, 2
    s_lshr_b32 s60, 0x8530, s60
    s_and_b32 s60, s60, 15
    s_lshl_b32 s60, s60, 7
    s_cmp_eq_u32 s36, 15
    s_cbranch_scc1 L_nod0
    s_add_u32 m0, s46, 0
    s_add_u32 s91, s38, s60
    buffer_load_dwordx4 v2, s[4:7], s91 offen lds
    s_add_u32 m0, s46, 1024
    s_nop 0
    buffer_load_dwordx4 v3, s[4:7], s91 offen lds
    s_mul_i32 s92, s60, 1920
    s_add_u32 m0, s46, 16384
    s_add_u32 s92, s92, s39
    buffer_load_dwordx4 v0, s[8:11], s92 offen lds
    s_add_u32 m0, s46, 17408
    s_add_u32 s92, s92, 15360
    buffer_load_dwordx4 v0, s[8:11], s92 offen lds
    s_add_u32 s60, s60, 128
    s_cmp_eq_u32 s60, 1280
    s_cselect_b32 s60, 0, s60
L_nod0:
    v_and_b32 v64, 3, v1
    v_mul_u32_u24 v64, 1248, v64
    v_lshl_add_u32 v16, v1, 5, v64
    v_lshrrev_b32 v66, 1, v1
    v_mul_u32_u24 v66, 245504, v66
    v_lshl_add_u32 v47, v1, 7, v66
    s_lshl_b32 s91, s35, 2
    s_add_u32 s91, s91, s44
    s_lshl_b32 s91, s91, 3
    s_add_u32 s91, s91, s34
    s_mul_i32 s91, s91, 5120
    s_and_b32 s37, s35, 7
    s_lshl_b32 s37, s37, 3
    s_add_u32 s37, s37, s34
    s_mul_i32 s37, s37, 3840
    s_add_u32 s37, s37, s45
    s_cmp_eq_u32 s36, 15
    s_cbranch_scc1 L_nodma
    s_add_u32 m0, s46, 32768
    s_add_u32 s91, s38, s60
    buffer_load_dwordx4 v2, s[4:7], s91 offen lds
    s_add_u32 m0, s46, 33792
    s_nop 0
    buffer_load_dwordx4 v3, s[4:7], s91 offen lds
    s_mul_i32 s92, s60, 1920
    s_add_u32 m0, s46, 49152
    s_add_u32 s92, s92, s39
    buffer_load_dwordx4 v0, s[8:11], s92 offen lds
    s_add_u32 m0, s46, 50176
    s_add_u32 s92, s92, 15360
    buffer_load_dwordx4 v0, s[8:11], s92 offen lds
    s_add_u32 s60, s60, 128
    s_cmp_eq_u32 s60, 1280
    s_cselect_b32 s60, 0, s60
L_nodma:
    s_mov_b32 s14, 2457600
    s_mov_b32 s15, 0x20000
    s_mov_b32 s18, 25600
    s_mov_b32 s19, 0x20000
    s_mov_b32 s22, 1280
    s_mov_b32 s23, 0x20000
    s_mov_b32 s26, 268435456
    s_mov_b32 s27, 0x20000
    s_mov_b32 s30, 256
    s_mov_b32 s31, 0x20000
    s_mov_b32 s70, 819200
    s_mov_b32 s71, 0x20000
    s_mov_b32 s74, 819200
    s_mov_b32 s75, 0x20000
    s_mov_b32 s78, 2621440
    s_mov_b32 s79, 0x20000
    s_cmp_lg_u32 s34, 1
    s_cbranch_scc1 L_nocode
    s_getpc_b64 s[84:85]
    L_pc:
    s_sub_u32 s84, s84, L_pc-gated_mix__linear_kernel_hedgehog__softmax_full_mha__prompt_kernel
    s_subb_u32 s85, s85, 0
    s_mov_b32 s86, L_code_end-gated_mix__linear_kernel_hedgehog__softmax_full_mha__prompt_kernel
    s_mov_b32 s87, 0x20000
    v_lshlrev_b32 v64, 7, v1
    s_lshl_b32 s44, s43, 11
    s_mov_b64 exec, 0xffff
    buffer_load_dword v46, v64, s[84:87], s44 offen
    s_mov_b64 exec, -1
L_nocode:
    s_or_b32 s44, s2, s34
    s_cmp_lg_u32 s44, 0
    s_cbranch_scc1 L_nolead
    s_memrealtime s[66:67]
    s_waitcnt lgkmcnt(0)
    s_or_b32 s66, s66, 1
    s_or_b32 s67, s67, 0x80000000
    v_mov_b32 v64, s66
    v_mov_b32 v65, s67
    v_mov_b32 v66, 0
    s_mov_b64 exec, 1
    buffer_store_dwordx2 v[64:65], v66, s[28:31], 0 offen sc1
    s_mov_b64 exec, -1
L_nolead:
    s_lshl_b32 s32, s42, 2
    s_and_b32 s44, s43, 3
    s_add_u32 s32, s32, s44
    s_lshr_b32 s33, s43, 3
    s_and_b32 s44, s43, 4
    s_add_u32 s33, s33, s44
    s_and_b32 s41, s43, 15
    s_lshl_b32 s42, s42, 1
    s_lshr_b32 s43, s43, 4
    s_add_u32 s42, s42, s43
    s_lshl_b32 s42, s42, 3
    s_add_u32 s42, s42, s34
    s_mul_i32 s43, s41, 80
    s_mul_i32 s40, s42, 20480
    s_add_u32 s40, s40, s43
    s_mul_i32 s97, s34, 51200
    s_add_u32 s97, s97, s43
    s_lshr_b32 s3, s42, 1
    s_lshl_b32 s3, s3, 9
    s_add_u32 s3, s3, 15794176
    s_mul_i32 s42, s42, 40960
    s_add_u32 s42, s42, 20971520
    s_add_u32 s43, s41, 0
    s_and_b32 s43, s43, 3
    s_mul_i32 s80, s43, 5120
    s_add_u32 s80, s80, s42
    s_add_u32 s43, s41, 1
    s_and_b32 s43, s43, 3
    s_mul_i32 s81, s43, 5120
    s_add_u32 s81, s81, s42
    s_add_u32 s43, s41, 2
    s_and_b32 s43, s43, 3
    s_mul_i32 s82, s43, 5120
    s_add_u32 s82, s82, s42
    s_add_u32 s43, s41, 3
    s_and_b32 s43, s43, 3
    s_mul_i32 s83, s43, 5120
    s_add_u32 s83, s83, s42
    s_mul_i32 s96, s34, 1280
    s_lshl_b32 s95, s96, 2
    s_add_u32 s96, s96, 61440
    s_add_u32 s95, s95, 81920
    s_mul_i32 s44, s32, 163840
    s_add_u32 s57, s44, 5242880
    s_lshl_b32 s42, s33, 3
    s_add_u32 s42, s42, s34
    s_xor_b32 s43, s42, 1
    s_mul_i32 s84, s42, 2560
    s_mul_i32 s85, s43, 2560
    s_add_u32 s84, s84, s44
    s_add_u32 s85, s85, s44
    s_lshl_b32 s87, s42, 8
    s_add_u32 s87, s87, 15760384
    s_mul_i32 s98, s42, 81920
    s_mul_i32 s43, s32, 640
    s_add_u32 s98, s98, s43
    s_add_u32 s98, s98, 20971520
    s_lshl_b32 s99, s42, 9
    s_lshl_b32 s43, s32, 3
    s_add_u32 s99, s99, s43
    s_add_u32 s99, s99, 15794176
    s_lshl_b32 s86, s33, 1
    s_lshl_b32 s86, 0x30003, s86
    s_mul_i32 s63, s32, 40960
    s_add_u32 s63, s63, 15859712
    s_mul_i32 s93, s33, 5120
    s_add_u32 s93, s93, s63
    s_lshl_b32 s62, s32, 9
    s_lshl_b32 s43, s34, 6
    s_add_u32 s62, s62, s43
    s_add_u32 s62, s62, 15732736
    s_lshl_b32 s94, s33, 3
    s_add_u32 s94, s94, s62
    s_mul_i32 s55, s32, 800
    s_lshl_b32 s56, s36, 4
    s_add_u32 s56, s56, s35
    s_lshl_b32 s56, s56, 3
    s_add_u32 s56, s56, 15728640
    s_mov_b32 s61, 15728640
    s_mov_b32 s59, 0
    s_mov_b32 s54, 0
    s_mov_b32 s52, 0x3fb8aa3b
    s_add_u32 s42, s34, 0
    s_mul_i32 s43, s42, 52
    s_lshr_b32 s43, s43, 8
    s_lshl_b32 s43, s43, 9
    s_lshl_b32 s42, s42, 10
    s_add_u32 s88, s42, s43
    s_add_u32 s42, s34, 8
    s_mul_i32 s43, s42, 52
    s_lshr_b32 s43, s43, 8
    s_lshl_b32 s43, s43, 9
    s_lshl_b32 s42, s42, 10
    s_add_u32 s89, s42, s43
    s_cmp_lt_u32 s34, 4
    s_cselect_b32 s42, 16, 8
    s_add_u32 s42, s42, s34
    s_mul_i32 s43, s42, 52
    s_lshr_b32 s43, s43, 8
    s_lshl_b32 s43, s43, 9
    s_lshl_b32 s42, s42, 10
    s_add_u32 s90, s42, s43
    v_lshrrev_b32 v18, 5, v1
    v_and_b32 v19, 31, v1
    v_lshlrev_b32 v20, 4, v1
    v_and_b32 v21, 3, v1
    v_lshlrev_b32 v21, 3, v21
    v_bfe_u32 v22, v1, 2, 2
    v_and_b32 v64, 16, v1
    v_cmp_ne_u32 s[48:49], 0, v64
    v_cmp_ne_u32 s[50:51], 0, v18
    s_mul_i32 s42, s32, 20
    s_add_u32 s43, s42, 19
    s_lshr_b32 s42, s42, 7
    s_lshr_b32 s43, s43, 7
    v_mov_b32 v64, s42
    v_mov_b32 v65, s43
    v_cndmask_b32 v64, v64, v65, s[48:49]
    v_and_b32 v65, 15, v1
    v_lshlrev_b32 v65, 3, v65
    v_mad_u32_u24 v66, v18, 5, v64
    v_add_u32 v66, 5, v66
    v_lshl_add_u32 v30, v66, 7, v65
    v_cndmask_b32 v64, v64, 15, s[50:51]
    v_lshl_add_u32 v31, v64, 7, v65
    v_mov_b32 v32, 0
    v_mov_b32 v33, 0
    v_mov_b32 v34, 0
    v_mov_b32 v35, 0
    v_mov_b32 v36, 0
    v_mov_b32 v37, 0
    v_mov_b32 v38, 0
    v_mov_b32 v39, 0
    s_cmp_eq_u32 s36, 15
    s_cbranch_scc1 L_gate
    v_lshl_add_u32 v64, v18, 3, v22
    v_lshlrev_b32 v64, 8, v64
    v_bfe_u32 v65, v1, 4, 1
    v_lshl_add_u32 v65, v65, 5, v21
    s_lshr_b32 s42, s34, 2
    s_lshl_b32 s42, s42, 1
    v_xor_b32 v66, s42, v22
    v_lshlrev_b32 v66, 6, v66
    v_add3_u32 v40, v64, v65, v66
    v_xor_b32 v41, 64, v40
    v_add_u32 v42, 0x10000, v40
    v_add_u32 v43, 0x10000, v41
    v_add_u32 v44, 0x20000, v40
    v_add_u32 v45, 0x20000, v41
    s_and_b32 s42, s34, 3
    s_lshl_b32 s42, s42, 12
    v_lshl_add_u32 v64, v19, 7, s42
    v_bfe_u32 v65, v19, 1, 3
    v_xor_b32 v65, v65, v18
    v_xor_b32 v66, 0, v65
    v_lshl_add_u32 v4, v66, 4, v64
    v_add_u32 v8, 0x10000, v4
    v_add_u32 v12, 0x20000, v4
    v_xor_b32 v66, 2, v65
    v_lshl_add_u32 v5, v66, 4, v64
    v_add_u32 v9, 0x10000, v5
    v_add_u32 v13, 0x20000, v5
    v_xor_b32 v66, 4, v65
    v_lshl_add_u32 v6, v66, 4, v64
    v_add_u32 v10, 0x10000, v6
    v_add_u32 v14, 0x20000, v6
    v_xor_b32 v66, 6, v65
    v_lshl_add_u32 v7, v66, 4, v64
    v_add_u32 v11, 0x10000, v7
    v_add_u32 v15, 0x20000, v7
    s_mul_i32 s42, s36, 52
    s_lshr_b32 s42, s42, 8
    s_mul_i32 s43, s42, 5
    s_sub_u32 s43, s36, s43
    s_lshl_b32 s65, s43, 1
    s_lshr_b32 s44, s34, 2
    s_add_u32 s65, s65, s44
    s_lshl_b32 s47, s35, 2
    s_and_b32 s44, s34, 3
    s_add_u32 s47, s47, s44
    s_mul_i32 s47, s47, 2560
    s_mov_b32 s64, 5242880
    s_cmp_eq_u32 s42, 0
    s_cselect_b32 s53, 0x3ea52b5c, 1.0
    s_cselect_b32 s44, 0, 5242880
    s_cselect_b32 s64, 1280, s64
    s_add_u32 s47, s47, s44
    s_add_u32 s64, s64, s47
    s_mov_b32 s43, 163840
    s_cmp_eq_u32 s42, 2
    s_cbranch_scc1 L_gemm_v
    s_lshl_b32 s42, s65, 4
    v_add_u32 v64, s42, v18
    v_lshlrev_b32 v67, 3, v19
    v_add_u32 v65, 0, v64
    v_mul_u32_u24 v66, 205, v65
    v_lshrrev_b32 v66, 10, v66
    v_mad_u32_u24 v32, v66, s43, v67
    v_lshl_add_u32 v32, v65, 8, v32
    v_mul_u32_u24 v66, 1280, v66
    v_sub_u32 v32, v32, v66
    v_add_u32 v65, 2, v64
    v_mul_u32_u24 v66, 205, v65
    v_lshrrev_b32 v66, 10, v66
    v_mad_u32_u24 v33, v66, s43, v67
    v_lshl_add_u32 v33, v65, 8, v33
    v_mul_u32_u24 v66, 1280, v66
    v_sub_u32 v33, v33, v66
    v_add_u32 v65, 4, v64
    v_mul_u32_u24 v66, 205, v65
    v_lshrrev_b32 v66, 10, v66
    v_mad_u32_u24 v34, v66, s43, v67
    v_lshl_add_u32 v34, v65, 8, v34
    v_mul_u32_u24 v66, 1280, v66
    v_sub_u32 v34, v34, v66
    v_add_u32 v65, 6, v64
    v_mul_u32_u24 v66, 205, v65
    v_lshrrev_b32 v66, 10, v66
    v_mad_u32_u24 v35, v66, s43, v67
    v_lshl_add_u32 v35, v65, 8, v35
    v_mul_u32_u24 v66, 1280, v66
    v_sub_u32 v35, v35, v66
    v_add_u32 v65, 8, v64
    v_mul_u32_u24 v66, 205, v65
    v_lshrrev_b32 v66, 10, v66
    v_mad_u32_u24 v36, v66, s43, v67
    v_lshl_add_u32 v36, v65, 8, v36
    v_mul_u32_u24 v66, 1280, v66
    v_sub_u32 v36, v36, v66
    v_add_u32 v65, 10, v64
    v_mul_u32_u24 v66, 205, v65
    v_lshrrev_b32 v66, 10, v66
    v_mad_u32_u24 v37, v66, s43, v67
    v_lshl_add_u32 v37, v65, 8, v37
    v_mul_u32_u24 v66, 1280, v66
    v_sub_u32 v37, v37, v66
    v_add_u32 v65, 12, v64
    v_mul_u32_u24 v66, 205, v65
    v_lshrrev_b32 v66, 10, v66
    v_mad_u32_u24 v38, v66, s43, v67
    v_lshl_add_u32 v38, v65, 8, v38
    v_mul_u32_u24 v66, 1280, v66
    v_sub_u32 v38, v38, v66
    v_add_u32 v65, 14, v64
    v_mul_u32_u24 v66, 205, v65
    v_lshrrev_b32 v66, 10, v66
    v_mad_u32_u24 v39, v66, s43, v67
    v_lshl_add_u32 v39, v65, 8, v39
    v_mul_u32_u24 v66, 1280, v66
    v_sub_u32 v39, v39, v66
    buffer_load_dword v46, v20, s[16:19], s55 offen
    s_waitcnt vmcnt(5)
    s_barrier
    ds_read_b128 v[96:99], v4 offset:0
    ds_read_b64_tr_b16 v[48:49], v40 offset:16384
    ds_read_b64_tr_b16 v[50:51], v40 offset:17408
    ds_read_b64_tr_b16 v[52:53], v41 offset:16384
    ds_read_b64_tr_b16 v[54:55], v41 offset:17408
    ds_read_b128 v[100:103], v5 offset:0
    ds_read_b64_tr_b16 v[56:57], v40 offset:20480
    ds_read_b64_tr_b16 v[58:59], v40 offset:21504
    ds_read_b64_tr_b16 v[60:61], v41 offset:20480
    ds_read_b64_tr_b16 v[62:63], v41 offset:21504
    s_waitcnt lgkmcnt(7)
    v_mfma_f32_32x32x16_bf16 v[64:79], v[48:51], v[96:99], 0
    ds_read_b128 v[104:107], v6 offset:0
    ds_read_b64_tr_b16 v[48:49], v40 offset:24576
    ds_read_b64_tr_b16 v[50:51], v40 offset:25600
    s_add_u32 m0, s46, 65536
    s_add_u32 s91, s38, s60
    buffer_load_dwordx4 v2, s[4:7], s91 offen lds
    s_waitcnt lgkmcnt(8)
    v_mfma_f32_32x32x16_bf16 v[80:95], v[52:55], v[96:99], 0
    ds_read_b64_tr_b16 v[52:53], v41 offset:24576
    ds_read_b64_tr_b16 v[54:55], v41 offset:25600
    s_add_u32 m0, s46, 66560
    s_nop 0
    buffer_load_dwordx4 v3, s[4:7], s91 offen lds
    s_waitcnt lgkmcnt(7)
    v_mfma_f32_32x32x16_bf16 v[64:79], v[56:59], v[100:103], v[64:79]
    ds_read_b128 v[108:111], v7 offset:0
    ds_read_b64_tr_b16 v[56:57], v40 offset:28672
    ds_read_b64_tr_b16 v[58:59], v40 offset:29696
    s_mul_i32 s92, s60, 1920
    s_add_u32 m0, s46, 81920
    s_add_u32 s92, s92, s39
    buffer_load_dwordx4 v0, s[8:11], s92 offen lds
    s_waitcnt lgkmcnt(8)
    v_mfma_f32_32x32x16_bf16 v[80:95], v[60:63], v[100:103], v[80:95]
    ds_read_b64_tr_b16 v[60:61], v41 offset:28672
    ds_read_b64_tr_b16 v[62:63], v41 offset:29696
    s_add_u32 m0, s46, 82944
    s_add_u32 s92, s92, 15360
    buffer_load_dwordx4 v0, s[8:11], s92 offen lds
    s_add_u32 s60, s60, 128
    s_cmp_eq_u32 s60, 1280
    s_cselect_b32 s60, 0, s60
    s_waitcnt vmcnt(5)
    s_barrier
    s_waitcnt lgkmcnt(7)
    v_mfma_f32_32x32x16_bf16 v[64:79], v[48:51], v[104:107], v[64:79]
    ds_read_b128 v[112:115], v4 offset:32768
    ds_read_b64_tr_b16 v[48:49], v40 offset:49152
    ds_read_b64_tr_b16 v[50:51], v40 offset:50176
    s_add_u32 m0, s46, 98304
    s_add_u32 s91, s38, s60
    buffer_load_dwordx4 v2, s[4:7], s91 offen lds
    s_waitcnt lgkmcnt(8)
    v_mfma_f32_32x32x16_bf16 v[80:95], v[52:55], v[104:107], v[80:95]
    ds_read_b64_tr_b16 v[52:53], v41 offset:49152
    ds_read_b64_tr_b16 v[54:55], v41 offset:50176
    s_add_u32 m0, s46, 99328
    s_nop 0
    buffer_load_dwordx4 v3, s[4:7], s91 offen lds
    s_waitcnt lgkmcnt(7)
    v_mfma_f32_32x32x16_bf16 v[64:79], v[56:59], v[108:111], v[64:79]
    ds_read_b128 v[116:119], v5 offset:32768
    ds_read_b64_tr_b16 v[56:57], v40 offset:53248
    ds_read_b64_tr_b16 v[58:59], v40 offset:54272
    s_mul_i32 s92, s60, 1920
    s_add_u32 m0, s46, 114688
    s_add_u32 s92, s92, s39
    buffer_load_dwordx4 v0, s[8:11], s92 offen lds
    s_waitcnt lgkmcnt(8)
    v_mfma_f32_32x32x16_bf16 v[80:95], v[60:63], v[108:111], v[80:95]
    ds_read_b64_tr_b16 v[60:61], v41 offset:53248
    ds_read_b64_tr_b16 v[62:63], v41 offset:54272
    s_add_u32 m0, s46, 115712
    s_add_u32 s92, s92, 15360
    buffer_load_dwordx4 v0, s[8:11], s92 offen lds
    s_add_u32 s60, s60, 128
    s_cmp_eq_u32 s60, 1280
    s_cselect_b32 s60, 0, s60
    s_waitcnt lgkmcnt(7)
    v_mfma_f32_32x32x16_bf16 v[64:79], v[48:51], v[112:115], v[64:79]
    ds_read_b128 v[120:123], v6 offset:32768
    ds_read_b64_tr_b16 v[48:49], v40 offset:57344
    ds_read_b64_tr_b16 v[50:51], v40 offset:58368
    s_waitcnt lgkmcnt(8)
    v_mfma_f32_32x32x16_bf16 v[80:95], v[52:55], v[112:115], v[80:95]
    ds_read_b64_tr_b16 v[52:53], v41 offset:57344
    ds_read_b64_tr_b16 v[54:55], v41 offset:58368
    s_add_u32 m0, s46, 131072
    s_add_u32 s91, s38, s60
    buffer_load_dwordx4 v2, s[4:7], s91 offen lds
    s_waitcnt lgkmcnt(7)
    v_mfma_f32_32x32x16_bf16 v[64:79], v[56:59], v[116:119], v[64:79]
    ds_read_b128 v[124:127], v7 offset:32768
    ds_read_b64_tr_b16 v[56:57], v40 offset:61440
    ds_read_b64_tr_b16 v[58:59], v40 offset:62464
    s_waitcnt lgkmcnt(8)
    v_mfma_f32_32x32x16_bf16 v[80:95], v[60:63], v[116:119], v[80:95]
    ds_read_b64_tr_b16 v[60:61], v41 offset:61440
    ds_read_b64_tr_b16 v[62:63], v41 offset:62464
    s_add_u32 m0, s46, 132096
    s_nop 0
    buffer_load_dwordx4 v3, s[4:7], s91 offen lds
    s_waitcnt vmcnt(6)
    s_barrier
    s_waitcnt lgkmcnt(7)
    v_mfma_f32_32x32x16_bf16 v[64:79], v[48:51], v[120:123], v[64:79]
    ds_read_b128 v[128:131], v8 offset:0
    ds_read_b64_tr_b16 v[48:49], v42 offset:16384
    ds_read_b64_tr_b16 v[50:51], v42 offset:17408
    s_waitcnt lgkmcnt(8)
    v_mfma_f32_32x32x16_bf16 v[80:95], v[52:55], v[120:123], v[80:95]
    ds_read_b64_tr_b16 v[52:53], v43 offset:16384
    ds_read_b64_tr_b16 v[54:55], v43 offset:17408
    s_mul_i32 s92, s60, 1920
    s_add_u32 m0, s46, 147456
    s_add_u32 s92, s92, s39
    buffer_load_dwordx4 v0, s[8:11], s92 offen lds
    s_waitcnt lgkmcnt(7)
    v_mfma_f32_32x32x16_bf16 v[64:79], v[56:59], v[124:127], v[64:79]
    ds_read_b128 v[132:135], v9 offset:0
    ds_read_b64_tr_b16 v[56:57], v42 offset:20480
    ds_read_b64_tr_b16 v[58:59], v42 offset:21504
    s_waitcnt lgkmcnt(8)
    v_mfma_f32_32x32x16_bf16 v[80:95], v[60:63], v[124:127], v[80:95]
    ds_read_b64_tr_b16 v[60:61], v43 offset:20480
    ds_read_b64_tr_b16 v[62:63], v43 offset:21504
    s_add_u32 m0, s46, 148480
    s_add_u32 s92, s92, 15360
    buffer_load_dwordx4 v0, s[8:11], s92 offen lds
    s_add_u32 s60, s60, 128
    s_cmp_eq_u32 s60, 1280
    s_cselect_b32 s60, 0, s60
    s_waitcnt lgkmcnt(7)
    v_mfma_f32_32x32x16_bf16 v[64:79], v[48:51], v[128:131], v[64:79]
    ds_read_b128 v[136:139], v10 offset:0
    ds_read_b64_tr_b16 v[48:49], v42 offset:24576
    ds_read_b64_tr_b16 v[50:51], v42 offset:25600
    s_waitcnt lgkmcnt(8)
    v_mfma_f32_32x32x16_bf16 v[80:95], v[52:55], v[128:131], v[80:95]
    ds_read_b64_tr_b16 v[52:53], v43 offset:24576
    ds_read_b64_tr_b16 v[54:55], v43 offset:25600
    s_add_u32 m0, s46, 0
    s_add_u32 s91, s38, s60
    buffer_load_dwordx4 v2, s[4:7], s91 offen lds
    s_waitcnt lgkmcnt(7)
    v_mfma_f32_32x32x16_bf16 v[64:79], v[56:59], v[132:135], v[64:79]
    ds_read_b128 v[140:143], v11 offset:0
    ds_read_b64_tr_b16 v[56:57], v42 offset:28672
    ds_read_b64_tr_b16 v[58:59], v42 offset:29696
    s_waitcnt lgkmcnt(8)
    v_mfma_f32_32x32x16_bf16 v[80:95], v[60:63], v[132:135], v[80:95]
    ds_read_b64_tr_b16 v[60:61], v43 offset:28672
    ds_read_b64_tr_b16 v[62:63], v43 offset:29696
    s_add_u32 m0, s46, 1024
    s_nop 0
    buffer_load_dwordx4 v3, s[4:7], s91 offen lds
    s_waitcnt vmcnt(6)
    s_barrier
    s_waitcnt lgkmcnt(7)
    v_mfma_f32_32x32x16_bf16 v[64:79], v[48:51], v[136:139], v[64:79]
    ds_read_b128 v[144:147], v8 offset:32768
    ds_read_b64_tr_b16 v[48:49], v42 offset:49152
    ds_read_b64_tr_b16 v[50:51], v42 offset:50176
    s_waitcnt lgkmcnt(8)
    v_mfma_f32_32x32x16_bf16 v[80:95], v[52:55], v[136:139], v[80:95]
    ds_read_b64_tr_b16 v[52:53], v43 offset:49152
    ds_read_b64_tr_b16 v[54:55], v43 offset:50176
    s_mul_i32 s92, s60, 1920
    s_add_u32 m0, s46, 16384
    s_add_u32 s92, s92, s39
    buffer_load_dwordx4 v0, s[8:11], s92 offen lds
    s_waitcnt lgkmcnt(7)
    v_mfma_f32_32x32x16_bf16 v[64:79], v[56:59], v[140:143], v[64:79]
    ds_read_b128 v[148:151], v9 offset:32768
    ds_read_b64_tr_b16 v[56:57], v42 offset:53248
    ds_read_b64_tr_b16 v[58:59], v42 offset:54272
    s_waitcnt lgkmcnt(8)
    v_mfma_f32_32x32x16_bf16 v[80:95], v[60:63], v[140:143], v[80:95]
    ds_read_b64_tr_b16 v[60:61], v43 offset:53248
    ds_read_b64_tr_b16 v[62:63], v43 offset:54272
    s_add_u32 m0, s46, 17408
    s_add_u32 s92, s92, 15360
    buffer_load_dwordx4 v0, s[8:11], s92 offen lds
    s_add_u32 s60, s60, 128
    s_cmp_eq_u32 s60, 1280
    s_cselect_b32 s60, 0, s60
    s_waitcnt lgkmcnt(7)
    v_mfma_f32_32x32x16_bf16 v[64:79], v[48:51], v[144:147], v[64:79]
    ds_read_b128 v[152:155], v10 offset:32768
    ds_read_b64_tr_b16 v[48:49], v42 offset:57344
    ds_read_b64_tr_b16 v[50:51], v42 offset:58368
    s_waitcnt lgkmcnt(8)
    v_mfma_f32_32x32x16_bf16 v[80:95], v[52:55], v[144:147], v[80:95]
    ds_read_b64_tr_b16 v[52:53], v43 offset:57344
    ds_read_b64_tr_b16 v[54:55], v43 offset:58368
    s_add_u32 m0, s46, 32768
    s_add_u32 s91, s38, s60
    buffer_load_dwordx4 v2, s[4:7], s91 offen lds
    s_waitcnt lgkmcnt(7)
    v_mfma_f32_32x32x16_bf16 v[64:79], v[56:59], v[148:151], v[64:79]
    ds_read_b128 v[156:159], v11 offset:32768
    ds_read_b64_tr_b16 v[56:57], v42 offset:61440
    ds_read_b64_tr_b16 v[58:59], v42 offset:62464
    s_waitcnt lgkmcnt(8)
    v_mfma_f32_32x32x16_bf16 v[80:95], v[60:63], v[148:151], v[80:95]
    ds_read_b64_tr_b16 v[60:61], v43 offset:61440
    ds_read_b64_tr_b16 v[62:63], v43 offset:62464
    s_add_u32 m0, s46, 33792
    s_nop 0
    buffer_load_dwordx4 v3, s[4:7], s91 offen lds
    s_waitcnt vmcnt(6)
    s_barrier
    s_waitcnt lgkmcnt(7)
    v_mfma_f32_32x32x16_bf16 v[64:79], v[48:51], v[152:155], v[64:79]
    ds_read_b128 v[160:163], v12 offset:0
    ds_read_b64_tr_b16 v[48:49], v44 offset:16384
    ds_read_b64_tr_b16 v[50:51], v44 offset:17408
    s_waitcnt lgkmcnt(8)
    v_mfma_f32_32x32x16_bf16 v[80:95], v[52:55], v[152:155], v[80:95]
    ds_read_b64_tr_b16 v[52:53], v45 offset:16384
    ds_read_b64_tr_b16 v[54:55], v45 offset:17408
    s_mul_i32 s92, s60, 1920
    s_add_u32 m0, s46, 49152
    s_add_u32 s92, s92, s39
    buffer_load_dwordx4 v0, s[8:11], s92 offen lds
    s_waitcnt lgkmcnt(7)
    v_mfma_f32_32x32x16_bf16 v[64:79], v[56:59], v[156:159], v[64:79]
    ds_read_b128 v[164:167], v13 offset:0
    ds_read_b64_tr_b16 v[56:57], v44 offset:20480
    ds_read_b64_tr_b16 v[58:59], v44 offset:21504
    s_waitcnt lgkmcnt(8)
    v_mfma_f32_32x32x16_bf16 v[80:95], v[60:63], v[156:159], v[80:95]
    ds_read_b64_tr_b16 v[60:61], v45 offset:20480
    ds_read_b64_tr_b16 v[62:63], v45 offset:21504
    s_add_u32 m0, s46, 50176
    s_add_u32 s92, s92, 15360
    buffer_load_dwordx4 v0, s[8:11], s92 offen lds
    s_add_u32 s60, s60, 128
    s_cmp_eq_u32 s60, 1280
    s_cselect_b32 s60, 0, s60
    s_waitcnt lgkmcnt(7)
    v_mfma_f32_32x32x16_bf16 v[64:79], v[48:51], v[160:163], v[64:79]
    ds_read_b128 v[168:171], v14 offset:0
    ds_read_b64_tr_b16 v[48:49], v44 offset:24576
    ds_read_b64_tr_b16 v[50:51], v44 offset:25600
    s_waitcnt lgkmcnt(8)
    v_mfma_f32_32x32x16_bf16 v[80:95], v[52:55], v[160:163], v[80:95]
    ds_read_b64_tr_b16 v[52:53], v45 offset:24576
    ds_read_b64_tr_b16 v[54:55], v45 offset:25600
    s_add_u32 m0, s46, 65536
    s_add_u32 s91, s38, s60
    buffer_load_dwordx4 v2, s[4:7], s91 offen lds
    s_waitcnt lgkmcnt(7)
    v_mfma_f32_32x32x16_bf16 v[64:79], v[56:59], v[164:167], v[64:79]
    ds_read_b128 v[172:175], v15 offset:0
    ds_read_b64_tr_b16 v[56:57], v44 offset:28672
    ds_read_b64_tr_b16 v[58:59], v44 offset:29696
    s_waitcnt lgkmcnt(8)
    v_mfma_f32_32x32x16_bf16 v[80:95], v[60:63], v[164:167], v[80:95]
    ds_read_b64_tr_b16 v[60:61], v45 offset:28672
    ds_read_b64_tr_b16 v[62:63], v45 offset:29696
    s_add_u32 m0, s46, 66560
    s_nop 0
    buffer_load_dwordx4 v3, s[4:7], s91 offen lds
    s_waitcnt vmcnt(6)
    s_barrier
    s_waitcnt lgkmcnt(7)
    v_mfma_f32_32x32x16_bf16 v[64:79], v[48:51], v[168:171], v[64:79]
    ds_read_b128 v[176:179], v4 offset:0
    ds_read_b64_tr_b16 v[48:49], v40 offset:16384
    ds_read_b64_tr_b16 v[50:51], v40 offset:17408
    s_waitcnt lgkmcnt(8)
    v_mfma_f32_32x32x16_bf16 v[80:95], v[52:55], v[168:171], v[80:95]
    ds_read_b64_tr_b16 v[52:53], v41 offset:16384
    ds_read_b64_tr_b16 v[54:55], v41 offset:17408
    s_mul_i32 s92, s60, 1920
    s_add_u32 m0, s46, 81920
    s_add_u32 s92, s92, s39
    buffer_load_dwordx4 v0, s[8:11], s92 offen lds
    s_waitcnt lgkmcnt(7)
    v_mfma_f32_32x32x16_bf16 v[64:79], v[56:59], v[172:175], v[64:79]
    ds_read_b128 v[180:183], v5 offset:0
    ds_read_b64_tr_b16 v[56:57], v40 offset:20480
    ds_read_b64_tr_b16 v[58:59], v40 offset:21504
    s_waitcnt lgkmcnt(8)
    v_mfma_f32_32x32x16_bf16 v[80:95], v[60:63], v[172:175], v[80:95]
    ds_read_b64_tr_b16 v[60:61], v41 offset:20480
    ds_read_b64_tr_b16 v[62:63], v41 offset:21504
    s_add_u32 m0, s46, 82944
    s_add_u32 s92, s92, 15360
    buffer_load_dwordx4 v0, s[8:11], s92 offen lds
    s_add_u32 s60, s60, 128
    s_cmp_eq_u32 s60, 1280
    s_cselect_b32 s60, 0, s60
    s_waitcnt lgkmcnt(7)
    v_mfma_f32_32x32x16_bf16 v[64:79], v[48:51], v[176:179], v[64:79]
    ds_read_b128 v[184:187], v6 offset:0
    ds_read_b64_tr_b16 v[48:49], v40 offset:24576
    ds_read_b64_tr_b16 v[50:51], v40 offset:25600
    s_waitcnt lgkmcnt(8)
    v_mfma_f32_32x32x16_bf16 v[80:95], v[52:55], v[176:179], v[80:95]
    ds_read_b64_tr_b16 v[52:53], v41 offset:24576
    ds_read_b64_tr_b16 v[54:55], v41 offset:25600
    s_add_u32 m0, s46, 98304
    s_add_u32 s91, s38, s60
    buffer_load_dwordx4 v2, s[4:7], s91 offen lds
    s_waitcnt lgkmcnt(7)
    v_mfma_f32_32x32x16_bf16 v[64:79], v[56:59], v[180:183], v[64:79]
    ds_read_b128 v[188:191], v7 offset:0
    ds_read_b64_tr_b16 v[56:57], v40 offset:28672
    ds_read_b64_tr_b16 v[58:59], v40 offset:29696
    s_waitcnt lgkmcnt(8)
    v_mfma_f32_32x32x16_bf16 v[80:95], v[60:63], v[180:183], v[80:95]
    ds_read_b64_tr_b16 v[60:61], v41 offset:28672
    ds_read_b64_tr_b16 v[62:63], v41 offset:29696
    s_add_u32 m0, s46, 99328
    s_nop 0
    buffer_load_dwordx4 v3, s[4:7], s91 offen lds
    s_waitcnt vmcnt(6)
    s_barrier
    s_waitcnt lgkmcnt(7)
    v_mfma_f32_32x32x16_bf16 v[64:79], v[48:51], v[184:187], v[64:79]
    ds_read_b128 v[192:195], v4 offset:32768
    ds_read_b64_tr_b16 v[48:49], v40 offset:49152
    ds_read_b64_tr_b16 v[50:51], v40 offset:50176
    s_waitcnt lgkmcnt(8)
    v_mfma_f32_32x32x16_bf16 v[80:95], v[52:55], v[184:187], v[80:95]
    ds_read_b64_tr_b16 v[52:53], v41 offset:49152
    ds_read_b64_tr_b16 v[54:55], v41 offset:50176
    s_mul_i32 s92, s60, 1920
    s_add_u32 m0, s46, 114688
    s_add_u32 s92, s92, s39
    buffer_load_dwordx4 v0, s[8:11], s92 offen lds
    s_waitcnt lgkmcnt(7)
    v_mfma_f32_32x32x16_bf16 v[64:79], v[56:59], v[188:191], v[64:79]
    ds_read_b128 v[196:199], v5 offset:32768
    ds_read_b64_tr_b16 v[56:57], v40 offset:53248
    ds_read_b64_tr_b16 v[58:59], v40 offset:54272
    s_waitcnt lgkmcnt(8)
    v_mfma_f32_32x32x16_bf16 v[80:95], v[60:63], v[188:191], v[80:95]
    ds_read_b64_tr_b16 v[60:61], v41 offset:53248
    ds_read_b64_tr_b16 v[62:63], v41 offset:54272
    s_add_u32 m0, s46, 115712
    s_add_u32 s92, s92, 15360
    buffer_load_dwordx4 v0, s[8:11], s92 offen lds
    s_add_u32 s60, s60, 128
    s_cmp_eq_u32 s60, 1280
    s_cselect_b32 s60, 0, s60
    s_waitcnt lgkmcnt(7)
    v_mfma_f32_32x32x16_bf16 v[64:79], v[48:51], v[192:195], v[64:79]
    ds_read_b128 v[200:203], v6 offset:32768
    ds_read_b64_tr_b16 v[48:49], v40 offset:57344
    ds_read_b64_tr_b16 v[50:51], v40 offset:58368
    s_waitcnt lgkmcnt(8)
    v_mfma_f32_32x32x16_bf16 v[80:95], v[52:55], v[192:195], v[80:95]
    ds_read_b64_tr_b16 v[52:53], v41 offset:57344
    ds_read_b64_tr_b16 v[54:55], v41 offset:58368
    s_add_u32 m0, s46, 131072
    s_add_u32 s91, s38, s60
    buffer_load_dwordx4 v2, s[4:7], s91 offen lds
    s_waitcnt lgkmcnt(7)
    v_mfma_f32_32x32x16_bf16 v[64:79], v[56:59], v[196:199], v[64:79]
    ds_read_b128 v[204:207], v7 offset:32768
    ds_read_b64_tr_b16 v[56:57], v40 offset:61440
    ds_read_b64_tr_b16 v[58:59], v40 offset:62464
    s_waitcnt lgkmcnt(8)
    v_mfma_f32_32x32x16_bf16 v[80:95], v[60:63], v[196:199], v[80:95]
    ds_read_b64_tr_b16 v[60:61], v41 offset:61440
    ds_read_b64_tr_b16 v[62:63], v41 offset:62464
    s_add_u32 m0, s46, 132096
    s_nop 0
    buffer_load_dwordx4 v3, s[4:7], s91 offen lds
    s_waitcnt vmcnt(6)
    s_barrier
    s_waitcnt lgkmcnt(7)
    v_mfma_f32_32x32x16_bf16 v[64:79], v[48:51], v[200:203], v[64:79]
    ds_read_b128 v[208:211], v8 offset:0
    ds_read_b64_tr_b16 v[48:49], v42 offset:16384
    ds_read_b64_tr_b16 v[50:51], v42 offset:17408
    s_waitcnt lgkmcnt(8)
    v_mfma_f32_32x32x16_bf16 v[80:95], v[52:55], v[200:203], v[80:95]
    ds_read_b64_tr_b16 v[52:53], v43 offset:16384
    ds_read_b64_tr_b16 v[54:55], v43 offset:17408
    s_mul_i32 s92, s60, 1920
    s_add_u32 m0, s46, 147456
    s_add_u32 s92, s92, s39
    buffer_load_dwordx4 v0, s[8:11], s92 offen lds
    s_waitcnt lgkmcnt(7)
    v_mfma_f32_32x32x16_bf16 v[64:79], v[56:59], v[204:207], v[64:79]
    ds_read_b128 v[212:215], v9 offset:0
    ds_read_b64_tr_b16 v[56:57], v42 offset:20480
    ds_read_b64_tr_b16 v[58:59], v42 offset:21504
    s_waitcnt lgkmcnt(8)
    v_mfma_f32_32x32x16_bf16 v[80:95], v[60:63], v[204:207], v[80:95]
    ds_read_b64_tr_b16 v[60:61], v43 offset:20480
    ds_read_b64_tr_b16 v[62:63], v43 offset:21504
    s_add_u32 m0, s46, 148480
    s_add_u32 s92, s92, 15360
    buffer_load_dwordx4 v0, s[8:11], s92 offen lds
    s_add_u32 s60, s60, 128
    s_cmp_eq_u32 s60, 1280
    s_cselect_b32 s60, 0, s60
    s_mov_b64 exec, 0xfffff
    buffer_load_dword v46, v47, s[12:15], s37 offen
    s_mov_b64 exec, -1
    s_waitcnt lgkmcnt(7)
    v_mfma_f32_32x32x16_bf16 v[64:79], v[48:51], v[208:211], v[64:79]
    ds_read_b128 v[216:219], v10 offset:0
    ds_read_b64_tr_b16 v[48:49], v42 offset:24576
    ds_read_b64_tr_b16 v[50:51], v42 offset:25600
    s_waitcnt lgkmcnt(8)
    v_mfma_f32_32x32x16_bf16 v[80:95], v[52:55], v[208:211], v[80:95]
    ds_read_b64_tr_b16 v[52:53], v43 offset:24576
    ds_read_b64_tr_b16 v[54:55], v43 offset:25600
    s_mul_i32 s92, s60, 1920
    s_add_u32 m0, s46, 0
    s_add_u32 s92, s92, s39
    buffer_load_dwordx4 v0, s[12:15], s92 offen lds
    s_waitcnt lgkmcnt(7)
    v_mfma_f32_32x32x16_bf16 v[64:79], v[56:59], v[212:215], v[64:79]
    ds_read_b128 v[220:223], v11 offset:0
    ds_read_b64_tr_b16 v[56:57], v42 offset:28672
    ds_read_b64_tr_b16 v[58:59], v42 offset:29696
    s_waitcnt lgkmcnt(8)
    v_mfma_f32_32x32x16_bf16 v[80:95], v[60:63], v[212:215], v[80:95]
    ds_read_b64_tr_b16 v[60:61], v43 offset:28672
    ds_read_b64_tr_b16 v[62:63], v43 offset:29696
    s_add_u32 m0, s46, 1024
    s_add_u32 s92, s92, 15360
    buffer_load_dwordx4 v0, s[12:15], s92 offen lds
    s_add_u32 s60, s60, 128
    s_cmp_eq_u32 s60, 1280
    s_cselect_b32 s60, 0, s60
    s_waitcnt vmcnt(7)
    s_barrier
    s_waitcnt lgkmcnt(7)
    v_mfma_f32_32x32x16_bf16 v[64:79], v[48:51], v[216:219], v[64:79]
    ds_read_b128 v[224:227], v8 offset:32768
    ds_read_b64_tr_b16 v[48:49], v42 offset:49152
    ds_read_b64_tr_b16 v[50:51], v42 offset:50176
    s_waitcnt lgkmcnt(8)
    v_mfma_f32_32x32x16_bf16 v[80:95], v[52:55], v[216:219], v[80:95]
    ds_read_b64_tr_b16 v[52:53], v43 offset:49152
    ds_read_b64_tr_b16 v[54:55], v43 offset:50176
    s_mul_i32 s92, s60, 1920
    s_add_u32 m0, s46, 16384
    s_add_u32 s92, s92, s39
    buffer_load_dwordx4 v0, s[12:15], s92 offen lds
    s_waitcnt lgkmcnt(7)
    v_mfma_f32_32x32x16_bf16 v[64:79], v[56:59], v[220:223], v[64:79]
    ds_read_b128 v[228:231], v9 offset:32768
    ds_read_b64_tr_b16 v[56:57], v42 offset:53248
    ds_read_b64_tr_b16 v[58:59], v42 offset:54272
    s_waitcnt lgkmcnt(8)
    v_mfma_f32_32x32x16_bf16 v[80:95], v[60:63], v[220:223], v[80:95]
    ds_read_b64_tr_b16 v[60:61], v43 offset:53248
    ds_read_b64_tr_b16 v[62:63], v43 offset:54272
    s_add_u32 m0, s46, 17408
    s_add_u32 s92, s92, 15360
    buffer_load_dwordx4 v0, s[12:15], s92 offen lds
    s_add_u32 s60, s60, 128
    s_cmp_eq_u32 s60, 1280
    s_cselect_b32 s60, 0, s60
    s_waitcnt lgkmcnt(7)
    v_mfma_f32_32x32x16_bf16 v[64:79], v[48:51], v[224:227], v[64:79]
    ds_read_b128 v[232:235], v10 offset:32768
    ds_read_b64_tr_b16 v[48:49], v42 offset:57344
    ds_read_b64_tr_b16 v[50:51], v42 offset:58368
    s_waitcnt lgkmcnt(8)
    v_mfma_f32_32x32x16_bf16 v[80:95], v[52:55], v[224:227], v[80:95]
    ds_read_b64_tr_b16 v[52:53], v43 offset:57344
    ds_read_b64_tr_b16 v[54:55], v43 offset:58368
    s_mul_i32 s92, s60, 1920
    s_add_u32 m0, s46, 32768
    s_add_u32 s92, s92, s39
    buffer_load_dwordx4 v0, s[12:15], s92 offen lds
    s_waitcnt lgkmcnt(7)
    v_mfma_f32_32x32x16_bf16 v[64:79], v[56:59], v[228:231], v[64:79]
    ds_read_b128 v[236:239], v11 offset:32768
    ds_read_b64_tr_b16 v[56:57], v42 offset:61440
    ds_read_b64_tr_b16 v[58:59], v42 offset:62464
    s_waitcnt lgkmcnt(8)
    v_mfma_f32_32x32x16_bf16 v[80:95], v[60:63], v[228:231], v[80:95]
    ds_read_b64_tr_b16 v[60:61], v43 offset:61440
    ds_read_b64_tr_b16 v[62:63], v43 offset:62464
    s_add_u32 m0, s46, 33792
    s_add_u32 s92, s92, 15360
    buffer_load_dwordx4 v0, s[12:15], s92 offen lds
    s_add_u32 s60, s60, 128
    s_cmp_eq_u32 s60, 1280
    s_cselect_b32 s60, 0, s60
    s_waitcnt vmcnt(7)
    s_barrier
    s_waitcnt lgkmcnt(7)
    v_mfma_f32_32x32x16_bf16 v[64:79], v[48:51], v[232:235], v[64:79]
    ds_read_b128 v[240:243], v12 offset:0
    ds_read_b64_tr_b16 v[48:49], v44 offset:16384
    ds_read_b64_tr_b16 v[50:51], v44 offset:17408
    s_waitcnt lgkmcnt(8)
    v_mfma_f32_32x32x16_bf16 v[80:95], v[52:55], v[232:235], v[80:95]
    ds_read_b64_tr_b16 v[52:53], v45 offset:16384
    ds_read_b64_tr_b16 v[54:55], v45 offset:17408
    s_mul_i32 s92, s60, 1920
    s_add_u32 m0, s46, 49152
    s_add_u32 s92, s92, s39
    buffer_load_dwordx4 v0, s[12:15], s92 offen lds
    s_waitcnt lgkmcnt(7)
    v_mfma_f32_32x32x16_bf16 v[64:79], v[56:59], v[236:239], v[64:79]
    ds_read_b128 v[244:247], v13 offset:0
    ds_read_b64_tr_b16 v[56:57], v44 offset:20480
    ds_read_b64_tr_b16 v[58:59], v44 offset:21504
    s_waitcnt lgkmcnt(8)
    v_mfma_f32_32x32x16_bf16 v[80:95], v[60:63], v[236:239], v[80:95]
    ds_read_b64_tr_b16 v[60:61], v45 offset:20480
    ds_read_b64_tr_b16 v[62:63], v45 offset:21504
    s_add_u32 m0, s46, 50176
    s_add_u32 s92, s92, 15360
    buffer_load_dwordx4 v0, s[12:15], s92 offen lds
    s_add_u32 s60, s60, 128
    s_cmp_eq_u32 s60, 1280
    s_cselect_b32 s60, 0, s60
    s_waitcnt lgkmcnt(7)
    v_mfma_f32_32x32x16_bf16 v[64:79], v[48:51], v[240:243], v[64:79]
    ds_read_b128 v[248:251], v14 offset:0
    ds_read_b64_tr_b16 v[48:49], v44 offset:24576
    ds_read_b64_tr_b16 v[50:51], v44 offset:25600
    s_waitcnt lgkmcnt(8)
    v_mfma_f32_32x32x16_bf16 v[80:95], v[52:55], v[240:243], v[80:95]
    ds_read_b64_tr_b16 v[52:53], v45 offset:24576
    ds_read_b64_tr_b16 v[54:55], v45 offset:25600
    s_mul_i32 s92, s60, 1920
    s_add_u32 m0, s46, 65536
    s_add_u32 s92, s92, s39
    buffer_load_dwordx4 v0, s[12:15], s92 offen lds
    s_waitcnt lgkmcnt(7)
    v_mfma_f32_32x32x16_bf16 v[64:79], v[56:59], v[244:247], v[64:79]
    ds_read_b128 v[252:255], v15 offset:0
    ds_read_b64_tr_b16 v[56:57], v44 offset:28672
    ds_read_b64_tr_b16 v[58:59], v44 offset:29696
    s_waitcnt lgkmcnt(8)
    v_mfma_f32_32x32x16_bf16 v[80:95], v[60:63], v[244:247], v[80:95]
    ds_read_b64_tr_b16 v[60:61], v45 offset:28672
    ds_read_b64_tr_b16 v[62:63], v45 offset:29696
    s_add_u32 m0, s46, 66560
    s_add_u32 s92, s92, 15360
    buffer_load_dwordx4 v0, s[12:15], s92 offen lds
    s_add_u32 s60, s60, 128
    s_cmp_eq_u32 s60, 1280
    s_cselect_b32 s60, 0, s60
    s_waitcnt vmcnt(6)
    s_barrier
    s_waitcnt lgkmcnt(7)
    v_mfma_f32_32x32x16_bf16 v[64:79], v[48:51], v[248:251], v[64:79]
    ds_read_b64_tr_b16 v[48:49], v40 offset:0
    ds_read_b64_tr_b16 v[50:51], v40 offset:1024
    s_waitcnt lgkmcnt(7)
    v_mfma_f32_32x32x16_bf16 v[80:95], v[52:55], v[248:251], v[80:95]
    ds_read_b64_tr_b16 v[52:53], v41 offset:0
    ds_read_b64_tr_b16 v[54:55], v41 offset:1024
    s_mul_i32 s92, s60, 1920
    s_add_u32 m0, s46, 81920
    s_add_u32 s92, s92, s39
    buffer_load_dwordx4 v0, s[12:15], s92 offen lds
    s_waitcnt lgkmcnt(6)
    v_mfma_f32_32x32x16_bf16 v[64:79], v[56:59], v[252:255], v[64:79]
    ds_read_b64_tr_b16 v[56:57], v40 offset:4096
    ds_read_b64_tr_b16 v[58:59], v40 offset:5120
    s_waitcnt lgkmcnt(6)
    v_mfma_f32_32x32x16_bf16 v[80:95], v[60:63], v[252:255], v[80:95]
    ds_read_b64_tr_b16 v[60:61], v41 offset:4096
    ds_read_b64_tr_b16 v[62:63], v41 offset:5120
    s_add_u32 m0, s46, 82944
    s_add_u32 s92, s92, 15360
    buffer_load_dwordx4 v0, s[12:15], s92 offen lds
    s_add_u32 s60, s60, 128
    s_cmp_eq_u32 s60, 1280
    s_cselect_b32 s60, 0, s60
    s_nop 0
    v_pk_mul_f32 v[64:65], v[64:65], s[52:53] op_sel:[0,1] op_sel_hi:[1,1]
    v_pk_mul_f32 v[66:67], v[66:67], s[52:53] op_sel:[0,1] op_sel_hi:[1,1]
    v_pk_mul_f32 v[68:69], v[68:69], s[52:53] op_sel:[0,1] op_sel_hi:[1,1]
    v_pk_mul_f32 v[70:71], v[70:71], s[52:53] op_sel:[0,1] op_sel_hi:[1,1]
    v_pk_mul_f32 v[72:73], v[72:73], s[52:53] op_sel:[0,1] op_sel_hi:[1,1]
    v_pk_mul_f32 v[74:75], v[74:75], s[52:53] op_sel:[0,1] op_sel_hi:[1,1]
    v_pk_mul_f32 v[76:77], v[76:77], s[52:53] op_sel:[0,1] op_sel_hi:[1,1]
    v_pk_mul_f32 v[78:79], v[78:79], s[52:53] op_sel:[0,1] op_sel_hi:[1,1]
    v_cvt_pk_bf16_f32 v2, v64, v65
    v_cvt_pk_bf16_f32 v3, v66, v67
    v_cvt_pk_bf16_f32 v4, v68, v69
    v_cvt_pk_bf16_f32 v5, v70, v71
    v_cvt_pk_bf16_f32 v6, v72, v73
    v_cvt_pk_bf16_f32 v7, v74, v75
    v_cvt_pk_bf16_f32 v8, v76, v77
    v_cvt_pk_bf16_f32 v9, v78, v79
    v_pk_mul_f32 v[80:81], v[80:81], s[52:53] op_sel:[0,1] op_sel_hi:[1,1]
    v_pk_mul_f32 v[82:83], v[82:83], s[52:53] op_sel:[0,1] op_sel_hi:[1,1]
    v_pk_mul_f32 v[84:85], v[84:85], s[52:53] op_sel:[0,1] op_sel_hi:[1,1]
    v_pk_mul_f32 v[86:87], v[86:87], s[52:53] op_sel:[0,1] op_sel_hi:[1,1]
    v_pk_mul_f32 v[88:89], v[88:89], s[52:53] op_sel:[0,1] op_sel_hi:[1,1]
    v_pk_mul_f32 v[90:91], v[90:91], s[52:53] op_sel:[0,1] op_sel_hi:[1,1]
    v_pk_mul_f32 v[92:93], v[92:93], s[52:53] op_sel:[0,1] op_sel_hi:[1,1]
    v_pk_mul_f32 v[94:95], v[94:95], s[52:53] op_sel:[0,1] op_sel_hi:[1,1]
    v_cvt_pk_bf16_f32 v10, v80, v81
    v_cvt_pk_bf16_f32 v11, v82, v83
    v_cvt_pk_bf16_f32 v12, v84, v85
    v_cvt_pk_bf16_f32 v13, v86, v87
    v_cvt_pk_bf16_f32 v14, v88, v89
    v_cvt_pk_bf16_f32 v15, v90, v91
    v_cvt_pk_bf16_f32 v16, v92, v93
    v_cvt_pk_bf16_f32 v17, v94, v95
    s_waitcnt lgkmcnt(6)
    v_mfma_f32_32x32x16_bf16 v[64:79], v[48:51], v[96:99], 0
    ds_read_b64_tr_b16 v[48:49], v40 offset:8192
    ds_read_b64_tr_b16 v[50:51], v40 offset:9216
    buffer_store_dwordx2 v[2:3], v32, s[24:27], s47 offen sc1
    s_waitcnt lgkmcnt(6)
    v_mfma_f32_32x32x16_bf16 v[80:95], v[52:55], v[96:99], 0
    ds_read_b64_tr_b16 v[52:53], v41 offset:8192
    ds_read_b64_tr_b16 v[54:55], v41 offset:9216
    s_mul_i32 s92, s60, 1920
    s_add_u32 m0, s46, 98304
    s_add_u32 s92, s92, s39
    buffer_load_dwordx4 v0, s[12:15], s92 offen lds
    s_waitcnt lgkmcnt(6)
    v_mfma_f32_32x32x16_bf16 v[64:79], v[56:59], v[100:103], v[64:79]
    ds_read_b64_tr_b16 v[56:57], v40 offset:12288
    ds_read_b64_tr_b16 v[58:59], v40 offset:13312
    buffer_store_dwordx2 v[4:5], v33, s[24:27], s47 offen sc1
    s_waitcnt lgkmcnt(6)
    v_mfma_f32_32x32x16_bf16 v[80:95], v[60:63], v[100:103], v[80:95]
    ds_read_b64_tr_b16 v[60:61], v41 offset:12288
    ds_read_b64_tr_b16 v[62:63], v41 offset:13312
    s_add_u32 m0, s46, 99328
    s_add_u32 s92, s92, 15360
    buffer_load_dwordx4 v0, s[12:15], s92 offen lds
    s_add_u32 s60, s60, 128
    s_cmp_eq_u32 s60, 1280
    s_cselect_b32 s60, 0, s60
    s_waitcnt lgkmcnt(6)
    v_mfma_f32_32x32x16_bf16 v[64:79], v[48:51], v[104:107], v[64:79]
    ds_read_b64_tr_b16 v[48:49], v40 offset:16384
    ds_read_b64_tr_b16 v[50:51], v40 offset:17408
    buffer_store_dwordx2 v[6:7], v34, s[24:27], s47 offen sc1
    s_waitcnt lgkmcnt(6)
    v_mfma_f32_32x32x16_bf16 v[80:95], v[52:55], v[104:107], v[80:95]
    ds_read_b64_tr_b16 v[52:53], v41 offset:16384
    ds_read_b64_tr_b16 v[54:55], v41 offset:17408
    s_mul_i32 s92, s60, 1920
    s_add_u32 m0, s46, 114688
    s_add_u32 s92, s92, s39
    buffer_load_dwordx4 v0, s[12:15], s92 offen lds
    s_waitcnt lgkmcnt(6)
    v_mfma_f32_32x32x16_bf16 v[64:79], v[56:59], v[108:111], v[64:79]
    ds_read_b64_tr_b16 v[56:57], v40 offset:20480
    ds_read_b64_tr_b16 v[58:59], v40 offset:21504
    buffer_store_dwordx2 v[8:9], v35, s[24:27], s47 offen sc1
    s_waitcnt lgkmcnt(6)
    v_mfma_f32_32x32x16_bf16 v[80:95], v[60:63], v[108:111], v[80:95]
    ds_read_b64_tr_b16 v[60:61], v41 offset:20480
    ds_read_b64_tr_b16 v[62:63], v41 offset:21504
    s_add_u32 m0, s46, 115712
    s_add_u32 s92, s92, 15360
    buffer_load_dwordx4 v0, s[12:15], s92 offen lds
    s_add_u32 s60, s60, 128
    s_cmp_eq_u32 s60, 1280
    s_cselect_b32 s60, 0, s60
    s_waitcnt lgkmcnt(6)
    v_mfma_f32_32x32x16_bf16 v[64:79], v[48:51], v[112:115], v[64:79]
    ds_read_b64_tr_b16 v[48:49], v40 offset:24576
    ds_read_b64_tr_b16 v[50:51], v40 offset:25600
    buffer_store_dwordx2 v[10:11], v36, s[24:27], s47 offen sc1
    s_waitcnt lgkmcnt(6)
    v_mfma_f32_32x32x16_bf16 v[80:95], v[52:55], v[112:115], v[80:95]
    ds_read_b64_tr_b16 v[52:53], v41 offset:24576
    ds_read_b64_tr_b16 v[54:55], v41 offset:25600
    v_mov_b32 v46, 0
    buffer_load_dwordx2 v[24:25], v46, s[28:31], 0 offen sc1
    s_waitcnt lgkmcnt(6)
    v_mfma_f32_32x32x16_bf16 v[64:79], v[56:59], v[116:119], v[64:79]
    ds_read_b64_tr_b16 v[56:57], v40 offset:28672
    ds_read_b64_tr_b16 v[58:59], v40 offset:29696
    buffer_store_dwordx2 v[12:13], v37, s[24:27], s47 offen sc1
    s_waitcnt lgkmcnt(6)
    v_mfma_f32_32x32x16_bf16 v[80:95], v[60:63], v[116:119], v[80:95]
    ds_read_b64_tr_b16 v[60:61], v41 offset:28672
    ds_read_b64_tr_b16 v[62:63], v41 offset:29696
    s_waitcnt vmcnt(15)
    s_barrier
    s_waitcnt lgkmcnt(6)
    v_mfma_f32_32x32x16_bf16 v[64:79], v[48:51], v[120:123], v[64:79]
    ds_read_b64_tr_b16 v[48:49], v40 offset:32768
    ds_read_b64_tr_b16 v[50:51], v40 offset:33792
    buffer_store_dwordx2 v[14:15], v38, s[24:27], s47 offen sc1
    s_waitcnt lgkmcnt(6)
    v_mfma_f32_32x32x16_bf16 v[80:95], v[52:55], v[120:123], v[80:95]
    ds_read_b64_tr_b16 v[52:53], v41 offset:32768
    ds_read_b64_tr_b16 v[54:55], v41 offset:33792
    s_waitcnt lgkmcnt(6)
    v_mfma_f32_32x32x16_bf16 v[64:79], v[56:59], v[124:127], v[64:79]
    ds_read_b64_tr_b16 v[56:57], v40 offset:36864
    ds_read_b64_tr_b16 v[58:59], v40 offset:37888
    buffer_store_dwordx2 v[16:17], v39, s[24:27], s47 offen sc1
    s_waitcnt lgkmcnt(6)
    v_mfma_f32_32x32x16_bf16 v[80:95], v[60:63], v[124:127], v[80:95]
    ds_read_b64_tr_b16 v[60:61], v41 offset:36864
    ds_read_b64_tr_b16 v[62:63], v41 offset:37888
    s_waitcnt lgkmcnt(6)
    v_mfma_f32_32x32x16_bf16 v[64:79], v[48:51], v[128:131], v[64:79]
    ds_read_b64_tr_b16 v[48:49], v40 offset:40960
    ds_read_b64_tr_b16 v[50:51], v40 offset:41984
    s_mul_i32 s92, s60, 1920
    s_add_u32 m0, s46, 131072
    s_add_u32 s92, s92, s39
    buffer_load_dwordx4 v0, s[12:15], s92 offen lds
    s_waitcnt lgkmcnt(6)
    v_mfma_f32_32x32x16_bf16 v[80:95], v[52:55], v[128:131], v[80:95]
    ds_read_b64_tr_b16 v[52:53], v41 offset:40960
    ds_read_b64_tr_b16 v[54:55], v41 offset:41984
    s_add_u32 m0, s46, 132096
    s_add_u32 s92, s92, 15360
    buffer_load_dwordx4 v0, s[12:15], s92 offen lds
    s_add_u32 s60, s60, 128
    s_cmp_eq_u32 s60, 1280
    s_cselect_b32 s60, 0, s60
    s_waitcnt lgkmcnt(6)
    v_mfma_f32_32x32x16_bf16 v[64:79], v[56:59], v[132:135], v[64:79]
    ds_read_b64_tr_b16 v[56:57], v40 offset:45056
    ds_read_b64_tr_b16 v[58:59], v40 offset:46080
    s_mul_i32 s92, s60, 1920
    s_add_u32 m0, s46, 147456
    s_add_u32 s92, s92, s39
    buffer_load_dwordx4 v0, s[12:15], s92 offen lds
    s_waitcnt lgkmcnt(6)
    v_mfma_f32_32x32x16_bf16 v[80:95], v[60:63], v[132:135], v[80:95]
    ds_read_b64_tr_b16 v[60:61], v41 offset:45056
    ds_read_b64_tr_b16 v[62:63], v41 offset:46080
    s_add_u32 m0, s46, 148480
    s_add_u32 s92, s92, 15360
    buffer_load_dwordx4 v0, s[12:15], s92 offen lds
    s_add_u32 s60, s60, 128
    s_cmp_eq_u32 s60, 1280
    s_cselect_b32 s60, 0, s60
    s_waitcnt lgkmcnt(6)
    v_mfma_f32_32x32x16_bf16 v[64:79], v[48:51], v[136:139], v[64:79]
    ds_read_b64_tr_b16 v[48:49], v40 offset:49152
    ds_read_b64_tr_b16 v[50:51], v40 offset:50176
    s_waitcnt lgkmcnt(6)
    v_mfma_f32_32x32x16_bf16 v[80:95], v[52:55], v[136:139], v[80:95]
    ds_read_b64_tr_b16 v[52:53], v41 offset:49152
    ds_read_b64_tr_b16 v[54:55], v41 offset:50176
    s_waitcnt lgkmcnt(6)
    v_mfma_f32_32x32x16_bf16 v[64:79], v[56:59], v[140:143], v[64:79]
    ds_read_b64_tr_b16 v[56:57], v40 offset:53248
    ds_read_b64_tr_b16 v[58:59], v40 offset:54272
    s_waitcnt lgkmcnt(6)
    v_mfma_f32_32x32x16_bf16 v[80:95], v[60:63], v[140:143], v[80:95]
    ds_read_b64_tr_b16 v[60:61], v41 offset:53248
    ds_read_b64_tr_b16 v[62:63], v41 offset:54272
    s_waitcnt lgkmcnt(6)
    v_mfma_f32_32x32x16_bf16 v[64:79], v[48:51], v[144:147], v[64:79]
    ds_read_b64_tr_b16 v[48:49], v40 offset:57344
    ds_read_b64_tr_b16 v[50:51], v40 offset:58368
    s_waitcnt lgkmcnt(6)
    v_mfma_f32_32x32x16_bf16 v[80:95], v[52:55], v[144:147], v[80:95]
    ds_read_b64_tr_b16 v[52:53], v41 offset:57344
    ds_read_b64_tr_b16 v[54:55], v41 offset:58368
    s_waitcnt lgkmcnt(6)
    v_mfma_f32_32x32x16_bf16 v[64:79], v[56:59], v[148:151], v[64:79]
    ds_read_b64_tr_b16 v[56:57], v40 offset:61440
    ds_read_b64_tr_b16 v[58:59], v40 offset:62464
    s_waitcnt lgkmcnt(6)
    v_mfma_f32_32x32x16_bf16 v[80:95], v[60:63], v[148:151], v[80:95]
    ds_read_b64_tr_b16 v[60:61], v41 offset:61440
    ds_read_b64_tr_b16 v[62:63], v41 offset:62464
    s_waitcnt vmcnt(4)
    s_barrier
L_ck_nonk:
    v_cmp_ne_u32 vcc, 0, v24
    v_cmp_ne_u32 s[66:67], 0, v25
    s_nop 3
    s_and_b64 vcc, vcc, s[66:67]
    s_cbranch_scc0 L_sl_nonk
L_ok_nonk:
    s_cmp_lg_u32 s34, 0
    s_cbranch_scc1 L_fbk
    s_mov_b64 exec, 1
    buffer_store_dwordx2 v[24:25], v46, s[24:27], s56 offen offset:0 sc1
    s_mov_b64 exec, -1
L_fbk:
    s_waitcnt lgkmcnt(6)
    v_mfma_f32_32x32x16_bf16 v[64:79], v[48:51], v[152:155], v[64:79]
    ds_read_b64_tr_b16 v[48:49], v42 offset:0
    ds_read_b64_tr_b16 v[50:51], v42 offset:1024
    s_lshl_b32 s44, s34, 10
    v_add_u32 v112, s44, v20
    v_add_u32 v113, 8192, v112
    s_lshr_b32 s44, s34, 2
    s_lshl_b32 s44, s44, 13
    s_waitcnt lgkmcnt(6)
    v_mfma_f32_32x32x16_bf16 v[80:95], v[52:55], v[152:155], v[80:95]
    ds_read_b64_tr_b16 v[52:53], v43 offset:0
    ds_read_b64_tr_b16 v[54:55], v43 offset:1024
    s_sub_u32 s44, 8192, s44
    v_add_u32 v114, s44, v113
    v_lshlrev_b32 v117, 3, v1
    v_lshlrev_b32 v130, 3, v19
    v_add_u32 v118, 1024, v130
    s_waitcnt lgkmcnt(6)
    v_mfma_f32_32x32x16_bf16 v[64:79], v[56:59], v[156:159], v[64:79]
    ds_read_b64_tr_b16 v[56:57], v42 offset:4096
    ds_read_b64_tr_b16 v[58:59], v42 offset:5120
    v_lshrrev_b32 v120, 2, v19
    v_lshlrev_b32 v120, 2, v120
    v_mov_b32 v121, 0x43120
    v_bfe_u32 v120, v121, v120, 4
    v_lshlrev_b32 v120, 6, v120
    s_waitcnt lgkmcnt(6)
    v_mfma_f32_32x32x16_bf16 v[80:95], v[60:63], v[156:159], v[80:95]
    ds_read_b64_tr_b16 v[60:61], v43 offset:4096
    ds_read_b64_tr_b16 v[62:63], v43 offset:5120
    v_lshl_add_u32 v120, v21, 1, v120
    v_mul_u32_u24 v121, 320, v18
    v_add_u32 v115, v120, v121
    v_add_u32 v115, 1280, v115
    v_and_b32 v120, 27, v19
    s_waitcnt lgkmcnt(6)
    v_mfma_f32_32x32x16_bf16 v[64:79], v[48:51], v[160:163], v[64:79]
    ds_read_b64_tr_b16 v[48:49], v42 offset:8192
    ds_read_b64_tr_b16 v[50:51], v42 offset:9216
    v_cmp_eq_u32 vcc, 24, v120
    v_mov_b32 v122, 0x3f803f80
    v_mov_b32 v123, 5120
    v_mov_b32 v124, 5136
    v_cndmask_b32 v121, v124, v123, vcc
    s_waitcnt lgkmcnt(6)
    v_mfma_f32_32x32x16_bf16 v[80:95], v[52:55], v[160:163], v[80:95]
    ds_read_b64_tr_b16 v[52:53], v43 offset:8192
    ds_read_b64_tr_b16 v[54:55], v43 offset:9216
    v_cndmask_b32 v146, 0, v122, vcc
    s_and_b32 s44, s34, 1
    s_mul_i32 s44, s44, 2560
    v_add_u32 v108, s44, v117
    v_add_u32 v109, s44, v118
    s_waitcnt lgkmcnt(6)
    v_mfma_f32_32x32x16_bf16 v[64:79], v[56:59], v[164:167], v[64:79]
    ds_read_b64_tr_b16 v[56:57], v42 offset:12288
    ds_read_b64_tr_b16 v[58:59], v42 offset:13312
    v_cndmask_b32 v109, v109, v123, s[50:51]
    v_add_u32 v110, s44, v115
    v_add_u32 v111, 640, v110
    v_cmp_gt_u32 vcc, 20, v19
    v_mul_u32_u24 v120, 5632, v1
    s_waitcnt lgkmcnt(6)
    v_mfma_f32_32x32x16_bf16 v[80:95], v[60:63], v[164:167], v[80:95]
    ds_read_b64_tr_b16 v[60:61], v43 offset:12288
    ds_read_b64_tr_b16 v[62:63], v43 offset:13312
    v_add_u32 v120, 5120, v120
    v_cndmask_b32 v110, v121, v110, vcc
    v_cndmask_b32 v111, v121, v111, vcc
    v_mov_b32 v123, 0x3f803f80
    v_mov_b32 v124, 0x3f803f80
    s_waitcnt lgkmcnt(6)
    v_mfma_f32_32x32x16_bf16 v[64:79], v[48:51], v[168:171], v[64:79]
    ds_read_b64_tr_b16 v[48:49], v42 offset:16384
    ds_read_b64_tr_b16 v[50:51], v42 offset:17408
    v_mov_b32 v125, 0x3f803f80
    v_mov_b32 v152, 0
    v_mov_b32 v153, 0
    v_mov_b32 v154, 0
    v_mov_b32 v155, 0
    s_waitcnt lgkmcnt(6)
    v_mfma_f32_32x32x16_bf16 v[80:95], v[52:55], v[168:171], v[80:95]
    ds_read_b64_tr_b16 v[52:53], v43 offset:16384
    ds_read_b64_tr_b16 v[54:55], v43 offset:17408
    v_lshl_add_u32 v132, v18, 2, v22
    v_mul_u32_u24 v2, 40, v132
    v_add_u32 v2, 70656, v2
    v_mul_u32_u24 v3, 40, v22
    v_add_u32 v3, 71296, v3
    s_waitcnt lgkmcnt(6)
    v_mfma_f32_32x32x16_bf16 v[64:79], v[56:59], v[172:175], v[64:79]
    ds_read_b64_tr_b16 v[56:57], v42 offset:20480
    ds_read_b64_tr_b16 v[58:59], v42 offset:21504
    v_bfe_u32 v133, v1, 4, 1
    v_lshlrev_b32 v4, 4, v133
    v_and_b32 v5, 2, v1
    v_lshl_add_u32 v4, v5, 2, v4
    v_add_u32 v5, v4, v3
    s_waitcnt lgkmcnt(6)
    v_mfma_f32_32x32x16_bf16 v[80:95], v[60:63], v[172:175], v[80:95]
    ds_read_b64_tr_b16 v[60:61], v43 offset:20480
    ds_read_b64_tr_b16 v[62:63], v43 offset:21504
    v_add_u32 v4, v4, v2
    s_mul_i32 s44, s34, 5120
    s_add_u32 s44, s44, 81920
    v_mul_u32_u24 v6, 80, v19
    v_mul_u32_u24 v134, 40, v18
    s_waitcnt lgkmcnt(6)
    v_mfma_f32_32x32x16_bf16 v[64:79], v[48:51], v[176:179], v[64:79]
    ds_read_b64_tr_b16 v[48:49], v42 offset:24576
    ds_read_b64_tr_b16 v[50:51], v42 offset:25600
    v_add3_u32 v6, v6, v134, s44
    v_mul_u32_u24 v132, 80, v132
    v_mov_b32 v7, 0x30082800
    v_mov_b32 v134, 0x40183810
    v_cndmask_b32 v7, v7, v134, s[48:49]
    s_waitcnt lgkmcnt(6)
    v_mfma_f32_32x32x16_bf16 v[80:95], v[52:55], v[176:179], v[80:95]
    ds_read_b64_tr_b16 v[52:53], v43 offset:24576
    ds_read_b64_tr_b16 v[54:55], v43 offset:25600
    v_bfe_u32 v7, v7, v21, 8
    v_add3_u32 v7, v7, v132, s44
    v_mov_b32 v8, 0x48204820
    v_mov_b32 v134, 0x48204820
    v_cndmask_b32 v8, v8, v134, s[48:49]
    s_waitcnt lgkmcnt(6)
    v_mfma_f32_32x32x16_bf16 v[64:79], v[56:59], v[180:183], v[64:79]
    ds_read_b64_tr_b16 v[56:57], v42 offset:28672
    ds_read_b64_tr_b16 v[58:59], v42 offset:29696
    v_bfe_u32 v8, v8, v21, 8
    v_add3_u32 v8, v8, v132, s44
    v_add_u32 v9, s44, v20
    s_mul_i32 s44, s34, 640
    v_add_u32 v10, s44, v20
    s_waitcnt lgkmcnt(6)
    v_mfma_f32_32x32x16_bf16 v[80:95], v[60:63], v[180:183], v[80:95]
    ds_read_b64_tr_b16 v[60:61], v43 offset:28672
    ds_read_b64_tr_b16 v[62:63], v43 offset:29696
    v_add_u32 v11, 81920, v10
    v_lshrrev_b32 v12, 1, v10
    v_add_u32 v12, 67584, v12
    v_add_u32 v13, 67584, v117
    v_mul_u32_u24 v14, 40960, v133
    s_waitcnt vmcnt(0)
    s_barrier
    s_waitcnt lgkmcnt(6)
    v_mfma_f32_32x32x16_bf16 v[64:79], v[48:51], v[184:187], v[64:79]
    ds_read_b64_tr_b16 v[48:49], v42 offset:32768
    ds_read_b64_tr_b16 v[50:51], v42 offset:33792
    v_and_b32 v134, 15, v1
    v_lshl_add_u32 v15, v134, 4, v14
    v_lshl_add_u32 v15, v18, 8, v15
    v_lshl_add_u32 v14, v134, 3, v14
    v_and_b32 v16, 4, v1
    s_waitcnt lgkmcnt(6)
    v_mfma_f32_32x32x16_bf16 v[80:95], v[52:55], v[184:187], v[80:95]
    ds_read_b64_tr_b16 v[52:53], v43 offset:32768
    ds_read_b64_tr_b16 v[54:55], v43 offset:33792
    v_mul_u32_u24 v16, 0x2000, v16
    v_lshl_or_b32 v16, v16, 16, v16
    v_and_b32 v17, 7, v1
    v_lshlrev_b32 v17, 3, v17
    v_mul_u32_u24 v128, 640, v18
    s_waitcnt lgkmcnt(6)
    v_mfma_f32_32x32x16_bf16 v[64:79], v[56:59], v[188:191], v[64:79]
    ds_read_b64_tr_b16 v[56:57], v42 offset:36864
    ds_read_b64_tr_b16 v[58:59], v42 offset:37888
    v_lshl_add_u32 v128, v133, 8, v128
    v_lshl_add_u32 v128, v134, 4, v128
    v_lshrrev_b32 v135, 4, v1
    v_mul_u32_u24 v129, 640, v135
    v_lshl_add_u32 v129, v134, 3, v129
    s_waitcnt lgkmcnt(6)
    v_mfma_f32_32x32x16_bf16 v[80:95], v[60:63], v[188:191], v[80:95]
    ds_read_b64_tr_b16 v[60:61], v43 offset:36864
    ds_read_b64_tr_b16 v[62:63], v43 offset:37888
    v_mul_u32_u24 v131, 1280, v134
    v_lshl_add_u32 v131, v135, 3, v131
    v_mul_u32_u24 v132, 26, v1
    v_lshrrev_b32 v132, 8, v132
    v_mul_u32_u24 v133, 10, v132
    s_waitcnt lgkmcnt(6)
    v_mfma_f32_32x32x16_bf16 v[64:79], v[48:51], v[192:195], v[64:79]
    ds_read_b64_tr_b16 v[48:49], v42 offset:40960
    ds_read_b64_tr_b16 v[50:51], v42 offset:41984
    v_sub_u32 v133, v1, v133
    v_mul_u32_u24 v119, 1280, v132
    v_lshl_add_u32 v119, v133, 4, v119
    v_add_u32 v134, 409520, v119
    v_cmp_lt_u32 vcc, 4, v133
    s_waitcnt lgkmcnt(6)
    v_mfma_f32_32x32x16_bf16 v[80:95], v[52:55], v[192:195], v[80:95]
    ds_read_b64_tr_b16 v[52:53], v43 offset:40960
    ds_read_b64_tr_b16 v[54:55], v43 offset:41984
    v_mov_b32 v0, 0
    s_nop 0
    v_cndmask_b32 v119, v119, v134, vcc
    v_add_u32 v116, 9600, v119
    s_lshl_b32 s91, s35, 2
    s_waitcnt lgkmcnt(6)
    v_mfma_f32_32x32x16_bf16 v[64:79], v[56:59], v[196:199], v[64:79]
    ds_read_b64_tr_b16 v[56:57], v42 offset:45056
    ds_read_b64_tr_b16 v[58:59], v42 offset:46080
    s_and_b32 s44, s34, 3
    s_add_u32 s91, s91, s44
    s_lshl_b32 s91, s91, 4
    s_add_u32 s91, s91, s36
    s_lshl_b32 s91, s91, 1
    s_waitcnt lgkmcnt(6)
    v_mfma_f32_32x32x16_bf16 v[80:95], v[60:63], v[196:199], v[80:95]
    ds_read_b64_tr_b16 v[60:61], v43 offset:45056
    ds_read_b64_tr_b16 v[62:63], v43 offset:46080
    s_lshr_b32 s44, s34, 2
    s_add_u32 s91, s91, s44
    s_lshl_b32 s91, s91, 3
    s_add_u32 s91, s91, 15826944
    s_add_u32 s92, s87, 66560
    buffer_load_dwordx2 v[26:27], v30, s[24:27], s61 offen offset:0 sc1
    buffer_load_dwordx2 v[28:29], v31, s[24:27], s61 offen offset:0 sc1
    s_waitcnt lgkmcnt(6)
    v_mfma_f32_32x32x16_bf16 v[64:79], v[48:51], v[200:203], v[64:79]
    ds_read_b64_tr_b16 v[48:49], v42 offset:49152
    ds_read_b64_tr_b16 v[50:51], v42 offset:50176
    s_mul_i32 s44, s32, 20
    s_add_u32 s45, s44, 19
    s_lshr_b32 s44, s44, 6
    s_lshr_b32 s45, s45, 6
    s_lshl_b32 s44, 0x100401, s44
    s_waitcnt lgkmcnt(6)
    v_mfma_f32_32x32x16_bf16 v[80:95], v[52:55], v[200:203], v[80:95]
    ds_read_b64_tr_b16 v[52:53], v43 offset:49152
    ds_read_b64_tr_b16 v[54:55], v43 offset:50176
    s_lshl_b32 s45, 0x100401, s45
    s_or_b32 s37, s44, s45
    s_waitcnt lgkmcnt(6)
    v_mfma_f32_32x32x16_bf16 v[64:79], v[56:59], v[204:207], v[64:79]
    ds_read_b64_tr_b16 v[56:57], v42 offset:53248
    ds_read_b64_tr_b16 v[58:59], v42 offset:54272
    s_waitcnt lgkmcnt(6)
    v_mfma_f32_32x32x16_bf16 v[80:95], v[60:63], v[204:207], v[80:95]
    ds_read_b64_tr_b16 v[60:61], v43 offset:53248
    ds_read_b64_tr_b16 v[62:63], v43 offset:54272
    s_waitcnt lgkmcnt(6)
    v_mfma_f32_32x32x16_bf16 v[64:79], v[48:51], v[208:211], v[64:79]
    ds_read_b64_tr_b16 v[48:49], v42 offset:57344
    ds_read_b64_tr_b16 v[50:51], v42 offset:58368
    s_waitcnt lgkmcnt(6)
    v_mfma_f32_32x32x16_bf16 v[80:95], v[52:55], v[208:211], v[80:95]
    ds_read_b64_tr_b16 v[52:53], v43 offset:57344
    ds_read_b64_tr_b16 v[54:55], v43 offset:58368
    s_waitcnt lgkmcnt(6)
    v_mfma_f32_32x32x16_bf16 v[64:79], v[56:59], v[212:215], v[64:79]
    ds_read_b64_tr_b16 v[56:57], v42 offset:61440
    ds_read_b64_tr_b16 v[58:59], v42 offset:62464
    s_waitcnt lgkmcnt(6)
    v_mfma_f32_32x32x16_bf16 v[80:95], v[60:63], v[212:215], v[80:95]
    ds_read_b64_tr_b16 v[60:61], v43 offset:61440
    ds_read_b64_tr_b16 v[62:63], v43 offset:62464
    s_waitcnt lgkmcnt(6)
    v_mfma_f32_32x32x16_bf16 v[64:79], v[48:51], v[216:219], v[64:79]
    ds_read_b64_tr_b16 v[48:49], v44 offset:0
    ds_read_b64_tr_b16 v[50:51], v44 offset:1024
    s_waitcnt lgkmcnt(6)
    v_mfma_f32_32x32x16_bf16 v[80:95], v[52:55], v[216:219], v[80:95]
    ds_read_b64_tr_b16 v[52:53], v45 offset:0
    ds_read_b64_tr_b16 v[54:55], v45 offset:1024
    s_mov_b64 exec, 0xff
    ds_write_b128 v120, v[122:125]
    ds_write_b128 v120, v[152:155] offset:16
    s_mov_b64 exec, -1
L_ck_ask:
    s_waitcnt vmcnt(1)
    v_cmp_ne_u64 vcc, v[26:27], v[24:25]
    s_waitcnt vmcnt(0)
    v_cmp_ne_u64 s[66:67], v[28:29], v[24:25]
    s_nop 2
    s_or_b32 s42, vcc_lo, vcc_hi
    s_and_b32 s42, s42, 0x03030303
    s_and_b32 s43, s66, s86
    s_or_b32 s42, s42, s43
    s_cmp_eq_u32 s42, 0
    s_cbranch_scc0 L_sl_ask
L_ok_ask:
    s_waitcnt lgkmcnt(8)
    v_mfma_f32_32x32x16_bf16 v[64:79], v[56:59], v[220:223], v[64:79]
    ds_read_b64_tr_b16 v[56:57], v44 offset:4096
    ds_read_b64_tr_b16 v[58:59], v44 offset:5120
    s_add_u32 m0, s88, 0
    s_add_u32 s58, s57, 0
    buffer_load_dwordx4 v112, s[24:27], s58 offen sc1 lds
    v_mov_b32 v184, v146
    v_mov_b32 v185, v146
    v_mov_b32 v186, v146
    v_mov_b32 v187, v146
    v_mov_b32 v188, v146
    s_waitcnt lgkmcnt(8)
    v_mfma_f32_32x32x16_bf16 v[80:95], v[60:63], v[220:223], v[80:95]
    ds_read_b64_tr_b16 v[60:61], v45 offset:4096
    ds_read_b64_tr_b16 v[62:63], v45 offset:5120
    s_add_u32 m0, s89, 0
    s_nop 0
    buffer_load_dwordx4 v113, s[24:27], s58 offen sc1 lds
    v_mov_b32 v189, v146
    v_mov_b32 v190, v146
    v_mov_b32 v191, v146
    s_waitcnt lgkmcnt(8)
    v_mfma_f32_32x32x16_bf16 v[64:79], v[48:51], v[224:227], v[64:79]
    ds_read_b64_tr_b16 v[48:49], v44 offset:8192
    ds_read_b64_tr_b16 v[50:51], v44 offset:9216
    s_add_u32 m0, s90, 0
    s_nop 0
    buffer_load_dwordx4 v114, s[24:27], s58 offen sc1 lds
    s_waitcnt lgkmcnt(8)
    v_mfma_f32_32x32x16_bf16 v[80:95], v[52:55], v[224:227], v[80:95]
    ds_read_b64_tr_b16 v[52:53], v45 offset:8192
    ds_read_b64_tr_b16 v[54:55], v45 offset:9216
    buffer_load_dwordx2 v[96:97], v117, s[24:27], s84 offen sc1
    buffer_load_dwordx2 v[98:99], v117, s[24:27], s84 offen offset:512 sc1
    s_waitcnt lgkmcnt(6)
    v_mfma_f32_32x32x16_bf16 v[64:79], v[56:59], v[228:231], v[64:79]
    ds_read_b64_tr_b16 v[56:57], v44 offset:12288
    ds_read_b64_tr_b16 v[58:59], v44 offset:13312
    buffer_load_dwordx2 v[100:101], v118, s[24:27], s84 offen sc1
    s_waitcnt lgkmcnt(6)
    v_mfma_f32_32x32x16_bf16 v[80:95], v[60:63], v[228:231], v[80:95]
    ds_read_b64_tr_b16 v[60:61], v45 offset:12288
    ds_read_b64_tr_b16 v[62:63], v45 offset:13312
    buffer_load_dwordx2 v[102:103], v117, s[24:27], s85 offen sc1
    buffer_load_dwordx2 v[104:105], v117, s[24:27], s85 offen offset:512 sc1
    s_waitcnt lgkmcnt(6)
    v_mfma_f32_32x32x16_bf16 v[64:79], v[48:51], v[232:235], v[64:79]
    ds_read_b64_tr_b16 v[48:49], v44 offset:16384
    ds_read_b64_tr_b16 v[50:51], v44 offset:17408
    buffer_load_dwordx2 v[106:107], v118, s[24:27], s85 offen sc1
    s_waitcnt lgkmcnt(6)
    v_mfma_f32_32x32x16_bf16 v[80:95], v[52:55], v[232:235], v[80:95]
    ds_read_b64_tr_b16 v[52:53], v45 offset:16384
    ds_read_b64_tr_b16 v[54:55], v45 offset:17408
    s_add_u32 m0, s88, 22528
    s_add_u32 s58, s57, 81920
    buffer_load_dwordx4 v112, s[24:27], s58 offen sc1 lds
    s_waitcnt lgkmcnt(6)
    v_mfma_f32_32x32x16_bf16 v[64:79], v[56:59], v[236:239], v[64:79]
    ds_read_b64_tr_b16 v[56:57], v44 offset:20480
    ds_read_b64_tr_b16 v[58:59], v44 offset:21504
    s_add_u32 m0, s89, 22528
    s_nop 0
    buffer_load_dwordx4 v113, s[24:27], s58 offen sc1 lds
    s_waitcnt lgkmcnt(6)
    v_mfma_f32_32x32x16_bf16 v[80:95], v[60:63], v[236:239], v[80:95]
    ds_read_b64_tr_b16 v[60:61], v45 offset:20480
    ds_read_b64_tr_b16 v[62:63], v45 offset:21504
    s_add_u32 m0, s90, 22528
    s_nop 0
    buffer_load_dwordx4 v114, s[24:27], s58 offen sc1 lds
    s_waitcnt lgkmcnt(6)
    v_mfma_f32_32x32x16_bf16 v[64:79], v[48:51], v[240:243], v[64:79]
    ds_read_b64_tr_b16 v[48:49], v44 offset:24576
    ds_read_b64_tr_b16 v[50:51], v44 offset:25600
    buffer_load_dwordx2 v[26:27], v30, s[24:27], s61 offen sc1
    s_waitcnt lgkmcnt(6)
    v_mfma_f32_32x32x16_bf16 v[80:95], v[52:55], v[240:243], v[80:95]
    ds_read_b64_tr_b16 v[52:53], v45 offset:24576
    ds_read_b64_tr_b16 v[54:55], v45 offset:25600
    s_waitcnt lgkmcnt(6)
    v_mfma_f32_32x32x16_bf16 v[64:79], v[56:59], v[244:247], v[64:79]
    ds_read_b64_tr_b16 v[56:57], v44 offset:28672
    ds_read_b64_tr_b16 v[58:59], v44 offset:29696
    s_waitcnt lgkmcnt(6)
    v_mfma_f32_32x32x16_bf16 v[80:95], v[60:63], v[244:247], v[80:95]
    ds_read_b64_tr_b16 v[60:61], v45 offset:28672
    ds_read_b64_tr_b16 v[62:63], v45 offset:29696
    s_waitcnt lgkmcnt(6)
    v_mfma_f32_32x32x16_bf16 v[64:79], v[48:51], v[248:251], v[64:79]
    s_waitcnt lgkmcnt(4)
    v_mfma_f32_32x32x16_bf16 v[80:95], v[52:55], v[248:251], v[80:95]
    s_waitcnt lgkmcnt(2)
    v_mfma_f32_32x32x16_bf16 v[64:79], v[56:59], v[252:255], v[64:79]
    s_waitcnt lgkmcnt(0)
    v_mfma_f32_32x32x16_bf16 v[80:95], v[60:63], v[252:255], v[80:95]
    s_nop 10
    v_cvt_pk_bf16_f32 v40, v64, v65
    v_cvt_pk_bf16_f32 v41, v66, v67
    v_cvt_pk_bf16_f32 v42, v68, v69
    v_cvt_pk_bf16_f32 v43, v70, v71
    v_cvt_pk_bf16_f32 v44, v72, v73
    v_cvt_pk_bf16_f32 v45, v74, v75
    v_cvt_pk_bf16_f32 v46, v76, v77
    v_cvt_pk_bf16_f32 v47, v78, v79
    v_cvt_pk_bf16_f32 v48, v80, v81
    v_cvt_pk_bf16_f32 v49, v82, v83
    v_cvt_pk_bf16_f32 v50, v84, v85
    v_cvt_pk_bf16_f32 v51, v86, v87
    v_cvt_pk_bf16_f32 v52, v88, v89
    v_cvt_pk_bf16_f32 v53, v90, v91
    v_cvt_pk_bf16_f32 v54, v92, v93
    v_cvt_pk_bf16_f32 v55, v94, v95
    s_mov_b32 s65, 0
    s_mov_b64 s[38:39], -1
    s_mov_b64 s[46:47], 0
    s_waitcnt vmcnt(0) lgkmcnt(0)
L_common:
    s_barrier
    ds_read2st64_b64 v[140:143], v117 offset0:0 offset1:1
    ds_read_b64 v[144:145], v118
    v_cndmask_b32 v100, v100, 0, s[50:51]
    v_cndmask_b32 v101, v101, 0, s[50:51]
    v_cndmask_b32 v106, v106, 0, s[50:51]
    v_cndmask_b32 v107, v107, 0, s[50:51]
    s_mov_b64 exec, 0xf00
    ds_write_b128 v120, v[122:125]
    ds_write_b128 v120, v[152:155] offset:16
    s_mov_b64 exec, -1
    s_mov_b32 m0, 70656
    s_waitcnt lgkmcnt(3)
    v_mfma_f32_32x32x16_bf16 v[64:79], v[140:143], v[96:99], 0
    v_mfma_f32_32x32x16_bf16 v[80:95], v[140:143], v[102:105], 0
    s_waitcnt lgkmcnt(2)
    v_mfma_f32_32x32x8_bf16 v[64:79], v[144:145], v[100:101], v[64:79]
    v_mfma_f32_32x32x8_bf16 v[80:95], v[144:145], v[106:107], v[80:95]
    buffer_load_dwordx4 v20, s[16:19], s55 offen lds
L_ck_b0:
    v_cmp_ne_u64 vcc, v[26:27], v[24:25]
    s_nop 3
    s_or_b32 s42, vcc_lo, vcc_hi
    s_and_b32 s42, s42, 0x000c000c
    s_cmp_eq_u32 s42, 0
    s_cbranch_scc0 L_sl_b0
L_ok_b0:
    s_add_u32 m0, s88, 45056
    s_add_u32 s58, s57, 20480
    buffer_load_dwordx4 v112, s[24:27], s58 offen sc1 lds
    s_add_u32 m0, s89, 45056
    s_nop 0
    buffer_load_dwordx4 v113, s[24:27], s58 offen sc1 lds
    s_add_u32 m0, s90, 45056
    s_nop 0
    buffer_load_dwordx4 v114, s[24:27], s58 offen sc1 lds
    v_max3_f32 v156, v64, v65, v66
    v_max3_f32 v156, v156, v67, v68
    v_max3_f32 v156, v156, v69, v70
    v_max3_f32 v156, v156, v71, v72
    v_max3_f32 v156, v156, v73, v74
    v_max3_f32 v156, v156, v75, v76
    v_max3_f32 v156, v156, v77, v78
    v_max_f32 v156, v156, v79
    v_max3_f32 v157, v80, v81, v82
    v_max3_f32 v157, v157, v83, v84
    v_max3_f32 v157, v157, v85, v86
    v_max3_f32 v157, v157, v87, v88
    v_max3_f32 v157, v157, v89, v90
    v_max3_f32 v157, v157, v91, v92
    v_max3_f32 v157, v157, v93, v94
    v_max_f32 v157, v157, v95
    ds_read2st64_b64 v[140:143], v108 offset0:0 offset1:1
    ds_read_b64 v[144:145], v109
    ds_read_b128 v[148:151], v110
    v_mov_b32 v158, v156
    s_waitcnt lgkmcnt(2)
    v_mfma_f32_32x32x16_bf16 v[64:79], v[140:143], v[96:99], 0
    s_nop 0
    v_permlane32_swap_b32 v156, v158
    v_max_f32 v156, v156, v158
    v_sub_f32 v156, 0, v156
    v_and_b32 v158, 0xffff0000, v156
    v_sub_f32 v156, v156, v158
    v_and_b32 v159, 0xffff0000, v156
    v_sub_f32 v156, v156, v159
    v_lshrrev_b32 v158, 16, v158
    v_or_b32 v158, v158, v159
    v_lshrrev_b32 v156, 16, v156
    v_cndmask_b32 v100, v100, v158, s[50:51]
    v_cndmask_b32 v101, v101, v156, s[50:51]
    v_mov_b32 v170, v157
    s_waitcnt lgkmcnt(1)
    v_mfma_f32_32x32x8_bf16 v[64:79], v[144:145], v[100:101], v[64:79]
    v_permlane32_swap_b32 v157, v170
    v_max_f32 v157, v157, v170
    v_sub_f32 v157, 0, v157
    v_and_b32 v170, 0xffff0000, v157
    v_sub_f32 v157, v157, v170
    v_and_b32 v171, 0xffff0000, v157
    v_sub_f32 v157, v157, v171
    v_lshrrev_b32 v170, 16, v170
    v_or_b32 v170, v170, v171
    v_lshrrev_b32 v157, 16, v157
    v_cndmask_b32 v106, v106, v170, s[50:51]
    v_cndmask_b32 v107, v107, v157, s[50:51]
    s_setprio 3
    v_mfma_f32_32x32x16_bf16 v[80:95], v[140:143], v[102:105], 0
    ds_read2st64_b64 v[140:143], v108 offset0:11 offset1:12
    v_exp_f32 v64, v64
    v_exp_f32 v65, v65
    v_exp_f32 v66, v66
    v_exp_f32 v67, v67
    v_cvt_pk_bf16_f32 v132, v64, v65
    v_cvt_pk_bf16_f32 v133, v66, v67
    ds_read_b128 v[152:155], v111 offset:0
    v_exp_f32 v68, v68
    v_exp_f32 v69, v69
    v_exp_f32 v70, v70
    v_exp_f32 v71, v71
    v_cvt_pk_bf16_f32 v134, v68, v69
    v_cvt_pk_bf16_f32 v135, v70, v71
    v_mfma_f32_32x32x8_bf16 v[80:95], v[144:145], v[106:107], v[80:95]
    ds_read_b64 v[144:145], v109 offset:5632
    s_cmp_eq_u32 s38, 0
    s_cbranch_scc1 L_av0
    buffer_store_dwordx2 v[40:41], v32, s[24:27], s64 offen sc1
    buffer_store_dwordx2 v[42:43], v33, s[24:27], s64 offen sc1
    L_ar0:
    v_exp_f32 v72, v72
    v_exp_f32 v73, v73
    v_exp_f32 v74, v74
    v_exp_f32 v75, v75
    v_cvt_pk_bf16_f32 v136, v72, v73
    v_cvt_pk_bf16_f32 v137, v74, v75
    s_waitcnt lgkmcnt(3)
    v_mfma_f32_32x32x16_bf16 v[224:239], v[148:151], v[132:135], 0
    v_exp_f32 v76, v76
    v_exp_f32 v77, v77
    v_exp_f32 v78, v78
    v_exp_f32 v79, v79
    v_cvt_pk_bf16_f32 v138, v76, v77
    v_cvt_pk_bf16_f32 v139, v78, v79
    s_waitcnt lgkmcnt(0)
    v_mfma_f32_32x32x16_bf16 v[64:79], v[140:143], v[96:99], 0
    v_exp_f32 v80, v80
    v_exp_f32 v81, v81
    v_exp_f32 v82, v82
    v_exp_f32 v83, v83
    v_cvt_pk_bf16_f32 v132, v80, v81
    v_cvt_pk_bf16_f32 v133, v82, v83
    v_mfma_f32_32x32x16_bf16 v[224:239], v[152:155], v[136:139], v[224:239]
    v_exp_f32 v84, v84
    v_exp_f32 v85, v85
    v_exp_f32 v86, v86
    v_exp_f32 v87, v87
    v_cvt_pk_bf16_f32 v134, v84, v85
    v_cvt_pk_bf16_f32 v135, v86, v87
    v_mfma_f32_32x32x8_bf16 v[64:79], v[144:145], v[100:101], v[64:79]
    s_cmp_eq_u32 s38, 0
    s_cbranch_scc1 L_av1
    buffer_store_dwordx2 v[44:45], v34, s[24:27], s64 offen sc1
    buffer_store_dwordx2 v[46:47], v35, s[24:27], s64 offen sc1
    L_ar1:
    v_exp_f32 v88, v88
    v_exp_f32 v89, v89
    v_exp_f32 v90, v90
    v_exp_f32 v91, v91
    v_cvt_pk_bf16_f32 v136, v88, v89
    v_cvt_pk_bf16_f32 v137, v90, v91
    v_mfma_f32_32x32x16_bf16 v[240:255], v[148:151], v[132:135], 0
    ds_read_b128 v[148:151], v110 offset:5632
    v_exp_f32 v92, v92
    v_exp_f32 v93, v93
    v_exp_f32 v94, v94
    v_exp_f32 v95, v95
    v_cvt_pk_bf16_f32 v138, v92, v93
    v_cvt_pk_bf16_f32 v139, v94, v95
    v_mfma_f32_32x32x16_bf16 v[80:95], v[140:143], v[102:105], 0
    ds_read2st64_b64 v[140:143], v108 offset0:22 offset1:23
    v_exp_f32 v64, v64
    v_exp_f32 v65, v65
    v_exp_f32 v66, v66
    v_exp_f32 v67, v67
    v_cvt_pk_bf16_f32 v132, v64, v65
    v_cvt_pk_bf16_f32 v133, v66, v67
    v_mfma_f32_32x32x16_bf16 v[240:255], v[152:155], v[136:139], v[240:255]
    ds_read_b128 v[152:155], v111 offset:5632
    v_exp_f32 v68, v68
    v_exp_f32 v69, v69
    v_exp_f32 v70, v70
    v_exp_f32 v71, v71
    v_cvt_pk_bf16_f32 v134, v68, v69
    v_cvt_pk_bf16_f32 v135, v70, v71
    v_mfma_f32_32x32x8_bf16 v[80:95], v[144:145], v[106:107], v[80:95]
    ds_read_b64 v[144:145], v109 offset:11264
    s_cmp_eq_u32 s38, 0
    s_cbranch_scc1 L_av2
    buffer_store_dwordx2 v[48:49], v36, s[24:27], s64 offen sc1
    buffer_store_dwordx2 v[50:51], v37, s[24:27], s64 offen sc1
    L_ar2:
    v_exp_f32 v72, v72
    v_exp_f32 v73, v73
    v_exp_f32 v74, v74
    v_exp_f32 v75, v75
    v_cvt_pk_bf16_f32 v136, v72, v73
    v_cvt_pk_bf16_f32 v137, v74, v75
    s_waitcnt lgkmcnt(3)
    v_mfma_f32_32x32x16_bf16 v[224:239], v[148:151], v[132:135], v[224:239]
    v_exp_f32 v76, v76
    v_exp_f32 v77, v77
    v_exp_f32 v78, v78
    v_exp_f32 v79, v79
    v_cvt_pk_bf16_f32 v138, v76, v77
    v_cvt_pk_bf16_f32 v139, v78, v79
    s_waitcnt lgkmcnt(0)
    s_setprio 2
    v_mfma_f32_32x32x16_bf16 v[64:79], v[140:143], v[96:99], 0
    v_exp_f32 v80, v80
    v_exp_f32 v81, v81
    v_exp_f32 v82, v82
    v_exp_f32 v83, v83
    v_cvt_pk_bf16_f32 v132, v80, v81
    v_cvt_pk_bf16_f32 v133, v82, v83
    v_mfma_f32_32x32x16_bf16 v[224:239], v[152:155], v[136:139], v[224:239]
    v_exp_f32 v84, v84
    v_exp_f32 v85, v85
    v_exp_f32 v86, v86
    v_exp_f32 v87, v87
    v_cvt_pk_bf16_f32 v134, v84, v85
    v_cvt_pk_bf16_f32 v135, v86, v87
    v_mfma_f32_32x32x8_bf16 v[64:79], v[144:145], v[100:101], v[64:79]
    s_cmp_eq_u32 s38, 0
    s_cbranch_scc1 L_av3
    buffer_store_dwordx2 v[52:53], v38, s[24:27], s64 offen sc1
    buffer_store_dwordx2 v[54:55], v39, s[24:27], s64 offen sc1
    L_ar3:
    v_exp_f32 v88, v88
    v_exp_f32 v89, v89
    v_exp_f32 v90, v90
    v_exp_f32 v91, v91
    v_cvt_pk_bf16_f32 v136, v88, v89
    v_cvt_pk_bf16_f32 v137, v90, v91
    v_mfma_f32_32x32x16_bf16 v[240:255], v[148:151], v[132:135], v[240:255]
    ds_read_b128 v[148:151], v110 offset:11264
    v_exp_f32 v92, v92
    v_exp_f32 v93, v93
    v_exp_f32 v94, v94
    v_exp_f32 v95, v95
    v_cvt_pk_bf16_f32 v138, v92, v93
    v_cvt_pk_bf16_f32 v139, v94, v95
    v_mfma_f32_32x32x16_bf16 v[80:95], v[140:143], v[102:105], 0
    ds_read2st64_b64 v[140:143], v108 offset0:33 offset1:34
    v_exp_f32 v64, v64
    v_exp_f32 v65, v65
    v_exp_f32 v66, v66
    v_exp_f32 v67, v67
    v_cvt_pk_bf16_f32 v132, v64, v65
    v_cvt_pk_bf16_f32 v133, v66, v67
    v_mov_b32 v204, -1
    v_mov_b32 v205, -1
    v_mov_b32 v206, -1
    v_mov_b32 v207, -1
    s_add_u32 s44, s98, 20480
    v_mfma_f32_32x32x16_bf16 v[240:255], v[152:155], v[136:139], v[240:255]
    ds_read_b128 v[152:155], v111 offset:11264
    v_exp_f32 v68, v68
    v_exp_f32 v69, v69
    v_exp_f32 v70, v70
    v_exp_f32 v71, v71
    v_cvt_pk_bf16_f32 v134, v68, v69
    v_cvt_pk_bf16_f32 v135, v70, v71
    v_mfma_f32_32x32x8_bf16 v[80:95], v[144:145], v[106:107], v[80:95]
    ds_read_b64 v[144:145], v109 offset:16896
    buffer_store_dwordx4 v[204:207], v15, s[24:27], s98 offen sc1
    buffer_store_dwordx4 v[204:207], v15, s[24:27], s44 offen sc1
    v_exp_f32 v72, v72
    v_exp_f32 v73, v73
    v_exp_f32 v74, v74
    v_exp_f32 v75, v75
    v_cvt_pk_bf16_f32 v136, v72, v73
    v_cvt_pk_bf16_f32 v137, v74, v75
    s_waitcnt lgkmcnt(3)
    v_mfma_f32_32x32x16_bf16 v[224:239], v[148:151], v[132:135], v[224:239]
    v_exp_f32 v76, v76
    v_exp_f32 v77, v77
    v_exp_f32 v78, v78
    v_exp_f32 v79, v79
    v_cvt_pk_bf16_f32 v138, v76, v77
    v_cvt_pk_bf16_f32 v139, v78, v79
    s_waitcnt lgkmcnt(0)
    s_setprio 1
    v_mfma_f32_32x32x16_bf16 v[64:79], v[140:143], v[96:99], 0
    v_exp_f32 v80, v80
    v_exp_f32 v81, v81
    v_exp_f32 v82, v82
    v_exp_f32 v83, v83
    v_cvt_pk_bf16_f32 v132, v80, v81
    v_cvt_pk_bf16_f32 v133, v82, v83
    v_mfma_f32_32x32x16_bf16 v[224:239], v[152:155], v[136:139], v[224:239]
    v_exp_f32 v84, v84
    v_exp_f32 v85, v85
    v_exp_f32 v86, v86
    v_exp_f32 v87, v87
    v_cvt_pk_bf16_f32 v134, v84, v85
    v_cvt_pk_bf16_f32 v135, v86, v87
    v_mfma_f32_32x32x8_bf16 v[64:79], v[144:145], v[100:101], v[64:79]
    s_mov_b32 exec_hi, 0
    buffer_store_dwordx2 v[204:205], v14, s[24:27], s98 offen offset:512 sc1
    buffer_store_dwordx2 v[204:205], v14, s[24:27], s44 offen offset:512 sc1
    s_mov_b32 exec_hi, 0xff
    buffer_store_dwordx4 v[204:207], v10, s[24:27], s93 offen sc1
    s_mov_b32 exec_hi, -1
    v_exp_f32 v88, v88
    v_exp_f32 v89, v89
    v_exp_f32 v90, v90
    v_exp_f32 v91, v91
    v_cvt_pk_bf16_f32 v136, v88, v89
    v_cvt_pk_bf16_f32 v137, v90, v91
    v_mfma_f32_32x32x16_bf16 v[240:255], v[148:151], v[132:135], v[240:255]
    ds_read_b128 v[148:151], v110 offset:16896
    v_exp_f32 v92, v92
    v_exp_f32 v93, v93
    v_exp_f32 v94, v94
    v_exp_f32 v95, v95
    v_cvt_pk_bf16_f32 v138, v92, v93
    v_cvt_pk_bf16_f32 v139, v94, v95
    v_mfma_f32_32x32x16_bf16 v[80:95], v[140:143], v[102:105], 0
    ds_read2st64_b64 v[140:143], v108 offset0:44 offset1:45
    v_exp_f32 v64, v64
    v_exp_f32 v65, v65
    v_exp_f32 v66, v66
    v_exp_f32 v67, v67
    v_cvt_pk_bf16_f32 v132, v64, v65
    v_cvt_pk_bf16_f32 v133, v66, v67
    v_mfma_f32_32x32x16_bf16 v[240:255], v[152:155], v[136:139], v[240:255]
    ds_read_b128 v[152:155], v111 offset:16896
    v_exp_f32 v68, v68
    v_exp_f32 v69, v69
    v_exp_f32 v70, v70
    v_exp_f32 v71, v71
    v_cvt_pk_bf16_f32 v134, v68, v69
    v_cvt_pk_bf16_f32 v135, v70, v71
    v_mfma_f32_32x32x8_bf16 v[80:95], v[144:145], v[106:107], v[80:95]
    ds_read_b64 v[144:145], v109 offset:22528
    v_exp_f32 v72, v72
    v_exp_f32 v73, v73
    v_exp_f32 v74, v74
    v_exp_f32 v75, v75
    v_cvt_pk_bf16_f32 v136, v72, v73
    v_cvt_pk_bf16_f32 v137, v74, v75
    s_waitcnt lgkmcnt(3)
    v_mfma_f32_32x32x16_bf16 v[224:239], v[148:151], v[132:135], v[224:239]
    v_exp_f32 v76, v76
    v_exp_f32 v77, v77
    v_exp_f32 v78, v78
    v_exp_f32 v79, v79
    v_cvt_pk_bf16_f32 v138, v76, v77
    v_cvt_pk_bf16_f32 v139, v78, v79
    s_waitcnt lgkmcnt(0)
    v_mfma_f32_32x32x16_bf16 v[64:79], v[140:143], v[96:99], 0
    v_exp_f32 v80, v80
    v_exp_f32 v81, v81
    v_exp_f32 v82, v82
    v_exp_f32 v83, v83
    v_cvt_pk_bf16_f32 v132, v80, v81
    v_cvt_pk_bf16_f32 v133, v82, v83
    v_mfma_f32_32x32x16_bf16 v[224:239], v[152:155], v[136:139], v[224:239]
    buffer_load_dwordx2 v[26:27], v30, s[24:27], s61 offen offset:0 sc1
    buffer_load_dwordx2 v[28:29], v31, s[24:27], s61 offen offset:0 sc1
    v_exp_f32 v84, v84
    v_exp_f32 v85, v85
    v_exp_f32 v86, v86
    v_exp_f32 v87, v87
    v_cvt_pk_bf16_f32 v134, v84, v85
    v_cvt_pk_bf16_f32 v135, v86, v87
    v_mfma_f32_32x32x8_bf16 v[64:79], v[144:145], v[100:101], v[64:79]
    v_exp_f32 v88, v88
    v_exp_f32 v89, v89
    v_exp_f32 v90, v90
    v_exp_f32 v91, v91
    v_cvt_pk_bf16_f32 v136, v88, v89
    v_cvt_pk_bf16_f32 v137, v90, v91
    v_mfma_f32_32x32x16_bf16 v[240:255], v[148:151], v[132:135], v[240:255]
    ds_read_b128 v[148:151], v110 offset:22528
    v_exp_f32 v92, v92
    v_exp_f32 v93, v93
    v_exp_f32 v94, v94
    v_exp_f32 v95, v95
    v_cvt_pk_bf16_f32 v138, v92, v93
    v_cvt_pk_bf16_f32 v139, v94, v95
    s_setprio 0
    v_mfma_f32_32x32x16_bf16 v[80:95], v[140:143], v[102:105], 0
    ds_read2st64_b64 v[140:143], v108 offset0:55 offset1:56
    v_exp_f32 v64, v64
    v_exp_f32 v65, v65
    v_exp_f32 v66, v66
    v_exp_f32 v67, v67
    v_cvt_pk_bf16_f32 v132, v64, v65
    v_cvt_pk_bf16_f32 v133, v66, v67
    v_mfma_f32_32x32x16_bf16 v[240:255], v[152:155], v[136:139], v[240:255]
    ds_read_b128 v[152:155], v111 offset:22528
    v_exp_f32 v68, v68
    v_exp_f32 v69, v69
    v_exp_f32 v70, v70
    v_exp_f32 v71, v71
    v_cvt_pk_bf16_f32 v134, v68, v69
    v_cvt_pk_bf16_f32 v135, v70, v71
    v_mfma_f32_32x32x8_bf16 v[80:95], v[144:145], v[106:107], v[80:95]
    ds_read_b64 v[144:145], v109 offset:28160
    v_exp_f32 v72, v72
    v_exp_f32 v73, v73
    v_exp_f32 v74, v74
    v_exp_f32 v75, v75
    v_cvt_pk_bf16_f32 v136, v72, v73
    v_cvt_pk_bf16_f32 v137, v74, v75
    s_waitcnt lgkmcnt(3)
    v_mfma_f32_32x32x16_bf16 v[224:239], v[148:151], v[132:135], v[224:239]
    s_waitcnt vmcnt(2)
    s_mov_b64 exec, 1
    buffer_store_dwordx2 v[24:25], v0, s[24:27], s91 offen sc1
    buffer_store_dwordx2 v[24:25], v0, s[24:27], s94 offen sc1
    buffer_store_dwordx2 v[24:25], v0, s[24:27], s99 offen sc1
    s_mov_b64 exec, -1
    v_exp_f32 v76, v76
    v_exp_f32 v77, v77
    v_exp_f32 v78, v78
    v_exp_f32 v79, v79
    v_cvt_pk_bf16_f32 v138, v76, v77
    v_cvt_pk_bf16_f32 v139, v78, v79
    s_waitcnt lgkmcnt(0)
    v_mfma_f32_32x32x16_bf16 v[64:79], v[140:143], v[96:99], 0
    v_exp_f32 v80, v80
    v_exp_f32 v81, v81
    v_exp_f32 v82, v82
    v_exp_f32 v83, v83
    v_cvt_pk_bf16_f32 v132, v80, v81
    v_cvt_pk_bf16_f32 v133, v82, v83
    v_mfma_f32_32x32x16_bf16 v[224:239], v[152:155], v[136:139], v[224:239]
    v_exp_f32 v84, v84
    v_exp_f32 v85, v85
    v_exp_f32 v86, v86
    v_exp_f32 v87, v87
    v_cvt_pk_bf16_f32 v134, v84, v85
    v_cvt_pk_bf16_f32 v135, v86, v87
    v_mfma_f32_32x32x8_bf16 v[64:79], v[144:145], v[100:101], v[64:79]
    v_exp_f32 v88, v88
    v_exp_f32 v89, v89
    v_exp_f32 v90, v90
    v_exp_f32 v91, v91
    v_cvt_pk_bf16_f32 v136, v88, v89
    v_cvt_pk_bf16_f32 v137, v90, v91
    v_mfma_f32_32x32x16_bf16 v[240:255], v[148:151], v[132:135], v[240:255]
    ds_read_b128 v[148:151], v110 offset:28160
    v_exp_f32 v92, v92
    v_exp_f32 v93, v93
    v_exp_f32 v94, v94
    v_exp_f32 v95, v95
    v_cvt_pk_bf16_f32 v138, v92, v93
    v_cvt_pk_bf16_f32 v139, v94, v95
    s_waitcnt vmcnt(3) lgkmcnt(0)
    s_barrier
    s_setprio 3
    v_mfma_f32_32x32x16_bf16 v[80:95], v[140:143], v[102:105], 0
    ds_read2st64_b64 v[140:143], v108 offset0:66 offset1:67
    v_exp_f32 v64, v64
    v_exp_f32 v65, v65
    v_exp_f32 v66, v66
    v_exp_f32 v67, v67
    v_cvt_pk_bf16_f32 v132, v64, v65
    v_cvt_pk_bf16_f32 v133, v66, v67
    v_mfma_f32_32x32x16_bf16 v[240:255], v[152:155], v[136:139], v[240:255]
    ds_read_b128 v[152:155], v111 offset:28160
L_ck_b:
    v_cmp_eq_u64 vcc, v[26:27], v[24:25]
    v_cmp_eq_u64 s[66:67], v[28:29], v[24:25]
    s_nop 3
    s_and_b64 vcc, vcc, s[66:67]
    s_cmp_eq_u64 vcc, -1
    s_cbranch_scc0 L_sl_b
L_ok_b:
    buffer_load_dword v18, v118, s[24:27], s87 offen sc1
    v_exp_f32 v68, v68
    v_exp_f32 v69, v69
    v_exp_f32 v70, v70
    v_exp_f32 v71, v71
    v_cvt_pk_bf16_f32 v134, v68, v69
    v_cvt_pk_bf16_f32 v135, v70, v71
    v_mfma_f32_32x32x8_bf16 v[80:95], v[144:145], v[106:107], v[80:95]
    ds_read_b64 v[144:145], v109 offset:33792
    v_exp_f32 v72, v72
    v_exp_f32 v73, v73
    v_exp_f32 v74, v74
    v_exp_f32 v75, v75
    v_cvt_pk_bf16_f32 v136, v72, v73
    v_cvt_pk_bf16_f32 v137, v74, v75
    s_add_u32 m0, s88, 0
    s_add_u32 s58, s57, 102400
    v_mfma_f32_32x32x16_bf16 v[224:239], v[148:151], v[132:135], v[224:239]
    buffer_load_dwordx4 v112, s[24:27], s58 offen sc1 lds
    v_exp_f32 v76, v76
    v_exp_f32 v77, v77
    v_exp_f32 v78, v78
    v_exp_f32 v79, v79
    v_cvt_pk_bf16_f32 v138, v76, v77
    v_cvt_pk_bf16_f32 v139, v78, v79
    s_add_u32 m0, s89, 0
    s_waitcnt lgkmcnt(0)
    v_mfma_f32_32x32x16_bf16 v[64:79], v[140:143], v[96:99], 0
    buffer_load_dwordx4 v113, s[24:27], s58 offen sc1 lds
    v_exp_f32 v80, v80
    v_exp_f32 v81, v81
    v_exp_f32 v82, v82
    v_exp_f32 v83, v83
    v_cvt_pk_bf16_f32 v132, v80, v81
    v_cvt_pk_bf16_f32 v133, v82, v83
    s_add_u32 m0, s90, 0
    v_mfma_f32_32x32x16_bf16 v[224:239], v[152:155], v[136:139], v[224:239]
    buffer_load_dwordx4 v114, s[24:27], s58 offen sc1 lds
    v_exp_f32 v84, v84
    v_exp_f32 v85, v85
    v_exp_f32 v86, v86
    v_exp_f32 v87, v87
    v_cvt_pk_bf16_f32 v134, v84, v85
    v_cvt_pk_bf16_f32 v135, v86, v87
    v_mfma_f32_32x32x8_bf16 v[64:79], v[144:145], v[100:101], v[64:79]
    ds_read_b64_tr_b16 v[192:193], v4
    ds_read_b64_tr_b16 v[194:195], v4 offset:320
    ds_read_b64_tr_b16 v[196:197], v5
    v_exp_f32 v88, v88
    v_exp_f32 v89, v89
    v_exp_f32 v90, v90
    v_exp_f32 v91, v91
    v_cvt_pk_bf16_f32 v136, v88, v89
    v_cvt_pk_bf16_f32 v137, v90, v91
    v_mfma_f32_32x32x16_bf16 v[240:255], v[148:151], v[132:135], v[240:255]
    ds_read_b128 v[148:151], v110 offset:33792
    v_exp_f32 v92, v92
    v_exp_f32 v93, v93
    v_exp_f32 v94, v94
    v_exp_f32 v95, v95
    v_cvt_pk_bf16_f32 v138, v92, v93
    v_cvt_pk_bf16_f32 v139, v94, v95
    v_mfma_f32_32x32x16_bf16 v[80:95], v[140:143], v[102:105], 0
    ds_read2st64_b64 v[140:143], v108 offset0:77 offset1:78
    v_exp_f32 v64, v64
    v_exp_f32 v65, v65
    v_exp_f32 v66, v66
    v_exp_f32 v67, v67
    v_cvt_pk_bf16_f32 v132, v64, v65
    v_cvt_pk_bf16_f32 v133, v66, v67
    v_mfma_f32_32x32x16_bf16 v[240:255], v[152:155], v[136:139], v[240:255]
    ds_read_b128 v[152:155], v111 offset:33792
    v_exp_f32 v68, v68
    v_exp_f32 v69, v69
    v_exp_f32 v70, v70
    v_exp_f32 v71, v71
    v_cvt_pk_bf16_f32 v134, v68, v69
    v_cvt_pk_bf16_f32 v135, v70, v71
    v_mfma_f32_32x32x8_bf16 v[80:95], v[144:145], v[106:107], v[80:95]
    ds_read_b64 v[144:145], v109 offset:39424
    v_exp_f32 v72, v72
    v_exp_f32 v73, v73
    v_exp_f32 v74, v74
    v_exp_f32 v75, v75
    v_cvt_pk_bf16_f32 v136, v72, v73
    v_cvt_pk_bf16_f32 v137, v74, v75
    s_waitcnt lgkmcnt(3)
    v_mfma_f32_32x32x16_bf16 v[224:239], v[148:151], v[132:135], v[224:239]
    ds_read_b64_tr_b16 v[198:199], v2 offset:32
    ds_read_b64_tr_b16 v[200:201], v2 offset:352
    ds_read_b64_tr_b16 v[202:203], v3 offset:32
    v_exp_f32 v76, v76
    v_exp_f32 v77, v77
    v_exp_f32 v78, v78
    v_exp_f32 v79, v79
    v_cvt_pk_bf16_f32 v138, v76, v77
    v_cvt_pk_bf16_f32 v139, v78, v79
    s_waitcnt lgkmcnt(3)
    s_setprio 2
    v_mfma_f32_32x32x16_bf16 v[64:79], v[140:143], v[96:99], 0
    v_exp_f32 v80, v80
    v_exp_f32 v81, v81
    v_exp_f32 v82, v82
    v_exp_f32 v83, v83
    v_cvt_pk_bf16_f32 v132, v80, v81
    v_cvt_pk_bf16_f32 v133, v82, v83
    v_mfma_f32_32x32x16_bf16 v[224:239], v[152:155], v[136:139], v[224:239]
    v_exp_f32 v84, v84
    v_exp_f32 v85, v85
    v_exp_f32 v86, v86
    v_exp_f32 v87, v87
    v_cvt_pk_bf16_f32 v134, v84, v85
    v_cvt_pk_bf16_f32 v135, v86, v87
    v_mfma_f32_32x32x8_bf16 v[64:79], v[144:145], v[100:101], v[64:79]
    buffer_load_dwordx2 v[26:27], v130, s[24:27], s92 offen sc1
    v_exp_f32 v88, v88
    v_exp_f32 v89, v89
    v_exp_f32 v90, v90
    v_exp_f32 v91, v91
    v_cvt_pk_bf16_f32 v136, v88, v89
    v_cvt_pk_bf16_f32 v137, v90, v91
    v_mfma_f32_32x32x16_bf16 v[240:255], v[148:151], v[132:135], v[240:255]
    ds_read_b128 v[148:151], v110 offset:39424
    v_exp_f32 v92, v92
    v_exp_f32 v93, v93
    v_exp_f32 v94, v94
    v_exp_f32 v95, v95
    v_cvt_pk_bf16_f32 v138, v92, v93
    v_cvt_pk_bf16_f32 v139, v94, v95
    v_mfma_f32_32x32x16_bf16 v[80:95], v[140:143], v[102:105], 0
    ds_read2st64_b64 v[140:143], v108 offset0:88 offset1:89
    v_exp_f32 v64, v64
    v_exp_f32 v65, v65
    v_exp_f32 v66, v66
    v_exp_f32 v67, v67
    v_cvt_pk_bf16_f32 v132, v64, v65
    v_cvt_pk_bf16_f32 v133, v66, v67
    v_mfma_f32_32x32x16_bf16 v[240:255], v[152:155], v[136:139], v[240:255]
    ds_read_b128 v[152:155], v111 offset:39424
    v_exp_f32 v68, v68
    v_exp_f32 v69, v69
    v_exp_f32 v70, v70
    v_exp_f32 v71, v71
    v_cvt_pk_bf16_f32 v134, v68, v69
    v_cvt_pk_bf16_f32 v135, v70, v71
    v_xor_b32 v192, v192, v16
    v_xor_b32 v193, v193, v16
    v_xor_b32 v194, v194, v16
    v_xor_b32 v195, v195, v16
    v_xor_b32 v196, v196, v16
    v_cndmask_b32 v196, v196, 0, s[50:51]
    v_xor_b32 v197, v197, v16
    v_cndmask_b32 v197, v197, 0, s[50:51]
    s_waitcnt lgkmcnt(5)
    v_xor_b32 v198, v198, v16
    v_xor_b32 v199, v199, v16
    s_waitcnt lgkmcnt(4)
    v_xor_b32 v200, v200, v16
    v_xor_b32 v201, v201, v16
    s_waitcnt lgkmcnt(3)
    v_xor_b32 v202, v202, v16
    v_cndmask_b32 v202, v202, 0, s[50:51]
    v_xor_b32 v203, v203, v16
    v_cndmask_b32 v203, v203, 0, s[50:51]
    v_mfma_f32_32x32x8_bf16 v[80:95], v[144:145], v[106:107], v[80:95]
    ds_read_b64 v[144:145], v109 offset:45056
    v_exp_f32 v72, v72
    v_exp_f32 v73, v73
    v_exp_f32 v74, v74
    v_exp_f32 v75, v75
    v_cvt_pk_bf16_f32 v136, v72, v73
    v_cvt_pk_bf16_f32 v137, v74, v75
    s_waitcnt lgkmcnt(3)
    v_mfma_f32_32x32x16_bf16 v[224:239], v[148:151], v[132:135], v[224:239]
    v_exp_f32 v76, v76
    v_exp_f32 v77, v77
    v_exp_f32 v78, v78
    v_exp_f32 v79, v79
    v_cvt_pk_bf16_f32 v138, v76, v77
    v_cvt_pk_bf16_f32 v139, v78, v79
    s_waitcnt lgkmcnt(0)
    s_setprio 1
    v_mfma_f32_32x32x16_bf16 v[64:79], v[140:143], v[96:99], 0
    v_exp_f32 v80, v80
    v_exp_f32 v81, v81
    v_exp_f32 v82, v82
    v_exp_f32 v83, v83
    v_cvt_pk_bf16_f32 v132, v80, v81
    v_cvt_pk_bf16_f32 v133, v82, v83
    v_mfma_f32_32x32x16_bf16 v[224:239], v[152:155], v[136:139], v[224:239]
    v_exp_f32 v84, v84
    v_exp_f32 v85, v85
    v_exp_f32 v86, v86
    v_exp_f32 v87, v87
    v_cvt_pk_bf16_f32 v134, v84, v85
    v_cvt_pk_bf16_f32 v135, v86, v87
    v_mfma_f32_32x32x8_bf16 v[64:79], v[144:145], v[100:101], v[64:79]
    v_exp_f32 v88, v88
    v_exp_f32 v89, v89
    v_exp_f32 v90, v90
    v_exp_f32 v91, v91
    v_cvt_pk_bf16_f32 v136, v88, v89
    v_cvt_pk_bf16_f32 v137, v90, v91
    v_mfma_f32_32x32x16_bf16 v[240:255], v[148:151], v[132:135], v[240:255]
    ds_read_b128 v[148:151], v110 offset:45056
    v_exp_f32 v92, v92
    v_exp_f32 v93, v93
    v_exp_f32 v94, v94
    v_exp_f32 v95, v95
    v_cvt_pk_bf16_f32 v138, v92, v93
    v_cvt_pk_bf16_f32 v139, v94, v95
    v_mfma_f32_32x32x16_bf16 v[80:95], v[140:143], v[102:105], 0
    ds_read2st64_b64 v[140:143], v108 offset0:99 offset1:100
L_ck_a:
    s_waitcnt vmcnt(0)
    v_cmp_ne_u64 vcc, v[26:27], v[24:25]
    s_nop 3
    s_and_b32 s42, vcc_lo, s37
    s_cmp_eq_u32 s42, 0
    s_cbranch_scc0 L_sl_a
L_ok_a:
    s_add_u32 s85, s84, 10485760
    buffer_load_dwordx2 v[178:179], v117, s[24:27], s85 offen sc1
    buffer_load_dwordx2 v[180:181], v117, s[24:27], s85 offen offset:512 sc1
    buffer_load_dwordx2 v[182:183], v118, s[24:27], s85 offen sc1
    v_exp_f32 v64, v64
    v_exp_f32 v65, v65
    v_exp_f32 v66, v66
    v_exp_f32 v67, v67
    v_cvt_pk_bf16_f32 v132, v64, v65
    v_cvt_pk_bf16_f32 v133, v66, v67
    v_mfma_f32_32x32x16_bf16 v[240:255], v[152:155], v[136:139], v[240:255]
    ds_read_b128 v[152:155], v111 offset:45056
    buffer_load_dwordx2 v[172:173], v117, s[24:27], s84 offen offset:1280 sc1
    buffer_load_dwordx2 v[174:175], v117, s[24:27], s84 offen offset:1792 sc1
    buffer_load_dwordx2 v[176:177], v118, s[24:27], s84 offen offset:1280 sc1
    s_mov_b32 exec_lo, 0xfffff
    s_mov_b32 exec_hi, 0xfffff
    buffer_load_dwordx4 v[184:187], v115, s[24:27], s85 offen sc1
    buffer_load_dwordx4 v[188:191], v115, s[24:27], s85 offen offset:640 sc1
    s_mov_b64 exec, -1
    v_exp_f32 v68, v68
    v_exp_f32 v69, v69
    v_exp_f32 v70, v70
    v_exp_f32 v71, v71
    v_cvt_pk_bf16_f32 v134, v68, v69
    v_cvt_pk_bf16_f32 v135, v70, v71
    v_mfma_f32_32x32x8_bf16 v[80:95], v[144:145], v[106:107], v[80:95]
    ds_read_b64 v[144:145], v109 offset:50688
    v_exp_f32 v72, v72
    v_exp_f32 v73, v73
    v_exp_f32 v74, v74
    v_exp_f32 v75, v75
    v_cvt_pk_bf16_f32 v136, v72, v73
    v_cvt_pk_bf16_f32 v137, v74, v75
    s_waitcnt lgkmcnt(3)
    v_mfma_f32_32x32x16_bf16 v[224:239], v[148:151], v[132:135], v[224:239]
    v_exp_f32 v76, v76
    v_exp_f32 v77, v77
    v_exp_f32 v78, v78
    v_exp_f32 v79, v79
    v_cvt_pk_bf16_f32 v138, v76, v77
    v_cvt_pk_bf16_f32 v139, v78, v79
    s_waitcnt lgkmcnt(0)
    v_mfma_f32_32x32x16_bf16 v[64:79], v[140:143], v[96:99], 0
    v_exp_f32 v80, v80
    v_exp_f32 v81, v81
    v_exp_f32 v82, v82
    v_exp_f32 v83, v83
    v_cvt_pk_bf16_f32 v132, v80, v81
    v_cvt_pk_bf16_f32 v133, v82, v83
    v_mfma_f32_32x32x16_bf16 v[224:239], v[152:155], v[136:139], v[224:239]
    v_exp_f32 v84, v84
    v_exp_f32 v85, v85
    v_exp_f32 v86, v86
    v_exp_f32 v87, v87
    v_cvt_pk_bf16_f32 v134, v84, v85
    v_cvt_pk_bf16_f32 v135, v86, v87
    s_add_u32 m0, s95, 40960
    s_add_u32 s42, s97, 0
    v_mfma_f32_32x32x8_bf16 v[64:79], v[144:145], v[100:101], v[64:79]
    s_mov_b32 exec_hi, 0xff
    buffer_load_dwordx4 v119, s[72:75], s42 offen lds
    buffer_load_dwordx4 v116, s[72:75], s42 offen offset:640 lds
    s_mov_b32 exec_hi, -1
    v_exp_f32 v88, v88
    v_exp_f32 v89, v89
    v_exp_f32 v90, v90
    v_exp_f32 v91, v91
    v_cvt_pk_bf16_f32 v136, v88, v89
    v_cvt_pk_bf16_f32 v137, v90, v91
    v_mfma_f32_32x32x16_bf16 v[240:255], v[148:151], v[132:135], v[240:255]
    ds_read_b128 v[148:151], v110 offset:50688
    v_exp_f32 v92, v92
    v_exp_f32 v93, v93
    v_exp_f32 v94, v94
    v_exp_f32 v95, v95
    v_cvt_pk_bf16_f32 v138, v92, v93
    v_cvt_pk_bf16_f32 v139, v94, v95
    s_setprio 0
    v_mfma_f32_32x32x16_bf16 v[80:95], v[140:143], v[102:105], 0
    ds_read2st64_b64 v[140:143], v108 offset0:110 offset1:111
    v_exp_f32 v64, v64
    v_exp_f32 v65, v65
    v_exp_f32 v66, v66
    v_exp_f32 v67, v67
    v_cvt_pk_bf16_f32 v132, v64, v65
    v_cvt_pk_bf16_f32 v133, v66, v67
    v_mfma_f32_32x32x16_bf16 v[240:255], v[152:155], v[136:139], v[240:255]
    ds_read_b128 v[152:155], v111 offset:50688
    v_exp_f32 v68, v68
    v_exp_f32 v69, v69
    v_exp_f32 v70, v70
    v_exp_f32 v71, v71
    v_cvt_pk_bf16_f32 v134, v68, v69
    v_cvt_pk_bf16_f32 v135, v70, v71
    v_mfma_f32_32x32x8_bf16 v[80:95], v[144:145], v[106:107], v[80:95]
    ds_read_b64 v[144:145], v109 offset:56320
    v_exp_f32 v72, v72
    v_exp_f32 v73, v73
    v_exp_f32 v74, v74
    v_exp_f32 v75, v75
    v_cvt_pk_bf16_f32 v136, v72, v73
    v_cvt_pk_bf16_f32 v137, v74, v75
    s_waitcnt lgkmcnt(3)
    v_mfma_f32_32x32x16_bf16 v[224:239], v[148:151], v[132:135], v[224:239]
    v_exp_f32 v76, v76
    v_exp_f32 v77, v77
    v_exp_f32 v78, v78
    v_exp_f32 v79, v79
    v_cvt_pk_bf16_f32 v138, v76, v77
    v_cvt_pk_bf16_f32 v139, v78, v79
    s_waitcnt lgkmcnt(0)
    v_mfma_f32_32x32x16_bf16 v[64:79], v[140:143], v[96:99], 0
    v_exp_f32 v80, v80
    v_exp_f32 v81, v81
    v_exp_f32 v82, v82
    v_exp_f32 v83, v83
    v_cvt_pk_bf16_f32 v132, v80, v81
    v_cvt_pk_bf16_f32 v133, v82, v83
    v_mfma_f32_32x32x16_bf16 v[224:239], v[152:155], v[136:139], v[224:239]
    v_exp_f32 v84, v84
    v_exp_f32 v85, v85
    v_exp_f32 v86, v86
    v_exp_f32 v87, v87
    v_cvt_pk_bf16_f32 v134, v84, v85
    v_cvt_pk_bf16_f32 v135, v86, v87
    v_mfma_f32_32x32x8_bf16 v[64:79], v[144:145], v[100:101], v[64:79]
    v_exp_f32 v88, v88
    v_exp_f32 v89, v89
    v_exp_f32 v90, v90
    v_exp_f32 v91, v91
    v_cvt_pk_bf16_f32 v136, v88, v89
    v_cvt_pk_bf16_f32 v137, v90, v91
    v_mfma_f32_32x32x16_bf16 v[240:255], v[148:151], v[132:135], v[240:255]
    ds_read_b128 v[148:151], v110 offset:56320
    v_exp_f32 v92, v92
    v_exp_f32 v93, v93
    v_exp_f32 v94, v94
    v_exp_f32 v95, v95
    v_cvt_pk_bf16_f32 v138, v92, v93
    v_cvt_pk_bf16_f32 v139, v94, v95
    s_waitcnt vmcnt(11) lgkmcnt(0)
    s_barrier
    s_setprio 3
    v_mfma_f32_32x32x16_bf16 v[80:95], v[140:143], v[102:105], 0
    ds_read2st64_b64 v[140:143], v108 offset0:121 offset1:122
    v_exp_f32 v64, v64
    v_exp_f32 v65, v65
    v_exp_f32 v66, v66
    s_waitcnt vmcnt(8)
    v_mfma_f32_32x32x16_bf16 v[32:47], v[192:195], v[178:181], 0
    v_exp_f32 v67, v67
    v_cvt_pk_bf16_f32 v132, v64, v65
    v_cvt_pk_bf16_f32 v133, v66, v67
    v_mfma_f32_32x32x16_bf16 v[240:255], v[152:155], v[136:139], v[240:255]
    ds_read_b128 v[152:155], v111 offset:56320
    v_exp_f32 v68, v68
    v_exp_f32 v69, v69
    v_exp_f32 v70, v70
    v_mfma_f32_32x32x16_bf16 v[204:219], v[198:201], v[178:181], 0
    v_exp_f32 v71, v71
    v_cvt_pk_bf16_f32 v134, v68, v69
    v_cvt_pk_bf16_f32 v135, v70, v71
    s_add_u32 m0, s88, 22528
    s_add_u32 s58, s57, 40960
    v_mfma_f32_32x32x8_bf16 v[80:95], v[144:145], v[106:107], v[80:95]
    ds_read_b64 v[144:145], v109 offset:61952
    buffer_load_dwordx4 v112, s[24:27], s58 offen sc1 lds
    v_exp_f32 v72, v72
    v_exp_f32 v73, v73
    v_exp_f32 v74, v74
    s_waitcnt vmcnt(8)
    v_mfma_f32_32x32x8_bf16 v[32:47], v[196:197], v[182:183], v[32:47]
    v_exp_f32 v75, v75
    v_cvt_pk_bf16_f32 v136, v72, v73
    v_cvt_pk_bf16_f32 v137, v74, v75
    s_add_u32 m0, s89, 22528
    v_mfma_f32_32x32x16_bf16 v[224:239], v[148:151], v[132:135], v[224:239]
    buffer_load_dwordx4 v113, s[24:27], s58 offen sc1 lds
    v_exp_f32 v76, v76
    v_exp_f32 v77, v77
    v_exp_f32 v78, v78
    v_mfma_f32_32x32x8_bf16 v[204:219], v[202:203], v[182:183], v[204:219]
    v_exp_f32 v79, v79
    v_cvt_pk_bf16_f32 v138, v76, v77
    v_cvt_pk_bf16_f32 v139, v78, v79
    s_add_u32 m0, s90, 22528
    s_waitcnt lgkmcnt(0)
    v_mfma_f32_32x32x16_bf16 v[64:79], v[140:143], v[96:99], 0
    buffer_load_dwordx4 v114, s[24:27], s58 offen sc1 lds
    v_exp_f32 v80, v80
    v_exp_f32 v81, v81
    v_exp_f32 v82, v82
    s_waitcnt vmcnt(8)
    v_mfma_f32_32x32x16_bf16 v[48:63], v[192:195], v[172:175], 0
    v_exp_f32 v83, v83
    v_cvt_pk_bf16_f32 v132, v80, v81
    v_cvt_pk_bf16_f32 v133, v82, v83
    v_mfma_f32_32x32x16_bf16 v[224:239], v[152:155], v[136:139], v[224:239]
    v_exp_f32 v84, v84
    v_exp_f32 v85, v85
    v_exp_f32 v86, v86
    v_mfma_f32_32x32x16_bf16 v[208:223], v[198:201], v[172:175], 0
    v_exp_f32 v87, v87
    v_cvt_pk_bf16_f32 v134, v84, v85
    v_cvt_pk_bf16_f32 v135, v86, v87
    v_mfma_f32_32x32x8_bf16 v[64:79], v[144:145], v[100:101], v[64:79]
    v_exp_f32 v88, v88
    v_exp_f32 v89, v89
    v_exp_f32 v90, v90
    s_waitcnt vmcnt(7)
    v_mfma_f32_32x32x8_bf16 v[48:63], v[196:197], v[176:177], v[48:63]
    v_exp_f32 v91, v91
    v_cvt_pk_bf16_f32 v136, v88, v89
    v_cvt_pk_bf16_f32 v137, v90, v91
    v_mfma_f32_32x32x16_bf16 v[240:255], v[148:151], v[132:135], v[240:255]
    ds_read_b128 v[148:151], v110 offset:61952
    v_exp_f32 v92, v92
    v_exp_f32 v93, v93
    v_exp_f32 v94, v94
    v_mfma_f32_32x32x8_bf16 v[208:223], v[202:203], v[176:177], v[208:223]
    v_exp_f32 v95, v95
    v_cvt_pk_bf16_f32 v138, v92, v93
    v_cvt_pk_bf16_f32 v139, v94, v95
    s_setprio 2
    v_mfma_f32_32x32x16_bf16 v[80:95], v[140:143], v[102:105], 0
    ds_read2st64_b64 v[140:143], v108 offset0:0 offset1:1
    v_exp_f32 v64, v64
    v_exp_f32 v65, v65
    v_exp_f32 v66, v66
    v_exp_f32 v67, v67
    v_cvt_pk_bf16_f32 v132, v64, v65
    v_cvt_pk_bf16_f32 v133, v66, v67
    v_max3_f32 v146, v32, v33, v34
    v_max3_f32 v158, v35, v36, v37
    v_max3_f32 v146, v146, v38, v39
    v_max3_f32 v158, v158, v40, v41
    v_max3_f32 v146, v146, v42, v43
    v_max3_f32 v158, v158, v44, v45
    v_max3_f32 v146, v146, v46, v47
    v_max3_f32 v158, v158, v204, v205
    v_max3_f32 v146, v146, v206, v207
    v_max_f32 v146, v146, v158
    v_mul_f32 v146, s52, v146
    v_pk_fma_f32 v[32:33], v[32:33], s[52:53], v[146:147] op_sel_hi:[1,0,0] neg_lo:[0,0,1] neg_hi:[0,0,1]
    v_pk_fma_f32 v[34:35], v[34:35], s[52:53], v[146:147] op_sel_hi:[1,0,0] neg_lo:[0,0,1] neg_hi:[0,0,1]
    v_pk_fma_f32 v[36:37], v[36:37], s[52:53], v[146:147] op_sel_hi:[1,0,0] neg_lo:[0,0,1] neg_hi:[0,0,1]
    v_pk_fma_f32 v[38:39], v[38:39], s[52:53], v[146:147] op_sel_hi:[1,0,0] neg_lo:[0,0,1] neg_hi:[0,0,1]
    v_pk_fma_f32 v[40:41], v[40:41], s[52:53], v[146:147] op_sel_hi:[1,0,0] neg_lo:[0,0,1] neg_hi:[0,0,1]
    v_pk_fma_f32 v[42:43], v[42:43], s[52:53], v[146:147] op_sel_hi:[1,0,0] neg_lo:[0,0,1] neg_hi:[0,0,1]
    v_pk_fma_f32 v[44:45], v[44:45], s[52:53], v[146:147] op_sel_hi:[1,0,0] neg_lo:[0,0,1] neg_hi:[0,0,1]
    v_pk_fma_f32 v[46:47], v[46:47], s[52:53], v[146:147] op_sel_hi:[1,0,0] neg_lo:[0,0,1] neg_hi:[0,0,1]
    v_pk_fma_f32 v[204:205], v[204:205], s[52:53], v[146:147] op_sel_hi:[1,0,0] neg_lo:[0,0,1] neg_hi:[0,0,1]
    v_pk_fma_f32 v[206:207], v[206:207], s[52:53], v[146:147] op_sel_hi:[1,0,0] neg_lo:[0,0,1] neg_hi:[0,0,1]
    v_exp_f32 v32, v32
    v_exp_f32 v33, v33
    v_exp_f32 v34, v34
    v_exp_f32 v35, v35
    v_exp_f32 v36, v36
    v_exp_f32 v37, v37
    v_exp_f32 v38, v38
    v_exp_f32 v39, v39
    v_exp_f32 v40, v40
    v_exp_f32 v41, v41
    v_exp_f32 v42, v42
    v_exp_f32 v43, v43
    v_exp_f32 v44, v44
    v_exp_f32 v45, v45
    v_exp_f32 v46, v46
    v_exp_f32 v47, v47
    v_exp_f32 v204, v204
    v_exp_f32 v205, v205
    v_exp_f32 v206, v206
    v_exp_f32 v207, v207
    v_pk_add_f32 v[146:147], v[32:33], v[34:35]
    v_pk_add_f32 v[158:159], v[36:37], v[38:39]
    v_pk_add_f32 v[146:147], v[146:147], v[40:41]
    v_pk_add_f32 v[158:159], v[158:159], v[42:43]
    v_pk_add_f32 v[146:147], v[146:147], v[44:45]
    v_pk_add_f32 v[158:159], v[158:159], v[46:47]
    v_pk_add_f32 v[146:147], v[146:147], v[204:205]
    v_pk_add_f32 v[158:159], v[158:159], v[206:207]
    v_pk_add_f32 v[146:147], v[146:147], v[158:159]
    v_add_f32 v158, v146, v147
    v_rcp_f32 v158, v158
    s_nop 0
    v_pk_mul_f32 v[32:33], v[32:33], v[158:159] op_sel_hi:[1,0]
    v_pk_mul_f32 v[34:35], v[34:35], v[158:159] op_sel_hi:[1,0]
    v_pk_mul_f32 v[36:37], v[36:37], v[158:159] op_sel_hi:[1,0]
    v_pk_mul_f32 v[38:39], v[38:39], v[158:159] op_sel_hi:[1,0]
    v_pk_mul_f32 v[40:41], v[40:41], v[158:159] op_sel_hi:[1,0]
    v_pk_mul_f32 v[42:43], v[42:43], v[158:159] op_sel_hi:[1,0]
    v_pk_mul_f32 v[44:45], v[44:45], v[158:159] op_sel_hi:[1,0]
    v_pk_mul_f32 v[46:47], v[46:47], v[158:159] op_sel_hi:[1,0]
    v_pk_mul_f32 v[204:205], v[204:205], v[158:159] op_sel_hi:[1,0]
    v_pk_mul_f32 v[206:207], v[206:207], v[158:159] op_sel_hi:[1,0]
    v_cvt_pk_bf16_f32 v212, v32, v33
    v_cvt_pk_bf16_f32 v213, v34, v35
    v_cvt_pk_bf16_f32 v214, v36, v37
    v_cvt_pk_bf16_f32 v215, v38, v39
    v_cvt_pk_bf16_f32 v216, v40, v41
    v_cvt_pk_bf16_f32 v217, v42, v43
    v_cvt_pk_bf16_f32 v218, v44, v45
    v_cvt_pk_bf16_f32 v219, v46, v47
    v_cvt_pk_bf16_f32 v220, v204, v205
    v_cvt_pk_bf16_f32 v221, v206, v207
    v_mfma_f32_32x32x16_bf16 v[240:255], v[152:155], v[136:139], v[240:255]
    ds_read_b128 v[152:155], v111 offset:61952
    ds_write_b64 v6, v[212:213] offset:0
    ds_write_b64 v6, v[214:215] offset:8
    ds_write_b64 v6, v[216:217] offset:16
    ds_write_b64 v6, v[218:219] offset:24
    ds_write_b64 v6, v[220:221] offset:32
    v_exp_f32 v68, v68
    v_exp_f32 v69, v69
    v_exp_f32 v70, v70
    v_exp_f32 v71, v71
    v_cvt_pk_bf16_f32 v134, v68, v69
    v_cvt_pk_bf16_f32 v135, v70, v71
    s_add_u32 m0, s95, 42240
    s_add_u32 s42, s97, 5120
    v_mfma_f32_32x32x8_bf16 v[80:95], v[144:145], v[106:107], v[80:95]
    ds_read_b64 v[144:145], v109 offset:0
    s_mov_b32 exec_hi, 0xff
    buffer_load_dwordx4 v119, s[72:75], s42 offen lds
    buffer_load_dwordx4 v116, s[72:75], s42 offen offset:640 lds
    s_mov_b32 exec_hi, -1
    ds_read_b64_tr_b16 v[120:121], v7 offset:0
    ds_read_b64_tr_b16 v[172:173], v8 offset:0
    ds_read_b64_tr_b16 v[122:123], v7 offset:640
    ds_read_b64_tr_b16 v[174:175], v8 offset:640
    v_exp_f32 v72, v72
    v_exp_f32 v73, v73
    v_exp_f32 v74, v74
    v_exp_f32 v75, v75
    v_cvt_pk_bf16_f32 v136, v72, v73
    v_cvt_pk_bf16_f32 v137, v74, v75
    s_waitcnt lgkmcnt(12)
    v_mfma_f32_32x32x16_bf16 v[224:239], v[148:151], v[132:135], v[224:239]
    ds_read_b64_tr_b16 v[124:125], v7 offset:1280
    ds_read_b64_tr_b16 v[176:177], v8 offset:1280
    ds_read_b64_tr_b16 v[126:127], v7 offset:1920
    ds_read_b64_tr_b16 v[178:179], v8 offset:1920
    v_exp_f32 v76, v76
    v_exp_f32 v77, v77
    v_exp_f32 v78, v78
    v_exp_f32 v79, v79
    v_cvt_pk_bf16_f32 v138, v76, v77
    v_cvt_pk_bf16_f32 v139, v78, v79
    s_waitcnt lgkmcnt(8)
    s_setprio 1
    v_mfma_f32_32x32x16_bf16 v[64:79], v[140:143], v[96:99], 0
    v_exp_f32 v80, v80
    v_exp_f32 v81, v81
    v_exp_f32 v82, v82
    v_exp_f32 v83, v83
    v_cvt_pk_bf16_f32 v132, v80, v81
    v_cvt_pk_bf16_f32 v133, v82, v83
    v_max3_f32 v146, v48, v49, v50
    v_max3_f32 v158, v51, v52, v53
    v_max3_f32 v146, v146, v54, v55
    v_max3_f32 v158, v158, v56, v57
    v_max3_f32 v146, v146, v58, v59
    v_max3_f32 v158, v158, v60, v61
    v_max3_f32 v146, v146, v62, v63
    v_max3_f32 v158, v158, v208, v209
    v_max3_f32 v146, v146, v210, v211
    v_max_f32 v146, v146, v158
    v_mul_f32 v146, s52, v146
    v_pk_fma_f32 v[48:49], v[48:49], s[52:53], v[146:147] op_sel_hi:[1,0,0] neg_lo:[0,0,1] neg_hi:[0,0,1]
    v_pk_fma_f32 v[50:51], v[50:51], s[52:53], v[146:147] op_sel_hi:[1,0,0] neg_lo:[0,0,1] neg_hi:[0,0,1]
    v_pk_fma_f32 v[52:53], v[52:53], s[52:53], v[146:147] op_sel_hi:[1,0,0] neg_lo:[0,0,1] neg_hi:[0,0,1]
    v_pk_fma_f32 v[54:55], v[54:55], s[52:53], v[146:147] op_sel_hi:[1,0,0] neg_lo:[0,0,1] neg_hi:[0,0,1]
    v_pk_fma_f32 v[56:57], v[56:57], s[52:53], v[146:147] op_sel_hi:[1,0,0] neg_lo:[0,0,1] neg_hi:[0,0,1]
    v_pk_fma_f32 v[58:59], v[58:59], s[52:53], v[146:147] op_sel_hi:[1,0,0] neg_lo:[0,0,1] neg_hi:[0,0,1]
    v_pk_fma_f32 v[60:61], v[60:61], s[52:53], v[146:147] op_sel_hi:[1,0,0] neg_lo:[0,0,1] neg_hi:[0,0,1]
    v_pk_fma_f32 v[62:63], v[62:63], s[52:53], v[146:147] op_sel_hi:[1,0,0] neg_lo:[0,0,1] neg_hi:[0,0,1]
    v_pk_fma_f32 v[208:209], v[208:209], s[52:53], v[146:147] op_sel_hi:[1,0,0] neg_lo:[0,0,1] neg_hi:[0,0,1]
    v_pk_fma_f32 v[210:211], v[210:211], s[52:53], v[146:147] op_sel_hi:[1,0,0] neg_lo:[0,0,1] neg_hi:[0,0,1]
    v_exp_f32 v48, v48
    v_exp_f32 v49, v49
    v_exp_f32 v50, v50
    v_exp_f32 v51, v51
    v_exp_f32 v52, v52
    v_exp_f32 v53, v53
    v_exp_f32 v54, v54
    v_exp_f32 v55, v55
    v_exp_f32 v56, v56
    v_exp_f32 v57, v57
    v_exp_f32 v58, v58
    v_exp_f32 v59, v59
    v_exp_f32 v60, v60
    v_exp_f32 v61, v61
    v_exp_f32 v62, v62
    v_exp_f32 v63, v63
    v_exp_f32 v208, v208
    v_exp_f32 v209, v209
    v_exp_f32 v210, v210
    v_exp_f32 v211, v211
    v_pk_add_f32 v[146:147], v[48:49], v[50:51]
    v_pk_add_f32 v[158:159], v[52:53], v[54:55]
    v_pk_add_f32 v[146:147], v[146:147], v[56:57]
    v_pk_add_f32 v[158:159], v[158:159], v[58:59]
    v_pk_add_f32 v[146:147], v[146:147], v[60:61]
    v_pk_add_f32 v[158:159], v[158:159], v[62:63]
    v_pk_add_f32 v[146:147], v[146:147], v[208:209]
    v_pk_add_f32 v[158:159], v[158:159], v[210:211]
    v_pk_add_f32 v[146:147], v[146:147], v[158:159]
    v_add_f32 v158, v146, v147
    v_rcp_f32 v158, v158
    s_nop 0
    v_pk_mul_f32 v[48:49], v[48:49], v[158:159] op_sel_hi:[1,0]
    v_pk_mul_f32 v[50:51], v[50:51], v[158:159] op_sel_hi:[1,0]
    v_pk_mul_f32 v[52:53], v[52:53], v[158:159] op_sel_hi:[1,0]
    v_pk_mul_f32 v[54:55], v[54:55], v[158:159] op_sel_hi:[1,0]
    v_pk_mul_f32 v[56:57], v[56:57], v[158:159] op_sel_hi:[1,0]
    v_pk_mul_f32 v[58:59], v[58:59], v[158:159] op_sel_hi:[1,0]
    v_pk_mul_f32 v[60:61], v[60:61], v[158:159] op_sel_hi:[1,0]
    v_pk_mul_f32 v[62:63], v[62:63], v[158:159] op_sel_hi:[1,0]
    v_pk_mul_f32 v[208:209], v[208:209], v[158:159] op_sel_hi:[1,0]
    v_pk_mul_f32 v[210:211], v[210:211], v[158:159] op_sel_hi:[1,0]
    v_cvt_pk_bf16_f32 v160, v48, v49
    v_cvt_pk_bf16_f32 v161, v50, v51
    v_cvt_pk_bf16_f32 v162, v52, v53
    v_cvt_pk_bf16_f32 v163, v54, v55
    v_cvt_pk_bf16_f32 v164, v56, v57
    v_cvt_pk_bf16_f32 v165, v58, v59
    v_cvt_pk_bf16_f32 v166, v60, v61
    v_cvt_pk_bf16_f32 v167, v62, v63
    v_cvt_pk_bf16_f32 v168, v208, v209
    v_cvt_pk_bf16_f32 v169, v210, v211
    v_mfma_f32_32x32x16_bf16 v[224:239], v[152:155], v[136:139], v[224:239]
    v_exp_f32 v84, v84
    v_exp_f32 v85, v85
    v_exp_f32 v86, v86
    v_exp_f32 v87, v87
    v_cvt_pk_bf16_f32 v134, v84, v85
    v_cvt_pk_bf16_f32 v135, v86, v87
    v_mfma_f32_32x32x8_bf16 v[64:79], v[144:145], v[100:101], v[64:79]
    v_exp_f32 v88, v88
    v_exp_f32 v89, v89
    v_exp_f32 v90, v90
    s_waitcnt vmcnt(8) lgkmcnt(5)
    v_mfma_f32_32x32x16_bf16 v[32:47], v[120:123], v[184:187], 0
    v_exp_f32 v91, v91
    v_cvt_pk_bf16_f32 v136, v88, v89
    v_cvt_pk_bf16_f32 v137, v90, v91
    v_mfma_f32_32x32x16_bf16 v[240:255], v[148:151], v[132:135], v[240:255]
    ds_read_b128 v[148:151], v110 offset:0
    v_exp_f32 v92, v92
    v_exp_f32 v93, v93
    v_exp_f32 v94, v94
    s_waitcnt lgkmcnt(5)
    v_mfma_f32_32x32x16_bf16 v[48:63], v[172:175], v[184:187], 0
    v_exp_f32 v95, v95
    v_cvt_pk_bf16_f32 v138, v92, v93
    v_cvt_pk_bf16_f32 v139, v94, v95
    v_mfma_f32_32x32x16_bf16 v[80:95], v[140:143], v[102:105], 0
    ds_read2st64_b64 v[140:143], v108 offset0:11 offset1:12
    v_exp_f32 v64, v64
    v_exp_f32 v65, v65
    v_exp_f32 v66, v66
    s_waitcnt vmcnt(7) lgkmcnt(3)
    v_mfma_f32_32x32x16_bf16 v[32:47], v[124:127], v[188:191], v[32:47]
    v_exp_f32 v67, v67
    v_cvt_pk_bf16_f32 v132, v64, v65
    v_cvt_pk_bf16_f32 v133, v66, v67
    v_mfma_f32_32x32x16_bf16 v[240:255], v[152:155], v[136:139], v[240:255]
    ds_read_b128 v[152:155], v111 offset:0
    v_exp_f32 v68, v68
    v_exp_f32 v69, v69
    v_exp_f32 v70, v70
    s_waitcnt lgkmcnt(3)
    v_mfma_f32_32x32x16_bf16 v[48:63], v[176:179], v[188:191], v[48:63]
    v_exp_f32 v71, v71
    v_cvt_pk_bf16_f32 v134, v68, v69
    v_cvt_pk_bf16_f32 v135, v70, v71
    v_mfma_f32_32x32x8_bf16 v[80:95], v[144:145], v[106:107], v[80:95]
    ds_read_b64 v[144:145], v109 offset:5632
    v_exp_f32 v72, v72
    v_exp_f32 v73, v73
    v_exp_f32 v74, v74
    v_exp_f32 v75, v75
    v_cvt_pk_bf16_f32 v136, v72, v73
    v_cvt_pk_bf16_f32 v137, v74, v75
    s_waitcnt lgkmcnt(3)
    v_mfma_f32_32x32x16_bf16 v[224:239], v[148:151], v[132:135], v[224:239]
    ds_write_b128 v9, v[32:35] offset:0
    v_exp_f32 v76, v76
    v_exp_f32 v77, v77
    v_exp_f32 v78, v78
    v_exp_f32 v79, v79
    v_cvt_pk_bf16_f32 v138, v76, v77
    v_cvt_pk_bf16_f32 v139, v78, v79
    s_waitcnt lgkmcnt(1)
    s_setprio 0
    v_mfma_f32_32x32x16_bf16 v[64:79], v[140:143], v[96:99], 0
    ds_write_b128 v9, v[36:39] offset:1024
    v_exp_f32 v80, v80
    v_exp_f32 v81, v81
    v_exp_f32 v82, v82
    v_exp_f32 v83, v83
    v_cvt_pk_bf16_f32 v132, v80, v81
    v_cvt_pk_bf16_f32 v133, v82, v83
    v_mfma_f32_32x32x16_bf16 v[224:239], v[152:155], v[136:139], v[224:239]
    ds_write_b128 v9, v[40:43] offset:2048
    v_exp_f32 v84, v84
    v_exp_f32 v85, v85
    v_exp_f32 v86, v86
    v_exp_f32 v87, v87
    v_cvt_pk_bf16_f32 v134, v84, v85
    v_cvt_pk_bf16_f32 v135, v86, v87
    v_mfma_f32_32x32x8_bf16 v[64:79], v[144:145], v[100:101], v[64:79]
    buffer_load_dwordx2 v[26:27], v17, s[24:27], s62 offen sc1
    buffer_load_dwordx2 v[28:29], v130, s[24:27], s3 offen sc1
    ds_write_b128 v9, v[44:47] offset:3072
    v_exp_f32 v88, v88
    v_exp_f32 v89, v89
    v_exp_f32 v90, v90
    v_exp_f32 v91, v91
    v_cvt_pk_bf16_f32 v136, v88, v89
    v_cvt_pk_bf16_f32 v137, v90, v91
    v_mfma_f32_32x32x16_bf16 v[240:255], v[148:151], v[132:135], v[240:255]
    ds_read_b128 v[148:151], v110 offset:5632
    ds_write_b128 v9, v[48:51] offset:4096
    v_exp_f32 v92, v92
    v_exp_f32 v93, v93
    v_exp_f32 v94, v94
    v_exp_f32 v95, v95
    v_cvt_pk_bf16_f32 v138, v92, v93
    v_cvt_pk_bf16_f32 v139, v94, v95
    s_waitcnt vmcnt(4) lgkmcnt(0)
    s_barrier
    s_setprio 3
    v_mfma_f32_32x32x16_bf16 v[80:95], v[140:143], v[102:105], 0
    ds_read2st64_b64 v[140:143], v108 offset0:22 offset1:23
    ds_read_b128 v[172:175], v11 offset:0
    ds_read_b128 v[176:179], v11 offset:5120
    ds_read_b128 v[180:183], v11 offset:10240
    ds_read_b128 v[184:187], v11 offset:15360
    v_exp_f32 v64, v64
    v_exp_f32 v65, v65
    v_exp_f32 v66, v66
    v_exp_f32 v67, v67
    v_cvt_pk_bf16_f32 v132, v64, v65
    v_cvt_pk_bf16_f32 v133, v66, v67
    v_mfma_f32_32x32x16_bf16 v[240:255], v[152:155], v[136:139], v[240:255]
    ds_read_b128 v[152:155], v111 offset:5632
    ds_read_b128 v[188:191], v11 offset:20480
    ds_read_b128 v[192:195], v11 offset:25600
    ds_read_b128 v[196:199], v11 offset:30720
    ds_read_b128 v[200:203], v11 offset:35840
    v_exp_f32 v68, v68
    v_exp_f32 v69, v69
    v_exp_f32 v70, v70
    v_exp_f32 v71, v71
    v_cvt_pk_bf16_f32 v134, v68, v69
    v_cvt_pk_bf16_f32 v135, v70, v71
    s_add_u32 m0, s88, 45056
    s_add_u32 s58, s57, 122880
    v_mfma_f32_32x32x8_bf16 v[80:95], v[144:145], v[106:107], v[80:95]
    ds_read_b64 v[144:145], v109 offset:11264
    buffer_load_dwordx4 v112, s[24:27], s58 offen sc1 lds
    v_exp_f32 v72, v72
    v_exp_f32 v73, v73
    v_exp_f32 v74, v74
    v_exp_f32 v75, v75
    v_cvt_pk_bf16_f32 v136, v72, v73
    v_cvt_pk_bf16_f32 v137, v74, v75
    s_add_u32 m0, s89, 45056
    v_mfma_f32_32x32x16_bf16 v[224:239], v[148:151], v[132:135], v[224:239]
    buffer_load_dwordx4 v113, s[24:27], s58 offen sc1 lds
    v_exp_f32 v76, v76
    v_exp_f32 v77, v77
    v_exp_f32 v78, v78
    v_exp_f32 v79, v79
    v_cvt_pk_bf16_f32 v138, v76, v77
    v_cvt_pk_bf16_f32 v139, v78, v79
    s_add_u32 m0, s90, 45056
    s_waitcnt lgkmcnt(0)
    v_mfma_f32_32x32x16_bf16 v[64:79], v[140:143], v[96:99], 0
    buffer_load_dwordx4 v114, s[24:27], s58 offen sc1 lds
    v_exp_f32 v80, v80
    v_exp_f32 v81, v81
    v_exp_f32 v82, v82
    v_exp_f32 v83, v83
    v_cvt_pk_bf16_f32 v132, v80, v81
    v_cvt_pk_bf16_f32 v133, v82, v83
    v_pk_add_f32 v[172:173], v[172:173], v[176:177]
    v_pk_add_f32 v[174:175], v[174:175], v[178:179]
    v_pk_add_f32 v[172:173], v[172:173], v[180:181]
    v_pk_add_f32 v[174:175], v[174:175], v[182:183]
    v_pk_add_f32 v[172:173], v[172:173], v[184:185]
    v_pk_add_f32 v[174:175], v[174:175], v[186:187]
    v_pk_add_f32 v[172:173], v[172:173], v[188:189]
    v_pk_add_f32 v[174:175], v[174:175], v[190:191]
    v_pk_add_f32 v[172:173], v[172:173], v[192:193]
    v_pk_add_f32 v[174:175], v[174:175], v[194:195]
    v_pk_add_f32 v[172:173], v[172:173], v[196:197]
    v_pk_add_f32 v[174:175], v[174:175], v[198:199]
    v_pk_add_f32 v[172:173], v[172:173], v[200:201]
    v_pk_add_f32 v[174:175], v[174:175], v[202:203]
    v_mfma_f32_32x32x16_bf16 v[224:239], v[152:155], v[136:139], v[224:239]
    s_mov_b32 exec_hi, 0xff
    buffer_store_dwordx4 v[172:175], v10, s[24:27], s93 offen sc1
    s_mov_b32 exec_hi, -1
    v_exp_f32 v84, v84
    v_exp_f32 v85, v85
    v_exp_f32 v86, v86
    v_exp_f32 v87, v87
    v_cvt_pk_bf16_f32 v134, v84, v85
    v_cvt_pk_bf16_f32 v135, v86, v87
    v_mfma_f32_32x32x8_bf16 v[64:79], v[144:145], v[100:101], v[64:79]
    v_exp_f32 v88, v88
    v_exp_f32 v89, v89
    v_exp_f32 v90, v90
    v_exp_f32 v91, v91
    v_cvt_pk_bf16_f32 v136, v88, v89
    v_cvt_pk_bf16_f32 v137, v90, v91
    v_mfma_f32_32x32x16_bf16 v[240:255], v[148:151], v[132:135], v[240:255]
    ds_read_b128 v[148:151], v110 offset:11264
    v_exp_f32 v92, v92
    v_exp_f32 v93, v93
    v_exp_f32 v94, v94
    v_exp_f32 v95, v95
    v_cvt_pk_bf16_f32 v138, v92, v93
    v_cvt_pk_bf16_f32 v139, v94, v95
    v_mfma_f32_32x32x16_bf16 v[80:95], v[140:143], v[102:105], 0
    ds_read2st64_b64 v[140:143], v108 offset0:33 offset1:34
    v_exp_f32 v64, v64
    v_exp_f32 v65, v65
    v_exp_f32 v66, v66
    v_exp_f32 v67, v67
    v_cvt_pk_bf16_f32 v132, v64, v65
    v_cvt_pk_bf16_f32 v133, v66, v67
    v_mfma_f32_32x32x16_bf16 v[240:255], v[152:155], v[136:139], v[240:255]
    ds_read_b128 v[152:155], v111 offset:11264
    v_exp_f32 v68, v68
    v_exp_f32 v69, v69
    v_exp_f32 v70, v70
    v_exp_f32 v71, v71
    v_cvt_pk_bf16_f32 v134, v68, v69
    v_cvt_pk_bf16_f32 v135, v70, v71
    v_mfma_f32_32x32x8_bf16 v[80:95], v[144:145], v[106:107], v[80:95]
    ds_read_b64 v[144:145], v109 offset:16896
    v_exp_f32 v72, v72
    v_exp_f32 v73, v73
    v_exp_f32 v74, v74
    v_exp_f32 v75, v75
    v_cvt_pk_bf16_f32 v136, v72, v73
    v_cvt_pk_bf16_f32 v137, v74, v75
    s_waitcnt lgkmcnt(3)
    v_mfma_f32_32x32x16_bf16 v[224:239], v[148:151], v[132:135], v[224:239]
    v_exp_f32 v76, v76
    v_exp_f32 v77, v77
    v_exp_f32 v78, v78
    v_exp_f32 v79, v79
    v_cvt_pk_bf16_f32 v138, v76, v77
    v_cvt_pk_bf16_f32 v139, v78, v79
    s_waitcnt lgkmcnt(0)
    s_setprio 2
    v_mfma_f32_32x32x16_bf16 v[64:79], v[140:143], v[96:99], 0
    v_exp_f32 v80, v80
    v_exp_f32 v81, v81
    v_exp_f32 v82, v82
    v_exp_f32 v83, v83
    v_cvt_pk_bf16_f32 v132, v80, v81
    v_cvt_pk_bf16_f32 v133, v82, v83
    v_mfma_f32_32x32x16_bf16 v[224:239], v[152:155], v[136:139], v[224:239]
    v_exp_f32 v84, v84
    v_exp_f32 v85, v85
    v_exp_f32 v86, v86
    v_exp_f32 v87, v87
    v_cvt_pk_bf16_f32 v134, v84, v85
    v_cvt_pk_bf16_f32 v135, v86, v87
    v_mfma_f32_32x32x8_bf16 v[64:79], v[144:145], v[100:101], v[64:79]
    v_exp_f32 v88, v88
    v_exp_f32 v89, v89
    v_exp_f32 v90, v90
    v_exp_f32 v91, v91
    v_cvt_pk_bf16_f32 v136, v88, v89
    v_cvt_pk_bf16_f32 v137, v90, v91
    v_mfma_f32_32x32x16_bf16 v[240:255], v[148:151], v[132:135], v[240:255]
    ds_read_b128 v[148:151], v110 offset:16896
    v_exp_f32 v92, v92
    v_exp_f32 v93, v93
    v_exp_f32 v94, v94
    v_exp_f32 v95, v95
    v_cvt_pk_bf16_f32 v138, v92, v93
    v_cvt_pk_bf16_f32 v139, v94, v95
    v_mfma_f32_32x32x16_bf16 v[80:95], v[140:143], v[102:105], 0
    ds_read2st64_b64 v[140:143], v108 offset0:44 offset1:45
    v_exp_f32 v64, v64
    v_exp_f32 v65, v65
    v_exp_f32 v66, v66
    v_exp_f32 v67, v67
    v_cvt_pk_bf16_f32 v132, v64, v65
    v_cvt_pk_bf16_f32 v133, v66, v67
    v_mfma_f32_32x32x16_bf16 v[240:255], v[152:155], v[136:139], v[240:255]
    ds_read_b128 v[152:155], v111 offset:16896
L_ck_p:
    s_waitcnt vmcnt(5)
    v_cmp_eq_u64 vcc, v[26:27], v[24:25]
    s_waitcnt vmcnt(4)
    v_cmp_eq_u64 s[66:67], v[28:29], v[24:25]
    s_nop 3
    s_and_b64 vcc, vcc, s[66:67]
    s_cmp_eq_u64 vcc, -1
    s_cbranch_scc0 L_sl_p
L_ok_p:
    v_exp_f32 v68, v68
    v_exp_f32 v69, v69
    v_exp_f32 v70, v70
    v_exp_f32 v71, v71
    v_cvt_pk_bf16_f32 v134, v68, v69
    v_cvt_pk_bf16_f32 v135, v70, v71
    v_mfma_f32_32x32x8_bf16 v[80:95], v[144:145], v[106:107], v[80:95]
    ds_read_b64 v[144:145], v109 offset:22528
    v_exp_f32 v72, v72
    v_exp_f32 v73, v73
    v_exp_f32 v74, v74
    v_exp_f32 v75, v75
    v_cvt_pk_bf16_f32 v136, v72, v73
    v_cvt_pk_bf16_f32 v137, v74, v75
    s_waitcnt lgkmcnt(3)
    v_mfma_f32_32x32x16_bf16 v[224:239], v[148:151], v[132:135], v[224:239]
    v_exp_f32 v76, v76
    v_exp_f32 v77, v77
    v_exp_f32 v78, v78
    v_exp_f32 v79, v79
    v_cvt_pk_bf16_f32 v138, v76, v77
    v_cvt_pk_bf16_f32 v139, v78, v79
    s_waitcnt lgkmcnt(0)
    v_mfma_f32_32x32x16_bf16 v[64:79], v[140:143], v[96:99], 0
    v_exp_f32 v80, v80
    v_exp_f32 v81, v81
    v_exp_f32 v82, v82
    v_exp_f32 v83, v83
    v_cvt_pk_bf16_f32 v132, v80, v81
    v_cvt_pk_bf16_f32 v133, v82, v83
    v_mfma_f32_32x32x16_bf16 v[224:239], v[152:155], v[136:139], v[224:239]
    s_mov_b32 exec_hi, 0xff
    s_add_u32 s42, s63, 0
    buffer_load_dwordx4 v[172:175], v10, s[24:27], s42 offen sc1
    s_add_u32 s42, s63, 5120
    buffer_load_dwordx4 v[176:179], v10, s[24:27], s42 offen sc1
    s_add_u32 s42, s63, 10240
    buffer_load_dwordx4 v[180:183], v10, s[24:27], s42 offen sc1
    s_add_u32 s42, s63, 15360
    buffer_load_dwordx4 v[184:187], v10, s[24:27], s42 offen sc1
    s_mov_b32 exec_hi, -1
    v_exp_f32 v84, v84
    v_exp_f32 v85, v85
    v_exp_f32 v86, v86
    v_exp_f32 v87, v87
    v_cvt_pk_bf16_f32 v134, v84, v85
    v_cvt_pk_bf16_f32 v135, v86, v87
    v_mfma_f32_32x32x8_bf16 v[64:79], v[144:145], v[100:101], v[64:79]
    s_mov_b32 exec_hi, 0xff
    s_add_u32 s42, s63, 20480
    buffer_load_dwordx4 v[188:191], v10, s[24:27], s42 offen sc1
    s_add_u32 s42, s63, 25600
    buffer_load_dwordx4 v[192:195], v10, s[24:27], s42 offen sc1
    s_add_u32 s42, s63, 30720
    buffer_load_dwordx4 v[196:199], v10, s[24:27], s42 offen sc1
    s_add_u32 s42, s63, 35840
    buffer_load_dwordx4 v[200:203], v10, s[24:27], s42 offen sc1
    s_mov_b32 exec_hi, -1
    v_exp_f32 v88, v88
    v_exp_f32 v89, v89
    v_exp_f32 v90, v90
    v_exp_f32 v91, v91
    v_cvt_pk_bf16_f32 v136, v88, v89
    v_cvt_pk_bf16_f32 v137, v90, v91
    v_mfma_f32_32x32x16_bf16 v[240:255], v[148:151], v[132:135], v[240:255]
    ds_read_b128 v[148:151], v110 offset:22528
    v_exp_f32 v92, v92
    v_exp_f32 v93, v93
    v_exp_f32 v94, v94
    v_exp_f32 v95, v95
    v_cvt_pk_bf16_f32 v138, v92, v93
    v_cvt_pk_bf16_f32 v139, v94, v95
    s_setprio 1
    v_mfma_f32_32x32x16_bf16 v[80:95], v[140:143], v[102:105], 0
    ds_read2st64_b64 v[140:143], v108 offset0:55 offset1:56
    v_exp_f32 v64, v64
    v_exp_f32 v65, v65
    v_exp_f32 v66, v66
    v_exp_f32 v67, v67
    v_cvt_pk_bf16_f32 v132, v64, v65
    v_cvt_pk_bf16_f32 v133, v66, v67
    v_mfma_f32_32x32x16_bf16 v[240:255], v[152:155], v[136:139], v[240:255]
    ds_read_b128 v[152:155], v111 offset:22528
    v_exp_f32 v68, v68
    v_exp_f32 v69, v69
    v_exp_f32 v70, v70
    v_exp_f32 v71, v71
    v_cvt_pk_bf16_f32 v134, v68, v69
    v_cvt_pk_bf16_f32 v135, v70, v71
    s_add_u32 m0, s95, 43520
    s_add_u32 s42, s97, 25600
    v_mfma_f32_32x32x8_bf16 v[80:95], v[144:145], v[106:107], v[80:95]
    ds_read_b64 v[144:145], v109 offset:28160
    s_mov_b32 exec_hi, 0xff
    buffer_load_dwordx4 v119, s[72:75], s42 offen lds
    buffer_load_dwordx4 v116, s[72:75], s42 offen offset:640 lds
    s_mov_b32 exec_hi, -1
    v_exp_f32 v72, v72
    v_exp_f32 v73, v73
    v_exp_f32 v74, v74
    v_exp_f32 v75, v75
    v_cvt_pk_bf16_f32 v136, v72, v73
    v_cvt_pk_bf16_f32 v137, v74, v75
    s_waitcnt lgkmcnt(3)
    v_mfma_f32_32x32x16_bf16 v[224:239], v[148:151], v[132:135], v[224:239]
    v_exp_f32 v76, v76
    v_exp_f32 v77, v77
    v_exp_f32 v78, v78
    v_exp_f32 v79, v79
    v_cvt_pk_bf16_f32 v138, v76, v77
    v_cvt_pk_bf16_f32 v139, v78, v79
    s_waitcnt lgkmcnt(0)
    v_mfma_f32_32x32x16_bf16 v[64:79], v[140:143], v[96:99], 0
    v_exp_f32 v80, v80
    v_exp_f32 v81, v81
    v_exp_f32 v82, v82
    v_exp_f32 v83, v83
    v_cvt_pk_bf16_f32 v132, v80, v81
    v_cvt_pk_bf16_f32 v133, v82, v83
    v_mfma_f32_32x32x16_bf16 v[224:239], v[152:155], v[136:139], v[224:239]
    v_exp_f32 v84, v84
    v_exp_f32 v85, v85
    v_exp_f32 v86, v86
    v_exp_f32 v87, v87
    v_cvt_pk_bf16_f32 v134, v84, v85
    v_cvt_pk_bf16_f32 v135, v86, v87
    v_mfma_f32_32x32x8_bf16 v[64:79], v[144:145], v[100:101], v[64:79]
    v_exp_f32 v88, v88
    v_exp_f32 v89, v89
    v_exp_f32 v90, v90
    v_exp_f32 v91, v91
    v_cvt_pk_bf16_f32 v136, v88, v89
    v_cvt_pk_bf16_f32 v137, v90, v91
    v_mfma_f32_32x32x16_bf16 v[240:255], v[148:151], v[132:135], v[240:255]
    ds_read_b128 v[148:151], v110 offset:28160
    v_exp_f32 v92, v92
    v_exp_f32 v93, v93
    v_exp_f32 v94, v94
    v_exp_f32 v95, v95
    v_cvt_pk_bf16_f32 v138, v92, v93
    v_cvt_pk_bf16_f32 v139, v94, v95
    v_mfma_f32_32x32x16_bf16 v[80:95], v[140:143], v[102:105], 0
    ds_read2st64_b64 v[140:143], v108 offset0:66 offset1:67
    v_exp_f32 v64, v64
    v_exp_f32 v65, v65
    v_exp_f32 v66, v66
    v_exp_f32 v67, v67
    v_cvt_pk_bf16_f32 v132, v64, v65
    v_cvt_pk_bf16_f32 v133, v66, v67
    v_mfma_f32_32x32x16_bf16 v[240:255], v[152:155], v[136:139], v[240:255]
    ds_read_b128 v[152:155], v111 offset:28160
    v_exp_f32 v68, v68
    v_exp_f32 v69, v69
    v_exp_f32 v70, v70
    v_exp_f32 v71, v71
    v_cvt_pk_bf16_f32 v134, v68, v69
    v_cvt_pk_bf16_f32 v135, v70, v71
    v_mfma_f32_32x32x8_bf16 v[80:95], v[144:145], v[106:107], v[80:95]
    ds_read_b64 v[144:145], v109 offset:33792
    v_exp_f32 v72, v72
    v_exp_f32 v73, v73
    v_exp_f32 v74, v74
    v_exp_f32 v75, v75
    v_cvt_pk_bf16_f32 v136, v72, v73
    v_cvt_pk_bf16_f32 v137, v74, v75
    s_waitcnt lgkmcnt(3)
    v_mfma_f32_32x32x16_bf16 v[224:239], v[148:151], v[132:135], v[224:239]
    v_exp_f32 v76, v76
    v_exp_f32 v77, v77
    v_exp_f32 v78, v78
    v_exp_f32 v79, v79
    v_cvt_pk_bf16_f32 v138, v76, v77
    v_cvt_pk_bf16_f32 v139, v78, v79
    s_waitcnt lgkmcnt(0)
    s_setprio 0
    v_mfma_f32_32x32x16_bf16 v[64:79], v[140:143], v[96:99], 0
    v_exp_f32 v80, v80
    v_exp_f32 v81, v81
    v_exp_f32 v82, v82
    v_exp_f32 v83, v83
    v_cvt_pk_bf16_f32 v132, v80, v81
    v_cvt_pk_bf16_f32 v133, v82, v83
    v_mfma_f32_32x32x16_bf16 v[224:239], v[152:155], v[136:139], v[224:239]
    v_exp_f32 v84, v84
    v_exp_f32 v85, v85
    v_exp_f32 v86, v86
    v_exp_f32 v87, v87
    v_cvt_pk_bf16_f32 v134, v84, v85
    v_cvt_pk_bf16_f32 v135, v86, v87
    s_add_u32 m0, s95, 44800
    s_add_u32 s42, s97, 30720
    v_mfma_f32_32x32x8_bf16 v[64:79], v[144:145], v[100:101], v[64:79]
    s_mov_b32 exec_hi, 0xff
    buffer_load_dwordx4 v119, s[72:75], s42 offen lds
    buffer_load_dwordx4 v116, s[72:75], s42 offen offset:640 lds
    s_mov_b32 exec_hi, -1
    v_exp_f32 v88, v88
    v_exp_f32 v89, v89
    v_exp_f32 v90, v90
    v_exp_f32 v91, v91
    v_cvt_pk_bf16_f32 v136, v88, v89
    v_cvt_pk_bf16_f32 v137, v90, v91
L_ck_c:
    s_waitcnt vmcnt(10)
    v_pk_add_f32 v[172:173], v[172:173], v[176:177]
    v_pk_add_f32 v[174:175], v[174:175], v[178:179]
    s_waitcnt vmcnt(9)
    v_pk_add_f32 v[172:173], v[172:173], v[180:181]
    v_pk_add_f32 v[174:175], v[174:175], v[182:183]
    s_waitcnt vmcnt(8)
    v_pk_add_f32 v[172:173], v[172:173], v[184:185]
    v_pk_add_f32 v[174:175], v[174:175], v[186:187]
    s_waitcnt vmcnt(7)
    v_pk_add_f32 v[172:173], v[172:173], v[188:189]
    v_pk_add_f32 v[174:175], v[174:175], v[190:191]
    s_waitcnt vmcnt(6)
    v_pk_add_f32 v[172:173], v[172:173], v[192:193]
    v_pk_add_f32 v[174:175], v[174:175], v[194:195]
    s_waitcnt vmcnt(5)
    v_pk_add_f32 v[172:173], v[172:173], v[196:197]
    v_pk_add_f32 v[174:175], v[174:175], v[198:199]
    s_waitcnt vmcnt(4)
    v_pk_add_f32 v[172:173], v[172:173], v[200:201]
    v_pk_add_f32 v[174:175], v[174:175], v[202:203]
    v_cmp_u_f32 vcc, v172, v173
    v_cmp_u_f32 s[66:67], v174, v175
    v_cvt_pk_bf16_f32 v172, v172, v173
    v_cvt_pk_bf16_f32 v173, v174, v175
    s_nop 1
    s_or_b64 vcc, vcc, s[66:67]
    s_and_b32 vcc_hi, vcc_hi, 0xff
    s_cmp_eq_u64 vcc, 0
    s_cbranch_scc0 L_sl_c
L_ok_c:
    v_mfma_f32_32x32x16_bf16 v[240:255], v[148:151], v[132:135], v[240:255]
    ds_read_b128 v[148:151], v110 offset:33792
    s_mov_b32 exec_hi, 0xff
    ds_write_b64 v12, v[172:173]
    s_mov_b32 exec_hi, -1
    v_exp_f32 v92, v92
    v_exp_f32 v93, v93
    v_exp_f32 v94, v94
    v_exp_f32 v95, v95
    v_cvt_pk_bf16_f32 v138, v92, v93
    v_cvt_pk_bf16_f32 v139, v94, v95
    v_mfma_f32_32x32x16_bf16 v[80:95], v[140:143], v[102:105], 0
    ds_read2st64_b64 v[140:143], v108 offset0:77 offset1:78
    v_exp_f32 v64, v64
    v_exp_f32 v65, v65
    v_exp_f32 v66, v66
    v_exp_f32 v67, v67
    v_cvt_pk_bf16_f32 v132, v64, v65
    v_cvt_pk_bf16_f32 v133, v66, v67
    v_mfma_f32_32x32x16_bf16 v[240:255], v[152:155], v[136:139], v[240:255]
    ds_read_b128 v[152:155], v111 offset:33792
    v_exp_f32 v68, v68
    v_exp_f32 v69, v69
    v_exp_f32 v70, v70
    v_exp_f32 v71, v71
    v_cvt_pk_bf16_f32 v134, v68, v69
    v_cvt_pk_bf16_f32 v135, v70, v71
    v_mfma_f32_32x32x8_bf16 v[80:95], v[144:145], v[106:107], v[80:95]
    ds_read_b64 v[144:145], v109 offset:39424
    v_exp_f32 v72, v72
    v_exp_f32 v73, v73
    v_exp_f32 v74, v74
    v_exp_f32 v75, v75
    v_cvt_pk_bf16_f32 v136, v72, v73
    v_cvt_pk_bf16_f32 v137, v74, v75
    s_waitcnt lgkmcnt(4)
    v_mfma_f32_32x32x16_bf16 v[224:239], v[148:151], v[132:135], v[224:239]
    v_exp_f32 v76, v76
    v_exp_f32 v77, v77
    v_exp_f32 v78, v78
    v_exp_f32 v79, v79
    v_cvt_pk_bf16_f32 v138, v76, v77
    v_cvt_pk_bf16_f32 v139, v78, v79
    s_waitcnt lgkmcnt(0)
    s_waitcnt vmcnt(13) lgkmcnt(0)
    s_barrier
    s_setprio 3
    v_mfma_f32_32x32x16_bf16 v[64:79], v[140:143], v[96:99], 0
    ds_read_b64 v[176:177], v13 offset:0
    ds_read_b64 v[178:179], v13 offset:512
    ds_read_b64 v[180:181], v13 offset:1024
    ds_read_b64 v[182:183], v13 offset:1536
    ds_read_b64 v[184:185], v13 offset:2048
    v_exp_f32 v80, v80
    v_exp_f32 v81, v81
    v_exp_f32 v82, v82
    v_exp_f32 v83, v83
    v_cvt_pk_bf16_f32 v132, v80, v81
    v_cvt_pk_bf16_f32 v133, v82, v83
    v_mfma_f32_32x32x16_bf16 v[224:239], v[152:155], v[136:139], v[224:239]
    v_exp_f32 v84, v84
    v_exp_f32 v85, v85
    v_exp_f32 v86, v86
    v_exp_f32 v87, v87
    v_cvt_pk_bf16_f32 v134, v84, v85
    v_cvt_pk_bf16_f32 v135, v86, v87
    s_add_u32 m0, s88, 0
    s_add_u32 s58, s57, 61440
    v_mfma_f32_32x32x8_bf16 v[64:79], v[144:145], v[100:101], v[64:79]
    buffer_load_dwordx4 v112, s[24:27], s58 offen sc1 lds
    v_exp_f32 v88, v88
    v_exp_f32 v89, v89
    v_exp_f32 v90, v90
    v_exp_f32 v91, v91
    v_cvt_pk_bf16_f32 v136, v88, v89
    v_cvt_pk_bf16_f32 v137, v90, v91
    s_add_u32 m0, s89, 0
    v_mfma_f32_32x32x16_bf16 v[240:255], v[148:151], v[132:135], v[240:255]
    ds_read_b128 v[148:151], v110 offset:39424
    buffer_load_dwordx4 v113, s[24:27], s58 offen sc1 lds
    v_exp_f32 v92, v92
    v_exp_f32 v93, v93
    v_exp_f32 v94, v94
    v_exp_f32 v95, v95
    v_cvt_pk_bf16_f32 v138, v92, v93
    v_cvt_pk_bf16_f32 v139, v94, v95
    s_add_u32 m0, s90, 0
    v_mfma_f32_32x32x16_bf16 v[80:95], v[140:143], v[102:105], 0
    ds_read2st64_b64 v[140:143], v108 offset0:88 offset1:89
    buffer_load_dwordx4 v114, s[24:27], s58 offen sc1 lds
    v_exp_f32 v64, v64
    v_exp_f32 v65, v65
    v_exp_f32 v66, v66
    v_exp_f32 v67, v67
    v_cvt_pk_bf16_f32 v132, v64, v65
    v_cvt_pk_bf16_f32 v133, v66, v67
    v_mfma_f32_32x32x16_bf16 v[240:255], v[152:155], v[136:139], v[240:255]
    ds_read_b128 v[152:155], v111 offset:39424
    v_exp_f32 v68, v68
    v_exp_f32 v69, v69
    v_exp_f32 v70, v70
    s_waitcnt lgkmcnt(6)
    v_mfma_f32_32x32x16_bf16 v[32:47], v[176:179], v[160:163], 0
    v_exp_f32 v71, v71
    v_cvt_pk_bf16_f32 v134, v68, v69
    v_cvt_pk_bf16_f32 v135, v70, v71
    v_mfma_f32_32x32x8_bf16 v[80:95], v[144:145], v[106:107], v[80:95]
    ds_read_b64 v[144:145], v109 offset:45056
    v_exp_f32 v72, v72
    v_exp_f32 v73, v73
    v_exp_f32 v74, v74
    s_waitcnt lgkmcnt(5)
    v_mfma_f32_32x32x16_bf16 v[32:47], v[180:183], v[164:167], v[32:47]
    v_exp_f32 v75, v75
    v_cvt_pk_bf16_f32 v136, v72, v73
    v_cvt_pk_bf16_f32 v137, v74, v75
    s_add_u32 m0, s95, 0
    s_add_u32 s42, s97, 0
    s_waitcnt lgkmcnt(3)
    v_mfma_f32_32x32x16_bf16 v[224:239], v[148:151], v[132:135], v[224:239]
    s_mov_b32 exec_hi, 0xff
    buffer_load_dwordx4 v119, s[68:71], s42 offen lds
    buffer_load_dwordx4 v116, s[68:71], s42 offen offset:640 lds
    s_mov_b32 exec_hi, -1
    v_exp_f32 v76, v76
    v_exp_f32 v77, v77
    v_exp_f32 v78, v78
    v_mfma_f32_32x32x8_bf16 v[32:47], v[184:185], v[168:169], v[32:47]
    v_exp_f32 v79, v79
    v_cvt_pk_bf16_f32 v138, v76, v77
    v_cvt_pk_bf16_f32 v139, v78, v79
    s_waitcnt lgkmcnt(0)
    v_mfma_f32_32x32x16_bf16 v[64:79], v[140:143], v[96:99], 0
    v_exp_f32 v80, v80
    v_exp_f32 v81, v81
    v_exp_f32 v82, v82
    v_exp_f32 v83, v83
    v_cvt_pk_bf16_f32 v132, v80, v81
    v_cvt_pk_bf16_f32 v133, v82, v83
    v_mfma_f32_32x32x16_bf16 v[224:239], v[152:155], v[136:139], v[224:239]
    v_exp_f32 v84, v84
    v_exp_f32 v85, v85
    v_exp_f32 v86, v86
    v_exp_f32 v87, v87
    v_cvt_pk_bf16_f32 v134, v84, v85
    v_cvt_pk_bf16_f32 v135, v86, v87
    v_add_f32 v146, 0x358637bd, v44
    v_rcp_f32 v146, v146
    s_nop 0
    v_mul_f32 v146, v146, v18
    v_pk_mul_f32 v[32:33], v[32:33], v[146:147] op_sel_hi:[1,0]
    v_pk_mul_f32 v[34:35], v[34:35], v[146:147] op_sel_hi:[1,0]
    v_pk_mul_f32 v[36:37], v[36:37], v[146:147] op_sel_hi:[1,0]
    v_pk_mul_f32 v[38:39], v[38:39], v[146:147] op_sel_hi:[1,0]
    v_pk_mul_f32 v[40:41], v[40:41], v[146:147] op_sel_hi:[1,0]
    v_pk_mul_f32 v[42:43], v[42:43], v[146:147] op_sel_hi:[1,0]
    v_cvt_pk_bf16_f32 v48, v32, v33
    v_cvt_pk_bf16_f32 v49, v34, v35
    v_cvt_pk_bf16_f32 v50, v36, v37
    v_cvt_pk_bf16_f32 v51, v38, v39
    v_cvt_pk_bf16_f32 v52, v40, v41
    v_cvt_pk_bf16_f32 v53, v42, v43
    v_mfma_f32_32x32x8_bf16 v[64:79], v[144:145], v[100:101], v[64:79]
    buffer_store_dwordx4 v[48:51], v15, s[24:27], s98 offen sc1
    s_mov_b32 exec_hi, 0
    buffer_store_dwordx2 v[52:53], v14, s[24:27], s98 offen offset:512 sc1
    s_mov_b32 exec_hi, -1
    v_exp_f32 v88, v88
    v_exp_f32 v89, v89
    v_exp_f32 v90, v90
    v_exp_f32 v91, v91
    v_cvt_pk_bf16_f32 v136, v88, v89
    v_cvt_pk_bf16_f32 v137, v90, v91
    v_mfma_f32_32x32x16_bf16 v[240:255], v[148:151], v[132:135], v[240:255]
    ds_read_b128 v[148:151], v110 offset:45056
    v_exp_f32 v92, v92
    v_exp_f32 v93, v93
    v_exp_f32 v94, v94
    v_exp_f32 v95, v95
    v_cvt_pk_bf16_f32 v138, v92, v93
    v_cvt_pk_bf16_f32 v139, v94, v95
    s_setprio 2
    v_mfma_f32_32x32x16_bf16 v[80:95], v[140:143], v[102:105], 0
    ds_read2st64_b64 v[140:143], v108 offset0:99 offset1:100
    v_exp_f32 v64, v64
    v_exp_f32 v65, v65
    v_exp_f32 v66, v66
    v_exp_f32 v67, v67
    v_cvt_pk_bf16_f32 v132, v64, v65
    v_cvt_pk_bf16_f32 v133, v66, v67
    v_mfma_f32_32x32x16_bf16 v[240:255], v[152:155], v[136:139], v[240:255]
    ds_read_b128 v[152:155], v111 offset:45056
    v_exp_f32 v68, v68
    v_exp_f32 v69, v69
    v_exp_f32 v70, v70
    v_exp_f32 v71, v71
    v_cvt_pk_bf16_f32 v134, v68, v69
    v_cvt_pk_bf16_f32 v135, v70, v71
    v_mfma_f32_32x32x8_bf16 v[80:95], v[144:145], v[106:107], v[80:95]
    ds_read_b64 v[144:145], v109 offset:50688
    v_exp_f32 v72, v72
    v_exp_f32 v73, v73
    v_exp_f32 v74, v74
    v_exp_f32 v75, v75
    v_cvt_pk_bf16_f32 v136, v72, v73
    v_cvt_pk_bf16_f32 v137, v74, v75
    s_add_u32 m0, s95, 1280
    s_add_u32 s42, s97, 5120
    s_waitcnt lgkmcnt(3)
    v_mfma_f32_32x32x16_bf16 v[224:239], v[148:151], v[132:135], v[224:239]
    s_mov_b32 exec_hi, 0xff
    buffer_load_dwordx4 v119, s[68:71], s42 offen lds
    buffer_load_dwordx4 v116, s[68:71], s42 offen offset:640 lds
    s_mov_b32 exec_hi, -1
    v_exp_f32 v76, v76
    v_exp_f32 v77, v77
    v_exp_f32 v78, v78
    v_exp_f32 v79, v79
    v_cvt_pk_bf16_f32 v138, v76, v77
    v_cvt_pk_bf16_f32 v139, v78, v79
    s_waitcnt lgkmcnt(0)
    v_mfma_f32_32x32x16_bf16 v[64:79], v[140:143], v[96:99], 0
    v_exp_f32 v80, v80
    v_exp_f32 v81, v81
    v_exp_f32 v82, v82
    v_exp_f32 v83, v83
    v_cvt_pk_bf16_f32 v132, v80, v81
    v_cvt_pk_bf16_f32 v133, v82, v83
    v_mul_u32_u24 v130, 640, v19
    s_min_u32 s85, s80, s81
    s_min_u32 s42, s82, s83
    s_min_u32 s85, s85, s42
    v_mfma_f32_32x32x16_bf16 v[224:239], v[152:155], v[136:139], v[224:239]
    v_exp_f32 v84, v84
    v_exp_f32 v85, v85
    v_exp_f32 v86, v86
    v_exp_f32 v87, v87
    v_cvt_pk_bf16_f32 v134, v84, v85
    v_cvt_pk_bf16_f32 v135, v86, v87
    v_mfma_f32_32x32x8_bf16 v[64:79], v[144:145], v[100:101], v[64:79]
    v_exp_f32 v88, v88
    v_exp_f32 v89, v89
    v_exp_f32 v90, v90
    v_exp_f32 v91, v91
    v_cvt_pk_bf16_f32 v136, v88, v89
    v_cvt_pk_bf16_f32 v137, v90, v91
    v_mfma_f32_32x32x16_bf16 v[240:255], v[148:151], v[132:135], v[240:255]
    ds_read_b128 v[148:151], v110 offset:50688
    v_exp_f32 v92, v92
    v_exp_f32 v93, v93
    v_exp_f32 v94, v94
    v_exp_f32 v95, v95
    v_cvt_pk_bf16_f32 v138, v92, v93
    v_cvt_pk_bf16_f32 v139, v94, v95
    s_setprio 1
    v_mfma_f32_32x32x16_bf16 v[80:95], v[140:143], v[102:105], 0
    ds_read2st64_b64 v[140:143], v108 offset0:110 offset1:111
    v_exp_f32 v64, v64
    v_exp_f32 v65, v65
    v_exp_f32 v66, v66
    v_exp_f32 v67, v67
    v_cvt_pk_bf16_f32 v132, v64, v65
    v_cvt_pk_bf16_f32 v133, v66, v67
    v_mfma_f32_32x32x16_bf16 v[240:255], v[152:155], v[136:139], v[240:255]
    ds_read_b128 v[152:155], v111 offset:50688
    v_exp_f32 v68, v68
    v_exp_f32 v69, v69
    v_exp_f32 v70, v70
    v_exp_f32 v71, v71
    v_cvt_pk_bf16_f32 v134, v68, v69
    v_cvt_pk_bf16_f32 v135, v70, v71
    v_mfma_f32_32x32x8_bf16 v[80:95], v[144:145], v[106:107], v[80:95]
    ds_read_b64 v[144:145], v109 offset:56320
    v_exp_f32 v72, v72
    v_exp_f32 v73, v73
    v_exp_f32 v74, v74
    v_exp_f32 v75, v75
    v_cvt_pk_bf16_f32 v136, v72, v73
    v_cvt_pk_bf16_f32 v137, v74, v75
    s_waitcnt lgkmcnt(3)
    v_mfma_f32_32x32x16_bf16 v[224:239], v[148:151], v[132:135], v[224:239]
    v_exp_f32 v76, v76
    v_exp_f32 v77, v77
    v_exp_f32 v78, v78
    v_exp_f32 v79, v79
    v_cvt_pk_bf16_f32 v138, v76, v77
    v_cvt_pk_bf16_f32 v139, v78, v79
    s_waitcnt lgkmcnt(0)
    v_mfma_f32_32x32x16_bf16 v[64:79], v[140:143], v[96:99], 0
    v_exp_f32 v80, v80
    v_exp_f32 v81, v81
    v_exp_f32 v82, v82
    v_exp_f32 v83, v83
    v_cvt_pk_bf16_f32 v132, v80, v81
    v_cvt_pk_bf16_f32 v133, v82, v83
    v_mfma_f32_32x32x16_bf16 v[224:239], v[152:155], v[136:139], v[224:239]
    v_exp_f32 v84, v84
    v_exp_f32 v85, v85
    v_exp_f32 v86, v86
    v_exp_f32 v87, v87
    v_cvt_pk_bf16_f32 v134, v84, v85
    v_cvt_pk_bf16_f32 v135, v86, v87
    v_mfma_f32_32x32x8_bf16 v[64:79], v[144:145], v[100:101], v[64:79]
    v_exp_f32 v88, v88
    v_exp_f32 v89, v89
    v_exp_f32 v90, v90
    v_exp_f32 v91, v91
    v_cvt_pk_bf16_f32 v136, v88, v89
    v_cvt_pk_bf16_f32 v137, v90, v91
    v_mfma_f32_32x32x16_bf16 v[240:255], v[148:151], v[132:135], v[240:255]
    ds_read_b128 v[148:151], v110 offset:56320
    v_exp_f32 v92, v92
    v_exp_f32 v93, v93
    v_exp_f32 v94, v94
    v_exp_f32 v95, v95
    v_cvt_pk_bf16_f32 v138, v92, v93
    v_cvt_pk_bf16_f32 v139, v94, v95
    s_setprio 0
    v_mfma_f32_32x32x16_bf16 v[80:95], v[140:143], v[102:105], 0
    ds_read2st64_b64 v[140:143], v108 offset0:121 offset1:122
    v_exp_f32 v64, v64
    v_exp_f32 v65, v65
    v_exp_f32 v66, v66
    v_exp_f32 v67, v67
    v_cvt_pk_bf16_f32 v132, v64, v65
    v_cvt_pk_bf16_f32 v133, v66, v67
    v_mfma_f32_32x32x16_bf16 v[240:255], v[152:155], v[136:139], v[240:255]
    ds_read_b128 v[152:155], v111 offset:56320
    v_exp_f32 v68, v68
    v_exp_f32 v69, v69
    v_exp_f32 v70, v70
    v_exp_f32 v71, v71
    v_cvt_pk_bf16_f32 v134, v68, v69
    v_cvt_pk_bf16_f32 v135, v70, v71
    v_mfma_f32_32x32x8_bf16 v[80:95], v[144:145], v[106:107], v[80:95]
    ds_read_b64 v[144:145], v109 offset:61952
    v_exp_f32 v72, v72
    v_exp_f32 v73, v73
    v_exp_f32 v74, v74
    v_exp_f32 v75, v75
    v_cvt_pk_bf16_f32 v136, v72, v73
    v_cvt_pk_bf16_f32 v137, v74, v75
    s_waitcnt lgkmcnt(3)
    v_mfma_f32_32x32x16_bf16 v[224:239], v[148:151], v[132:135], v[224:239]
    v_exp_f32 v76, v76
    v_exp_f32 v77, v77
    v_exp_f32 v78, v78
    v_exp_f32 v79, v79
    v_cvt_pk_bf16_f32 v138, v76, v77
    v_cvt_pk_bf16_f32 v139, v78, v79
    s_waitcnt lgkmcnt(0)
    v_mfma_f32_32x32x16_bf16 v[64:79], v[140:143], v[96:99], 0
    v_exp_f32 v80, v80
    v_exp_f32 v81, v81
    v_exp_f32 v82, v82
    v_exp_f32 v83, v83
    v_cvt_pk_bf16_f32 v132, v80, v81
    v_cvt_pk_bf16_f32 v133, v82, v83
    v_mfma_f32_32x32x16_bf16 v[224:239], v[152:155], v[136:139], v[224:239]
    v_exp_f32 v84, v84
    v_exp_f32 v85, v85
    v_exp_f32 v86, v86
    v_exp_f32 v87, v87
    v_cvt_pk_bf16_f32 v134, v84, v85
    v_cvt_pk_bf16_f32 v135, v86, v87
    v_mfma_f32_32x32x8_bf16 v[64:79], v[144:145], v[100:101], v[64:79]
    v_exp_f32 v88, v88
    v_exp_f32 v89, v89
    v_exp_f32 v90, v90
    v_exp_f32 v91, v91
    v_cvt_pk_bf16_f32 v136, v88, v89
    v_cvt_pk_bf16_f32 v137, v90, v91
    v_mfma_f32_32x32x16_bf16 v[240:255], v[148:151], v[132:135], v[240:255]
    ds_read_b128 v[148:151], v110 offset:61952
    v_exp_f32 v92, v92
    v_exp_f32 v93, v93
    v_exp_f32 v94, v94
    v_exp_f32 v95, v95
    v_cvt_pk_bf16_f32 v138, v92, v93
    v_cvt_pk_bf16_f32 v139, v94, v95
    s_waitcnt vmcnt(6) lgkmcnt(0)
    s_barrier
    s_setprio 3
    v_mfma_f32_32x32x16_bf16 v[80:95], v[140:143], v[102:105], 0
    ds_read2st64_b64 v[140:143], v108 offset0:0 offset1:1
    v_exp_f32 v64, v64
    v_exp_f32 v65, v65
    v_exp_f32 v66, v66
    v_exp_f32 v67, v67
    v_cvt_pk_bf16_f32 v132, v64, v65
    v_cvt_pk_bf16_f32 v133, v66, v67
    v_mfma_f32_32x32x16_bf16 v[240:255], v[152:155], v[136:139], v[240:255]
    ds_read_b128 v[152:155], v111 offset:61952
    buffer_load_dword v26, v130, s[24:27], s85 offen offset:636 sc1
    v_exp_f32 v68, v68
    v_exp_f32 v69, v69
    v_exp_f32 v70, v70
    v_exp_f32 v71, v71
    v_cvt_pk_bf16_f32 v134, v68, v69
    v_cvt_pk_bf16_f32 v135, v70, v71
    s_add_u32 m0, s88, 22528
    s_add_u32 s58, s57, 143360
    v_mfma_f32_32x32x8_bf16 v[80:95], v[144:145], v[106:107], v[80:95]
    ds_read_b64 v[144:145], v109 offset:0
    buffer_load_dwordx4 v112, s[24:27], s58 offen sc1 lds
    v_exp_f32 v72, v72
    v_exp_f32 v73, v73
    v_exp_f32 v74, v74
    v_exp_f32 v75, v75
    v_cvt_pk_bf16_f32 v136, v72, v73
    v_cvt_pk_bf16_f32 v137, v74, v75
    s_add_u32 m0, s89, 22528
    v_mfma_f32_32x32x16_bf16 v[224:239], v[148:151], v[132:135], v[224:239]
    buffer_load_dwordx4 v113, s[24:27], s58 offen sc1 lds
    v_exp_f32 v76, v76
    v_exp_f32 v77, v77
    v_exp_f32 v78, v78
    v_exp_f32 v79, v79
    v_cvt_pk_bf16_f32 v138, v76, v77
    v_cvt_pk_bf16_f32 v139, v78, v79
    s_add_u32 m0, s90, 22528
    s_waitcnt lgkmcnt(0)
    v_mfma_f32_32x32x16_bf16 v[64:79], v[140:143], v[96:99], 0
    buffer_load_dwordx4 v114, s[24:27], s58 offen sc1 lds
    v_exp_f32 v80, v80
    v_exp_f32 v81, v81
    v_exp_f32 v82, v82
    v_exp_f32 v83, v83
    v_cvt_pk_bf16_f32 v132, v80, v81
    v_cvt_pk_bf16_f32 v133, v82, v83
    v_mfma_f32_32x32x16_bf16 v[224:239], v[152:155], v[136:139], v[224:239]
    v_exp_f32 v84, v84
    v_exp_f32 v85, v85
    v_exp_f32 v86, v86
    v_exp_f32 v87, v87
    v_cvt_pk_bf16_f32 v134, v84, v85
    v_cvt_pk_bf16_f32 v135, v86, v87
    v_mfma_f32_32x32x8_bf16 v[64:79], v[144:145], v[100:101], v[64:79]
    v_exp_f32 v88, v88
    v_exp_f32 v89, v89
    v_exp_f32 v90, v90
    v_exp_f32 v91, v91
    v_cvt_pk_bf16_f32 v136, v88, v89
    v_cvt_pk_bf16_f32 v137, v90, v91
    v_mfma_f32_32x32x16_bf16 v[240:255], v[148:151], v[132:135], v[240:255]
    ds_read_b128 v[148:151], v110 offset:0
    v_exp_f32 v92, v92
    v_exp_f32 v93, v93
    v_exp_f32 v94, v94
    v_exp_f32 v95, v95
    v_cvt_pk_bf16_f32 v138, v92, v93
    v_cvt_pk_bf16_f32 v139, v94, v95
    s_setprio 2
    v_mfma_f32_32x32x16_bf16 v[80:95], v[140:143], v[102:105], 0
    ds_read2st64_b64 v[140:143], v108 offset0:11 offset1:12
    v_exp_f32 v64, v64
    v_exp_f32 v65, v65
    v_exp_f32 v66, v66
    v_exp_f32 v67, v67
    v_cvt_pk_bf16_f32 v132, v64, v65
    v_cvt_pk_bf16_f32 v133, v66, v67
    v_mfma_f32_32x32x16_bf16 v[240:255], v[152:155], v[136:139], v[240:255]
    ds_read_b128 v[152:155], v111 offset:0
    v_exp_f32 v68, v68
    v_exp_f32 v69, v69
    v_exp_f32 v70, v70
    v_exp_f32 v71, v71
    v_cvt_pk_bf16_f32 v134, v68, v69
    v_cvt_pk_bf16_f32 v135, v70, v71
    v_mfma_f32_32x32x8_bf16 v[80:95], v[144:145], v[106:107], v[80:95]
    ds_read_b64 v[144:145], v109 offset:5632
    v_exp_f32 v72, v72
    v_exp_f32 v73, v73
    v_exp_f32 v74, v74
    v_exp_f32 v75, v75
    v_cvt_pk_bf16_f32 v136, v72, v73
    v_cvt_pk_bf16_f32 v137, v74, v75
    s_waitcnt lgkmcnt(3)
    v_mfma_f32_32x32x16_bf16 v[224:239], v[148:151], v[132:135], v[224:239]
    v_exp_f32 v76, v76
    v_exp_f32 v77, v77
    v_exp_f32 v78, v78
    v_exp_f32 v79, v79
    v_cvt_pk_bf16_f32 v138, v76, v77
    v_cvt_pk_bf16_f32 v139, v78, v79
    s_waitcnt lgkmcnt(0)
    v_mfma_f32_32x32x16_bf16 v[64:79], v[140:143], v[96:99], 0
    v_exp_f32 v80, v80
    v_exp_f32 v81, v81
    v_exp_f32 v82, v82
    v_exp_f32 v83, v83
    v_cvt_pk_bf16_f32 v132, v80, v81
    v_cvt_pk_bf16_f32 v133, v82, v83
    v_mfma_f32_32x32x16_bf16 v[224:239], v[152:155], v[136:139], v[224:239]
L_ck_d:
    s_waitcnt vmcnt(3)
    v_cmp_eq_u32 vcc, -1, v26
    s_nop 3
    s_cmp_eq_u64 vcc, 0
    s_cbranch_scc0 L_sl_d
L_ok_d:
    buffer_load_dwordx4 v[172:175], v128, s[24:27], s80 offen offset:0 sc1
    v_exp_f32 v84, v84
    v_exp_f32 v85, v85
    v_exp_f32 v86, v86
    v_exp_f32 v87, v87
    v_cvt_pk_bf16_f32 v134, v84, v85
    v_cvt_pk_bf16_f32 v135, v86, v87
    v_mfma_f32_32x32x8_bf16 v[64:79], v[144:145], v[100:101], v[64:79]
    buffer_load_dwordx4 v[176:179], v128, s[24:27], s80 offen offset:1280 sc1
    v_exp_f32 v88, v88
    v_exp_f32 v89, v89
    v_exp_f32 v90, v90
    v_exp_f32 v91, v91
    v_cvt_pk_bf16_f32 v136, v88, v89
    v_cvt_pk_bf16_f32 v137, v90, v91
    v_mfma_f32_32x32x16_bf16 v[240:255], v[148:151], v[132:135], v[240:255]
    ds_read_b128 v[148:151], v110 offset:5632
    buffer_load_dwordx4 v[180:183], v128, s[24:27], s80 offen offset:2560 sc1
    v_exp_f32 v92, v92
    v_exp_f32 v93, v93
    v_exp_f32 v94, v94
    v_exp_f32 v95, v95
    v_cvt_pk_bf16_f32 v138, v92, v93
    v_cvt_pk_bf16_f32 v139, v94, v95
    s_setprio 1
    v_mfma_f32_32x32x16_bf16 v[80:95], v[140:143], v[102:105], 0
    ds_read2st64_b64 v[140:143], v108 offset0:22 offset1:23
    buffer_load_dwordx4 v[184:187], v128, s[24:27], s80 offen offset:3840 sc1
    v_exp_f32 v64, v64
    v_exp_f32 v65, v65
    v_exp_f32 v66, v66
    v_exp_f32 v67, v67
    v_cvt_pk_bf16_f32 v132, v64, v65
    v_cvt_pk_bf16_f32 v133, v66, v67
    v_mfma_f32_32x32x16_bf16 v[240:255], v[152:155], v[136:139], v[240:255]
    ds_read_b128 v[152:155], v111 offset:5632
    buffer_load_dwordx2 v[188:189], v129, s[24:27], s80 offen offset:512 sc1
    buffer_load_dwordx2 v[190:191], v129, s[24:27], s80 offen offset:3072 sc1
    v_exp_f32 v68, v68
    v_exp_f32 v69, v69
    v_exp_f32 v70, v70
    v_exp_f32 v71, v71
    v_cvt_pk_bf16_f32 v134, v68, v69
    v_cvt_pk_bf16_f32 v135, v70, v71
    v_mfma_f32_32x32x8_bf16 v[80:95], v[144:145], v[106:107], v[80:95]
    ds_read_b64 v[144:145], v109 offset:11264
    v_exp_f32 v72, v72
    v_exp_f32 v73, v73
    v_exp_f32 v74, v74
    v_exp_f32 v75, v75
    v_cvt_pk_bf16_f32 v136, v72, v73
    v_cvt_pk_bf16_f32 v137, v74, v75
    s_add_u32 m0, s95, 2560
    s_add_u32 s42, s97, 25600
    s_waitcnt lgkmcnt(3)
    v_mfma_f32_32x32x16_bf16 v[224:239], v[148:151], v[132:135], v[224:239]
    s_mov_b32 exec_hi, 0xff
    buffer_load_dwordx4 v119, s[68:71], s42 offen lds
    buffer_load_dwordx4 v116, s[68:71], s42 offen offset:640 lds
    s_mov_b32 exec_hi, -1
    v_exp_f32 v76, v76
    v_exp_f32 v77, v77
    v_exp_f32 v78, v78
    v_exp_f32 v79, v79
    v_cvt_pk_bf16_f32 v138, v76, v77
    v_cvt_pk_bf16_f32 v139, v78, v79
    s_waitcnt lgkmcnt(0)
    v_mfma_f32_32x32x16_bf16 v[64:79], v[140:143], v[96:99], 0
    v_exp_f32 v80, v80
    v_exp_f32 v81, v81
    v_exp_f32 v82, v82
    v_exp_f32 v83, v83
    v_cvt_pk_bf16_f32 v132, v80, v81
    v_cvt_pk_bf16_f32 v133, v82, v83
    v_mfma_f32_32x32x16_bf16 v[224:239], v[152:155], v[136:139], v[224:239]
    v_exp_f32 v84, v84
    v_exp_f32 v85, v85
    v_exp_f32 v86, v86
    v_exp_f32 v87, v87
    v_cvt_pk_bf16_f32 v134, v84, v85
    v_cvt_pk_bf16_f32 v135, v86, v87
    v_mfma_f32_32x32x8_bf16 v[64:79], v[144:145], v[100:101], v[64:79]
    v_exp_f32 v88, v88
    v_exp_f32 v89, v89
    v_exp_f32 v90, v90
    v_exp_f32 v91, v91
    v_cvt_pk_bf16_f32 v136, v88, v89
    v_cvt_pk_bf16_f32 v137, v90, v91
    v_mfma_f32_32x32x16_bf16 v[240:255], v[148:151], v[132:135], v[240:255]
    ds_read_b128 v[148:151], v110 offset:11264
    v_exp_f32 v92, v92
    v_exp_f32 v93, v93
    v_exp_f32 v94, v94
    v_exp_f32 v95, v95
    v_cvt_pk_bf16_f32 v138, v92, v93
    v_cvt_pk_bf16_f32 v139, v94, v95
    s_setprio 0
    v_mfma_f32_32x32x16_bf16 v[80:95], v[140:143], v[102:105], 0
    ds_read2st64_b64 v[140:143], v108 offset0:33 offset1:34
    v_exp_f32 v64, v64
    v_exp_f32 v65, v65
    v_exp_f32 v66, v66
    v_exp_f32 v67, v67
    v_cvt_pk_bf16_f32 v132, v64, v65
    v_cvt_pk_bf16_f32 v133, v66, v67
    v_mfma_f32_32x32x16_bf16 v[240:255], v[152:155], v[136:139], v[240:255]
    ds_read_b128 v[152:155], v111 offset:11264
    buffer_load_dwordx4 v[192:195], v128, s[24:27], s81 offen offset:0 sc1
    v_exp_f32 v68, v68
    v_exp_f32 v69, v69
    v_exp_f32 v70, v70
    v_exp_f32 v71, v71
    v_cvt_pk_bf16_f32 v134, v68, v69
    v_cvt_pk_bf16_f32 v135, v70, v71
    v_mfma_f32_32x32x8_bf16 v[80:95], v[144:145], v[106:107], v[80:95]
    ds_read_b64 v[144:145], v109 offset:16896
    buffer_load_dwordx4 v[196:199], v128, s[24:27], s81 offen offset:1280 sc1
    v_exp_f32 v72, v72
    v_exp_f32 v73, v73
    v_exp_f32 v74, v74
    v_exp_f32 v75, v75
    v_cvt_pk_bf16_f32 v136, v72, v73
    v_cvt_pk_bf16_f32 v137, v74, v75
    s_waitcnt lgkmcnt(3)
    v_mfma_f32_32x32x16_bf16 v[224:239], v[148:151], v[132:135], v[224:239]
    buffer_load_dwordx4 v[200:203], v128, s[24:27], s81 offen offset:2560 sc1
    v_exp_f32 v76, v76
    v_exp_f32 v77, v77
    v_exp_f32 v78, v78
    v_exp_f32 v79, v79
    v_cvt_pk_bf16_f32 v138, v76, v77
    v_cvt_pk_bf16_f32 v139, v78, v79
    s_waitcnt lgkmcnt(0)
    v_mfma_f32_32x32x16_bf16 v[64:79], v[140:143], v[96:99], 0
    buffer_load_dwordx4 v[204:207], v128, s[24:27], s81 offen offset:3840 sc1
    v_exp_f32 v80, v80
    v_exp_f32 v81, v81
    v_exp_f32 v82, v82
    v_exp_f32 v83, v83
    v_cvt_pk_bf16_f32 v132, v80, v81
    v_cvt_pk_bf16_f32 v133, v82, v83
    v_mfma_f32_32x32x16_bf16 v[224:239], v[152:155], v[136:139], v[224:239]
    buffer_load_dwordx2 v[208:209], v129, s[24:27], s81 offen offset:512 sc1
    buffer_load_dwordx2 v[210:211], v129, s[24:27], s81 offen offset:3072 sc1
    v_exp_f32 v84, v84
    v_exp_f32 v85, v85
    v_exp_f32 v86, v86
    v_exp_f32 v87, v87
    v_cvt_pk_bf16_f32 v134, v84, v85
    v_cvt_pk_bf16_f32 v135, v86, v87
    v_mfma_f32_32x32x8_bf16 v[64:79], v[144:145], v[100:101], v[64:79]
    v_exp_f32 v88, v88
    v_exp_f32 v89, v89
    v_exp_f32 v90, v90
    v_exp_f32 v91, v91
    v_cvt_pk_bf16_f32 v136, v88, v89
    v_cvt_pk_bf16_f32 v137, v90, v91
    s_add_u32 m0, s95, 3840
    s_add_u32 s42, s97, 30720
    v_mfma_f32_32x32x16_bf16 v[240:255], v[148:151], v[132:135], v[240:255]
    ds_read_b128 v[148:151], v110 offset:16896
    s_mov_b32 exec_hi, 0xff
    buffer_load_dwordx4 v119, s[68:71], s42 offen lds
    buffer_load_dwordx4 v116, s[68:71], s42 offen offset:640 lds
    s_mov_b32 exec_hi, -1
    v_exp_f32 v92, v92
    v_exp_f32 v93, v93
    v_exp_f32 v94, v94
    v_exp_f32 v95, v95
    v_cvt_pk_bf16_f32 v138, v92, v93
    v_cvt_pk_bf16_f32 v139, v94, v95
    s_waitcnt vmcnt(16) lgkmcnt(0)
    s_barrier
    s_setprio 3
    v_mfma_f32_32x32x16_bf16 v[80:95], v[140:143], v[102:105], 0
    ds_read2st64_b64 v[140:143], v108 offset0:44 offset1:45
    v_exp_f32 v64, v64
    v_exp_f32 v65, v65
    v_exp_f32 v66, v66
    v_exp_f32 v67, v67
    v_cvt_pk_bf16_f32 v132, v64, v65
    v_cvt_pk_bf16_f32 v133, v66, v67
    v_mfma_f32_32x32x16_bf16 v[240:255], v[152:155], v[136:139], v[240:255]
    ds_read_b128 v[152:155], v111 offset:16896
    v_exp_f32 v68, v68
    v_exp_f32 v69, v69
    v_exp_f32 v70, v70
    v_exp_f32 v71, v71
    v_cvt_pk_bf16_f32 v134, v68, v69
    v_cvt_pk_bf16_f32 v135, v70, v71
    v_mfma_f32_32x32x8_bf16 v[80:95], v[144:145], v[106:107], v[80:95]
    ds_read_b64 v[144:145], v109 offset:22528
    v_exp_f32 v72, v72
    v_exp_f32 v73, v73
    v_exp_f32 v74, v74
    v_exp_f32 v75, v75
    v_cvt_pk_bf16_f32 v136, v72, v73
    v_cvt_pk_bf16_f32 v137, v74, v75
    v_mfma_f32_32x32x16_bf16 v[224:239], v[148:151], v[132:135], v[224:239]
    v_exp_f32 v76, v76
    v_exp_f32 v77, v77
    v_exp_f32 v78, v78
    v_exp_f32 v79, v79
    v_cvt_pk_bf16_f32 v138, v76, v77
    v_cvt_pk_bf16_f32 v139, v78, v79
    s_waitcnt lgkmcnt(0)
    v_mfma_f32_32x32x16_bf16 v[64:79], v[140:143], v[96:99], 0
    v_exp_f32 v80, v80
    v_exp_f32 v81, v81
    v_exp_f32 v82, v82
    v_exp_f32 v83, v83
    v_cvt_pk_bf16_f32 v132, v80, v81
    v_cvt_pk_bf16_f32 v133, v82, v83
    v_mfma_f32_32x32x16_bf16 v[224:239], v[152:155], v[136:139], v[224:239]
    v_exp_f32 v84, v84
    v_exp_f32 v85, v85
    v_exp_f32 v86, v86
    v_exp_f32 v87, v87
    v_cvt_pk_bf16_f32 v134, v84, v85
    v_cvt_pk_bf16_f32 v135, v86, v87
    v_mfma_f32_32x32x8_bf16 v[64:79], v[144:145], v[100:101], v[64:79]
    v_exp_f32 v88, v88
    v_exp_f32 v89, v89
    v_exp_f32 v90, v90
    v_exp_f32 v91, v91
    v_cvt_pk_bf16_f32 v136, v88, v89
    v_cvt_pk_bf16_f32 v137, v90, v91
    s_add_u32 m0, s96, 0
    s_add_u32 s42, s97, 20480
    v_mfma_f32_32x32x16_bf16 v[240:255], v[148:151], v[132:135], v[240:255]
    ds_read_b128 v[148:151], v110 offset:22528
    s_mov_b32 exec_hi, 0xff
    buffer_load_dwordx4 v119, s[68:71], s42 offen lds
    s_mov_b32 exec_hi, -1
    v_exp_f32 v92, v92
    v_exp_f32 v93, v93
    v_exp_f32 v94, v94
    v_exp_f32 v95, v95
    v_cvt_pk_bf16_f32 v138, v92, v93
    v_cvt_pk_bf16_f32 v139, v94, v95
    s_setprio 2
    v_mfma_f32_32x32x16_bf16 v[80:95], v[140:143], v[102:105], 0
    ds_read2st64_b64 v[140:143], v108 offset0:55 offset1:56
    v_exp_f32 v64, v64
    v_exp_f32 v65, v65
    v_exp_f32 v66, v66
    v_exp_f32 v67, v67
    v_cvt_pk_bf16_f32 v132, v64, v65
    v_cvt_pk_bf16_f32 v133, v66, v67
    v_mfma_f32_32x32x16_bf16 v[240:255], v[152:155], v[136:139], v[240:255]
    ds_read_b128 v[152:155], v111 offset:22528
    buffer_load_dwordx4 v[32:35], v128, s[24:27], s82 offen offset:0 sc1
    v_exp_f32 v68, v68
    v_exp_f32 v69, v69
    v_exp_f32 v70, v70
    v_exp_f32 v71, v71
    v_cvt_pk_bf16_f32 v134, v68, v69
    v_cvt_pk_bf16_f32 v135, v70, v71
    v_mfma_f32_32x32x8_bf16 v[80:95], v[144:145], v[106:107], v[80:95]
    ds_read_b64 v[144:145], v109 offset:28160
    buffer_load_dwordx4 v[36:39], v128, s[24:27], s82 offen offset:1280 sc1
    v_exp_f32 v72, v72
    v_exp_f32 v73, v73
    v_exp_f32 v74, v74
    v_exp_f32 v75, v75
    v_cvt_pk_bf16_f32 v136, v72, v73
    v_cvt_pk_bf16_f32 v137, v74, v75
    s_waitcnt lgkmcnt(3)
    v_mfma_f32_32x32x16_bf16 v[224:239], v[148:151], v[132:135], v[224:239]
    buffer_load_dwordx4 v[40:43], v128, s[24:27], s82 offen offset:2560 sc1
    v_exp_f32 v76, v76
    v_exp_f32 v77, v77
    v_exp_f32 v78, v78
    v_exp_f32 v79, v79
    v_cvt_pk_bf16_f32 v138, v76, v77
    v_cvt_pk_bf16_f32 v139, v78, v79
    s_waitcnt lgkmcnt(0)
    v_mfma_f32_32x32x16_bf16 v[64:79], v[140:143], v[96:99], 0
    buffer_load_dwordx4 v[44:47], v128, s[24:27], s82 offen offset:3840 sc1
    v_exp_f32 v80, v80
    v_exp_f32 v81, v81
    v_exp_f32 v82, v82
    v_exp_f32 v83, v83
    v_cvt_pk_bf16_f32 v132, v80, v81
    v_cvt_pk_bf16_f32 v133, v82, v83
    v_mfma_f32_32x32x16_bf16 v[224:239], v[152:155], v[136:139], v[224:239]
    buffer_load_dwordx2 v[48:49], v129, s[24:27], s82 offen offset:512 sc1
    buffer_load_dwordx2 v[50:51], v129, s[24:27], s82 offen offset:3072 sc1
    v_exp_f32 v84, v84
    v_exp_f32 v85, v85
    v_exp_f32 v86, v86
    v_exp_f32 v87, v87
    v_cvt_pk_bf16_f32 v134, v84, v85
    v_cvt_pk_bf16_f32 v135, v86, v87
    v_mfma_f32_32x32x8_bf16 v[64:79], v[144:145], v[100:101], v[64:79]
    v_exp_f32 v88, v88
    v_exp_f32 v89, v89
    v_exp_f32 v90, v90
    v_exp_f32 v91, v91
    v_cvt_pk_bf16_f32 v136, v88, v89
    v_cvt_pk_bf16_f32 v137, v90, v91
    s_add_u32 m0, s96, 640
    s_add_u32 s42, s97, 46080
    v_mfma_f32_32x32x16_bf16 v[240:255], v[148:151], v[132:135], v[240:255]
    ds_read_b128 v[148:151], v110 offset:28160
    s_mov_b32 exec_hi, 0xff
    buffer_load_dwordx4 v119, s[68:71], s42 offen lds
    s_mov_b32 exec_hi, -1
    v_exp_f32 v92, v92
    v_exp_f32 v93, v93
    v_exp_f32 v94, v94
    v_exp_f32 v95, v95
    v_cvt_pk_bf16_f32 v138, v92, v93
    v_cvt_pk_bf16_f32 v139, v94, v95
    s_setprio 1
    v_mfma_f32_32x32x16_bf16 v[80:95], v[140:143], v[102:105], 0
    ds_read2st64_b64 v[140:143], v108 offset0:66 offset1:67
    v_exp_f32 v64, v64
    v_exp_f32 v65, v65
    v_exp_f32 v66, v66
    v_exp_f32 v67, v67
    v_cvt_pk_bf16_f32 v132, v64, v65
    v_cvt_pk_bf16_f32 v133, v66, v67
    v_mfma_f32_32x32x16_bf16 v[240:255], v[152:155], v[136:139], v[240:255]
    ds_read_b128 v[152:155], v111 offset:28160
    v_exp_f32 v68, v68
    v_exp_f32 v69, v69
    v_exp_f32 v70, v70
    v_exp_f32 v71, v71
    v_cvt_pk_bf16_f32 v134, v68, v69
    v_cvt_pk_bf16_f32 v135, v70, v71
    v_mfma_f32_32x32x8_bf16 v[80:95], v[144:145], v[106:107], v[80:95]
    ds_read_b64 v[144:145], v109 offset:33792
    v_exp_f32 v72, v72
    v_exp_f32 v73, v73
    v_exp_f32 v74, v74
    v_exp_f32 v75, v75
    v_cvt_pk_bf16_f32 v136, v72, v73
    v_cvt_pk_bf16_f32 v137, v74, v75
    s_add_u32 m0, s96, 10240
    s_add_u32 s42, s97, 20480
    s_waitcnt lgkmcnt(3)
    v_mfma_f32_32x32x16_bf16 v[224:239], v[148:151], v[132:135], v[224:239]
    s_mov_b32 exec_hi, 0xff
    buffer_load_dwordx4 v119, s[72:75], s42 offen lds
    s_mov_b32 exec_hi, -1
    v_exp_f32 v76, v76
    v_exp_f32 v77, v77
    v_exp_f32 v78, v78
    v_exp_f32 v79, v79
    v_cvt_pk_bf16_f32 v138, v76, v77
    v_cvt_pk_bf16_f32 v139, v78, v79
    s_waitcnt lgkmcnt(0)
    v_mfma_f32_32x32x16_bf16 v[64:79], v[140:143], v[96:99], 0
    v_exp_f32 v80, v80
    v_exp_f32 v81, v81
    v_exp_f32 v82, v82
    v_exp_f32 v83, v83
    v_cvt_pk_bf16_f32 v132, v80, v81
    v_cvt_pk_bf16_f32 v133, v82, v83
    v_mfma_f32_32x32x16_bf16 v[224:239], v[152:155], v[136:139], v[224:239]
    v_exp_f32 v84, v84
    v_exp_f32 v85, v85
    v_exp_f32 v86, v86
    v_exp_f32 v87, v87
    v_cvt_pk_bf16_f32 v134, v84, v85
    v_cvt_pk_bf16_f32 v135, v86, v87
    v_mfma_f32_32x32x8_bf16 v[64:79], v[144:145], v[100:101], v[64:79]
    v_exp_f32 v88, v88
    v_exp_f32 v89, v89
    v_exp_f32 v90, v90
    v_exp_f32 v91, v91
    v_cvt_pk_bf16_f32 v136, v88, v89
    v_cvt_pk_bf16_f32 v137, v90, v91
    s_add_u32 m0, s96, 10880
    s_add_u32 s42, s97, 46080
    v_mfma_f32_32x32x16_bf16 v[240:255], v[148:151], v[132:135], v[240:255]
    ds_read_b128 v[148:151], v110 offset:33792
    s_mov_b32 exec_hi, 0xff
    buffer_load_dwordx4 v119, s[72:75], s42 offen lds
    s_mov_b32 exec_hi, -1
    v_exp_f32 v92, v92
    v_exp_f32 v93, v93
    v_exp_f32 v94, v94
    v_exp_f32 v95, v95
    v_cvt_pk_bf16_f32 v138, v92, v93
    v_cvt_pk_bf16_f32 v139, v94, v95
    s_setprio 0
    v_mfma_f32_32x32x16_bf16 v[80:95], v[140:143], v[102:105], 0
    ds_read2st64_b64 v[140:143], v108 offset0:77 offset1:78
    v_exp_f32 v64, v64
    v_exp_f32 v65, v65
    v_exp_f32 v66, v66
    v_exp_f32 v67, v67
    v_cvt_pk_bf16_f32 v132, v64, v65
    v_cvt_pk_bf16_f32 v133, v66, v67
    v_mfma_f32_32x32x16_bf16 v[240:255], v[152:155], v[136:139], v[240:255]
    ds_read_b128 v[152:155], v111 offset:33792
    buffer_load_dwordx4 v[212:215], v128, s[24:27], s83 offen offset:0 sc1
    v_exp_f32 v68, v68
    v_exp_f32 v69, v69
    v_exp_f32 v70, v70
    v_exp_f32 v71, v71
    v_cvt_pk_bf16_f32 v134, v68, v69
    v_cvt_pk_bf16_f32 v135, v70, v71
    v_mfma_f32_32x32x8_bf16 v[80:95], v[144:145], v[106:107], v[80:95]
    ds_read_b64 v[144:145], v109 offset:39424
    buffer_load_dwordx4 v[216:219], v128, s[24:27], s83 offen offset:1280 sc1
    v_exp_f32 v72, v72
    v_exp_f32 v73, v73
    v_exp_f32 v74, v74
    v_exp_f32 v75, v75
    v_cvt_pk_bf16_f32 v136, v72, v73
    v_cvt_pk_bf16_f32 v137, v74, v75
    s_waitcnt lgkmcnt(3)
    v_mfma_f32_32x32x16_bf16 v[224:239], v[148:151], v[132:135], v[224:239]
    buffer_load_dwordx4 v[220:223], v128, s[24:27], s83 offen offset:2560 sc1
    v_exp_f32 v76, v76
    v_exp_f32 v77, v77
    v_exp_f32 v78, v78
    v_exp_f32 v79, v79
    v_cvt_pk_bf16_f32 v138, v76, v77
    v_cvt_pk_bf16_f32 v139, v78, v79
    s_waitcnt lgkmcnt(0)
    v_mfma_f32_32x32x16_bf16 v[64:79], v[140:143], v[96:99], 0
    buffer_load_dwordx4 v[52:55], v128, s[24:27], s83 offen offset:3840 sc1
    v_exp_f32 v80, v80
    v_exp_f32 v81, v81
    v_exp_f32 v82, v82
    v_exp_f32 v83, v83
    v_cvt_pk_bf16_f32 v132, v80, v81
    v_cvt_pk_bf16_f32 v133, v82, v83
    v_mfma_f32_32x32x16_bf16 v[224:239], v[152:155], v[136:139], v[224:239]
    buffer_load_dwordx2 v[56:57], v129, s[24:27], s83 offen offset:512 sc1
    buffer_load_dwordx2 v[58:59], v129, s[24:27], s83 offen offset:3072 sc1
    v_exp_f32 v84, v84
    v_exp_f32 v85, v85
    v_exp_f32 v86, v86
    v_exp_f32 v87, v87
    v_cvt_pk_bf16_f32 v134, v84, v85
    v_cvt_pk_bf16_f32 v135, v86, v87
    v_mfma_f32_32x32x8_bf16 v[64:79], v[144:145], v[100:101], v[64:79]
    v_exp_f32 v88, v88
    v_exp_f32 v89, v89
    v_exp_f32 v90, v90
    v_exp_f32 v91, v91
    v_cvt_pk_bf16_f32 v136, v88, v89
    v_cvt_pk_bf16_f32 v137, v90, v91
    v_mfma_f32_32x32x16_bf16 v[240:255], v[148:151], v[132:135], v[240:255]
    ds_read_b128 v[148:151], v110 offset:39424
    v_exp_f32 v92, v92
    v_exp_f32 v93, v93
    v_exp_f32 v94, v94
    v_exp_f32 v95, v95
    v_cvt_pk_bf16_f32 v138, v92, v93
    v_cvt_pk_bf16_f32 v139, v94, v95
    s_waitcnt vmcnt(6)
    s_barrier
    s_setprio 3
    v_mfma_f32_32x32x16_bf16 v[80:95], v[140:143], v[102:105], 0
    ds_read2st64_b64 v[140:143], v108 offset0:88 offset1:89
    v_exp_f32 v64, v64
    v_exp_f32 v65, v65
    v_exp_f32 v66, v66
    v_exp_f32 v67, v67
    v_cvt_pk_bf16_f32 v132, v64, v65
    v_cvt_pk_bf16_f32 v133, v66, v67
    v_mfma_f32_32x32x16_bf16 v[240:255], v[152:155], v[136:139], v[240:255]
    ds_read_b128 v[152:155], v111 offset:39424
    v_exp_f32 v68, v68
    v_exp_f32 v69, v69
    v_exp_f32 v70, v70
    v_exp_f32 v71, v71
    v_cvt_pk_bf16_f32 v134, v68, v69
    v_cvt_pk_bf16_f32 v135, v70, v71
    v_mfma_f32_32x32x8_bf16 v[80:95], v[144:145], v[106:107], v[80:95]
    ds_read_b64 v[144:145], v109 offset:45056
    v_exp_f32 v72, v72
    v_exp_f32 v73, v73
    v_exp_f32 v74, v74
    v_exp_f32 v75, v75
    v_cvt_pk_bf16_f32 v136, v72, v73
    v_cvt_pk_bf16_f32 v137, v74, v75
    s_waitcnt lgkmcnt(3)
    v_mfma_f32_32x32x16_bf16 v[224:239], v[148:151], v[132:135], v[224:239]
    v_exp_f32 v76, v76
    v_exp_f32 v77, v77
    v_exp_f32 v78, v78
    v_exp_f32 v79, v79
    v_cvt_pk_bf16_f32 v138, v76, v77
    v_cvt_pk_bf16_f32 v139, v78, v79
    s_waitcnt lgkmcnt(0)
    s_setprio 1
    v_mfma_f32_32x32x16_bf16 v[64:79], v[140:143], v[96:99], 0
    v_exp_f32 v80, v80
    v_exp_f32 v81, v81
    v_exp_f32 v82, v82
    v_exp_f32 v83, v83
    v_cvt_pk_bf16_f32 v132, v80, v81
    v_cvt_pk_bf16_f32 v133, v82, v83
    v_mfma_f32_32x32x16_bf16 v[224:239], v[152:155], v[136:139], v[224:239]
    v_exp_f32 v84, v84
    v_exp_f32 v85, v85
    v_exp_f32 v86, v86
    v_exp_f32 v87, v87
    v_cvt_pk_bf16_f32 v134, v84, v85
    v_cvt_pk_bf16_f32 v135, v86, v87
    v_mfma_f32_32x32x8_bf16 v[64:79], v[144:145], v[100:101], v[64:79]
    v_exp_f32 v88, v88
    v_exp_f32 v89, v89
    v_exp_f32 v90, v90
    v_exp_f32 v91, v91
    v_cvt_pk_bf16_f32 v136, v88, v89
    v_cvt_pk_bf16_f32 v137, v90, v91
    v_mfma_f32_32x32x16_bf16 v[240:255], v[148:151], v[132:135], v[240:255]
    ds_read_b128 v[148:151], v110 offset:45056
    v_exp_f32 v92, v92
    v_exp_f32 v93, v93
    v_exp_f32 v94, v94
    v_exp_f32 v95, v95
    v_cvt_pk_bf16_f32 v138, v92, v93
    v_cvt_pk_bf16_f32 v139, v94, v95
L_final:
    s_nop 1
    v_mfma_f32_32x32x16_bf16 v[240:255], v[152:155], v[136:139], v[240:255]
    s_setprio 0
    s_and_b32 s42, s34, 3
    s_lshl_b32 s42, s42, 12
    s_cmp_ge_u32 s34, 4
    s_cselect_b32 s43, 45056, 0
    v_add_u32 v2, s42, v20
    v_xor_b32 v3, 0x1000, v2
    v_add_u32 v2, s43, v2
    v_add_u32 v3, s43, v3
    s_add_u32 s44, s98, 20480
    v_sub_f32 v6, 1.0, v18
    s_lshl_b32 s43, s34, 2
    s_add_u32 s43, s43, 40960
    v_mov_b32 v8, s43
    ds_write_b128 v2, v[240:243] offset:0
    ds_write_b128 v2, v[244:247] offset:1024
    ds_write_b128 v2, v[248:251] offset:2048
    ds_write_b32 v2, v252 offset:3072
    s_waitcnt lgkmcnt(0)
    s_barrier
    ds_read_b32 v76, v3 offset:3072
    ds_read_b128 v[64:67], v3 offset:0
    ds_read_b128 v[68:71], v3 offset:1024
    ds_read_b128 v[72:75], v3 offset:2048
    v_lshrrev_b32 v9, 1, v17
    v_add_u32 v9, 40960, v9
    v_mov_b32 v4, 0x5f800000
    v_mov_b32 v7, 0x3b800000
    s_waitcnt lgkmcnt(3)
    v_add_f32 v236, v236, v76
    v_rcp_f32 v5, v236
    s_waitcnt lgkmcnt(2)
    v_pk_add_f32 v[224:225], v[224:225], v[64:65]
    v_pk_add_f32 v[226:227], v[226:227], v[66:67]
    s_waitcnt lgkmcnt(1)
    v_pk_add_f32 v[228:229], v[228:229], v[68:69]
    v_pk_add_f32 v[230:231], v[230:231], v[70:71]
    s_waitcnt lgkmcnt(0)
    v_pk_add_f32 v[232:233], v[232:233], v[72:73]
    v_pk_add_f32 v[234:235], v[234:235], v[74:75]
    v_mul_f32 v6, v5, v6
    v_pk_mul_f32 v[224:225], v[224:225], v[6:7] op_sel_hi:[1,0]
    v_pk_mul_f32 v[226:227], v[226:227], v[6:7] op_sel_hi:[1,0]
    v_pk_mul_f32 v[228:229], v[228:229], v[6:7] op_sel_hi:[1,0]
    v_pk_mul_f32 v[230:231], v[230:231], v[6:7] op_sel_hi:[1,0]
    v_pk_mul_f32 v[232:233], v[232:233], v[6:7] op_sel_hi:[1,0]
    v_pk_mul_f32 v[234:235], v[234:235], v[6:7] op_sel_hi:[1,0]
    v_cvt_pk_bf16_f32 v132, v224, v225
    v_cvt_pk_bf16_f32 v133, v226, v227
    v_cvt_pk_bf16_f32 v134, v228, v229
    v_cvt_pk_bf16_f32 v135, v230, v231
    v_cvt_pk_bf16_f32 v136, v232, v233
    v_cvt_pk_bf16_f32 v137, v234, v235
    v_cmp_le_f32 vcc, v236, v4
    v_cmp_ge_f32 s[66:67], v236, v7
    s_nop 3
    s_and_b64 vcc, vcc, s[66:67]
    s_cmp_eq_u64 vcc, -1
    s_cselect_b32 s42, 0, 1
    s_cbranch_scc1 L_pub
    s_cmp_lt_u32 s54, 16
    s_cbranch_scc1 L_nopub
L_pub:
    s_cmp_lg_u32 s65, 0
    s_cbranch_scc1 L_nopub
    s_mov_b32 s65, 1
    buffer_store_dwordx4 v[132:135], v15, s[24:27], s44 offen sc1
    s_mov_b32 exec_hi, 0
    buffer_store_dwordx2 v[136:137], v14, s[24:27], s44 offen offset:512 sc1
    s_mov_b64 exec, -1
L_nopub:
    v_mov_b32 v5, s42
    ds_write_b32 v8, v5
    v_lshrrev_b32 v2, 4, v1
    v_mul_u32_u24 v3, 160, v22
    v_add_u32 v3, v3, v21
    v_mul_u32_u24 v2, 640, v2
    v_add_u32 v2, v2, v3
    v_add_u32 v3, 1280, v2
    v_cndmask_b32 v3, v2, v3, s[50:51]
    s_add_u32 s42, s41, 0
    s_bfe_u32 s43, s42, 0x10001
    s_mul_i32 s43, s43, 80
    s_and_b32 s42, s42, 1
    s_mul_i32 s42, s42, 5120
    s_lshl_b32 s44, s42, 2
    s_add_u32 s44, s44, s43
    s_add_u32 s44, s44, 81920
    v_add_u32 v120, s44, v3
    s_add_u32 s42, s42, s43
    s_add_u32 s42, s42, 61440
    v_add_u32 v124, s42, v2
    s_add_u32 s42, s41, 1
    s_bfe_u32 s43, s42, 0x10001
    s_mul_i32 s43, s43, 80
    s_and_b32 s42, s42, 1
    s_mul_i32 s42, s42, 5120
    s_lshl_b32 s44, s42, 2
    s_add_u32 s44, s44, s43
    s_add_u32 s44, s44, 81920
    v_add_u32 v121, s44, v3
    s_add_u32 s42, s42, s43
    s_add_u32 s42, s42, 61440
    v_add_u32 v125, s42, v2
    s_add_u32 s42, s41, 2
    s_bfe_u32 s43, s42, 0x10001
    s_mul_i32 s43, s43, 80
    s_and_b32 s42, s42, 1
    s_mul_i32 s42, s42, 5120
    s_lshl_b32 s44, s42, 2
    s_add_u32 s44, s44, s43
    s_add_u32 s44, s44, 81920
    v_add_u32 v122, s44, v3
    s_add_u32 s42, s42, s43
    s_add_u32 s42, s42, 61440
    v_add_u32 v126, s42, v2
    s_add_u32 s42, s41, 3
    s_bfe_u32 s43, s42, 0x10001
    s_mul_i32 s43, s43, 80
    s_and_b32 s42, s42, 1
    s_mul_i32 s42, s42, 5120
    s_lshl_b32 s44, s42, 2
    s_add_u32 s44, s44, s43
    s_add_u32 s44, s44, 81920
    v_add_u32 v123, s44, v3
    s_add_u32 s42, s42, s43
    s_add_u32 s42, s42, 61440
    v_add_u32 v127, s42, v2
    s_add_u32 s45, s85, 20480
    s_waitcnt lgkmcnt(0)
    s_barrier
    ds_read_b32 v5, v9
    s_waitcnt lgkmcnt(0)
    v_cmp_ne_u32 vcc, 0, v5
    s_nop 3
    s_cmp_eq_u64 vcc, 0
    s_cbranch_scc1 L_good
    s_cmp_lt_u32 s54, 16
    s_cbranch_scc1 L_fallback
L_good:
    v_add_u32 v14, 20480, v128
    v_add_u32 v15, 20480, v129
    ds_read_b64_tr_b16 v[244:245], v120 offset:0
    ds_read_b64_tr_b16 v[246:247], v120 offset:1280
    ds_read_b64_tr_b16 v[248:249], v120 offset:32
    ds_read_b64_tr_b16 v[250:251], v120 offset:1312
    ds_read_b64_tr_b16 v[252:253], v120 offset:64
    ds_read_b64_tr_b16 v[254:255], v120 offset:1344
    ds_read_b64_tr_b16 v[152:153], v120 offset:5120
    ds_read_b64_tr_b16 v[154:155], v120 offset:6400
    ds_read_b64_tr_b16 v[156:157], v120 offset:5152
    ds_read_b64_tr_b16 v[158:159], v120 offset:6432
    ds_read_b64_tr_b16 v[116:117], v120 offset:5184
    ds_read_b64_tr_b16 v[118:119], v120 offset:6464
    s_waitcnt lgkmcnt(10)
    v_mfma_f32_16x16x32_bf16 v[160:163], v[244:247], v[172:175], 0
    ds_read_b64_tr_b16 v[2:3], v120 offset:10240
    ds_read_b64_tr_b16 v[4:5], v120 offset:11520
    s_waitcnt lgkmcnt(10)
    v_mfma_f32_16x16x32_bf16 v[164:167], v[248:251], v[172:175], 0
    ds_read_b64_tr_b16 v[6:7], v120 offset:10272
    ds_read_b64_tr_b16 v[8:9], v120 offset:11552
    s_waitcnt lgkmcnt(10)
    v_mfma_f32_16x16x32_bf16 v[168:171], v[252:255], v[172:175], 0
    ds_read_b64_tr_b16 v[10:11], v120 offset:10304
    ds_read_b64_tr_b16 v[12:13], v120 offset:11584
    s_waitcnt lgkmcnt(10)
    v_mfma_f32_16x16x32_bf16 v[160:163], v[152:155], v[176:179], v[160:163]
    ds_read_b64_tr_b16 v[244:245], v120 offset:15360
    ds_read_b64_tr_b16 v[246:247], v120 offset:16640
    s_waitcnt lgkmcnt(10)
    v_mfma_f32_16x16x32_bf16 v[164:167], v[156:159], v[176:179], v[164:167]
    ds_read_b64_tr_b16 v[248:249], v120 offset:15392
    ds_read_b64_tr_b16 v[250:251], v120 offset:16672
    s_waitcnt lgkmcnt(10)
    v_mfma_f32_16x16x32_bf16 v[168:171], v[116:119], v[176:179], v[168:171]
    ds_read_b64_tr_b16 v[252:253], v120 offset:15424
    ds_read_b64_tr_b16 v[254:255], v120 offset:16704
    s_waitcnt lgkmcnt(10)
    v_mfma_f32_16x16x32_bf16 v[160:163], v[2:5], v[180:183], v[160:163]
    ds_read_b64_tr_b16 v[152:153], v124 offset:0
    ds_read_b64_tr_b16 v[154:155], v124 offset:2560
    s_waitcnt lgkmcnt(10)
    v_mfma_f32_16x16x32_bf16 v[164:167], v[6:9], v[180:183], v[164:167]
    ds_read_b64_tr_b16 v[156:157], v124 offset:32
    ds_read_b64_tr_b16 v[158:159], v124 offset:2592
    s_waitcnt lgkmcnt(10)
    v_mfma_f32_16x16x32_bf16 v[168:171], v[10:13], v[180:183], v[168:171]
    ds_read_b64_tr_b16 v[116:117], v124 offset:64
    ds_read_b64_tr_b16 v[118:119], v124 offset:2624
    s_waitcnt lgkmcnt(10)
    v_mfma_f32_16x16x32_bf16 v[160:163], v[244:247], v[184:187], v[160:163]
    ds_read_b64_tr_b16 v[2:3], v121 offset:0
    ds_read_b64_tr_b16 v[4:5], v121 offset:1280
    buffer_load_dword v26, v130, s[24:27], s45 offen offset:636 sc1
    s_waitcnt lgkmcnt(10)
    v_mfma_f32_16x16x32_bf16 v[164:167], v[248:251], v[184:187], v[164:167]
    ds_read_b64_tr_b16 v[6:7], v121 offset:32
    ds_read_b64_tr_b16 v[8:9], v121 offset:1312
    s_waitcnt lgkmcnt(10)
    v_mfma_f32_16x16x32_bf16 v[168:171], v[252:255], v[184:187], v[168:171]
    ds_read_b64_tr_b16 v[10:11], v121 offset:64
    ds_read_b64_tr_b16 v[12:13], v121 offset:1344
    s_waitcnt lgkmcnt(10)
    v_mfma_f32_16x16x32_bf16 v[160:163], v[152:155], v[188:191], v[160:163]
    ds_read_b64_tr_b16 v[244:245], v121 offset:5120
    ds_read_b64_tr_b16 v[246:247], v121 offset:6400
    s_waitcnt lgkmcnt(10)
    v_mfma_f32_16x16x32_bf16 v[164:167], v[156:159], v[188:191], v[164:167]
    ds_read_b64_tr_b16 v[248:249], v121 offset:5152
    ds_read_b64_tr_b16 v[250:251], v121 offset:6432
    s_waitcnt lgkmcnt(10)
    v_mfma_f32_16x16x32_bf16 v[168:171], v[116:119], v[188:191], v[168:171]
    ds_read_b64_tr_b16 v[252:253], v121 offset:5184
    ds_read_b64_tr_b16 v[254:255], v121 offset:6464
    s_waitcnt lgkmcnt(10)
    v_mfma_f32_16x16x32_bf16 v[160:163], v[2:5], v[192:195], v[160:163]
    ds_read_b64_tr_b16 v[152:153], v121 offset:10240
    ds_read_b64_tr_b16 v[154:155], v121 offset:11520
    s_waitcnt lgkmcnt(10)
    v_mfma_f32_16x16x32_bf16 v[164:167], v[6:9], v[192:195], v[164:167]
    ds_read_b64_tr_b16 v[156:157], v121 offset:10272
    ds_read_b64_tr_b16 v[158:159], v121 offset:11552
    s_waitcnt lgkmcnt(10)
    v_mfma_f32_16x16x32_bf16 v[168:171], v[10:13], v[192:195], v[168:171]
    ds_read_b64_tr_b16 v[116:117], v121 offset:10304
    ds_read_b64_tr_b16 v[118:119], v121 offset:11584
    s_waitcnt lgkmcnt(10)
    v_mfma_f32_16x16x32_bf16 v[160:163], v[244:247], v[196:199], v[160:163]
    ds_read_b64_tr_b16 v[2:3], v121 offset:15360
    ds_read_b64_tr_b16 v[4:5], v121 offset:16640
    s_waitcnt lgkmcnt(10)
    v_mfma_f32_16x16x32_bf16 v[164:167], v[248:251], v[196:199], v[164:167]
    ds_read_b64_tr_b16 v[6:7], v121 offset:15392
    ds_read_b64_tr_b16 v[8:9], v121 offset:16672
    s_waitcnt lgkmcnt(10)
    v_mfma_f32_16x16x32_bf16 v[168:171], v[252:255], v[196:199], v[168:171]
    ds_read_b64_tr_b16 v[10:11], v121 offset:15424
    ds_read_b64_tr_b16 v[12:13], v121 offset:16704
    s_waitcnt lgkmcnt(10)
    v_mfma_f32_16x16x32_bf16 v[160:163], v[152:155], v[200:203], v[160:163]
    ds_read_b64_tr_b16 v[244:245], v125 offset:0
    ds_read_b64_tr_b16 v[246:247], v125 offset:2560
    s_waitcnt lgkmcnt(10)
    v_mfma_f32_16x16x32_bf16 v[164:167], v[156:159], v[200:203], v[164:167]
    ds_read_b64_tr_b16 v[248:249], v125 offset:32
    ds_read_b64_tr_b16 v[250:251], v125 offset:2592
    s_waitcnt lgkmcnt(10)
    v_mfma_f32_16x16x32_bf16 v[168:171], v[116:119], v[200:203], v[168:171]
    ds_read_b64_tr_b16 v[252:253], v125 offset:64
    ds_read_b64_tr_b16 v[254:255], v125 offset:2624
    s_waitcnt lgkmcnt(10)
    v_mfma_f32_16x16x32_bf16 v[160:163], v[2:5], v[204:207], v[160:163]
    ds_read_b64_tr_b16 v[152:153], v122 offset:0
    ds_read_b64_tr_b16 v[154:155], v122 offset:1280
    s_waitcnt lgkmcnt(10)
    v_mfma_f32_16x16x32_bf16 v[164:167], v[6:9], v[204:207], v[164:167]
    ds_read_b64_tr_b16 v[156:157], v122 offset:32
    ds_read_b64_tr_b16 v[158:159], v122 offset:1312
    s_waitcnt lgkmcnt(10)
    v_mfma_f32_16x16x32_bf16 v[168:171], v[10:13], v[204:207], v[168:171]
    ds_read_b64_tr_b16 v[116:117], v122 offset:64
    ds_read_b64_tr_b16 v[118:119], v122 offset:1344
    s_waitcnt lgkmcnt(10)
    v_mfma_f32_16x16x32_bf16 v[160:163], v[244:247], v[208:211], v[160:163]
    ds_read_b64_tr_b16 v[2:3], v122 offset:5120
    ds_read_b64_tr_b16 v[4:5], v122 offset:6400
    s_waitcnt lgkmcnt(10)
    v_mfma_f32_16x16x32_bf16 v[164:167], v[248:251], v[208:211], v[164:167]
    ds_read_b64_tr_b16 v[6:7], v122 offset:5152
    ds_read_b64_tr_b16 v[8:9], v122 offset:6432
    s_waitcnt lgkmcnt(10)
    v_mfma_f32_16x16x32_bf16 v[168:171], v[252:255], v[208:211], v[168:171]
    ds_read_b64_tr_b16 v[10:11], v122 offset:5184
    ds_read_b64_tr_b16 v[12:13], v122 offset:6464
    s_waitcnt lgkmcnt(10)
    v_mfma_f32_16x16x32_bf16 v[160:163], v[152:155], v[32:35], v[160:163]
    ds_read_b64_tr_b16 v[244:245], v122 offset:10240
    ds_read_b64_tr_b16 v[246:247], v122 offset:11520
L_ck_e:
    s_waitcnt vmcnt(0)
    v_cmp_eq_u32 vcc, -1, v26
    s_nop 3
    s_cmp_eq_u64 vcc, 0
    s_cbranch_scc0 L_sl_e
L_ok_e:
    buffer_load_dwordx4 v[64:67], v14, s[24:27], s80 offen offset:0 sc1
    s_waitcnt lgkmcnt(10)
    v_mfma_f32_16x16x32_bf16 v[164:167], v[156:159], v[32:35], v[164:167]
    ds_read_b64_tr_b16 v[248:249], v122 offset:10272
    ds_read_b64_tr_b16 v[250:251], v122 offset:11552
    buffer_load_dwordx4 v[68:71], v14, s[24:27], s80 offen offset:1280 sc1
    s_waitcnt lgkmcnt(10)
    v_mfma_f32_16x16x32_bf16 v[168:171], v[116:119], v[32:35], v[168:171]
    ds_read_b64_tr_b16 v[252:253], v122 offset:10304
    ds_read_b64_tr_b16 v[254:255], v122 offset:11584
    buffer_load_dwordx4 v[72:75], v14, s[24:27], s80 offen offset:2560 sc1
    s_waitcnt lgkmcnt(10)
    v_mfma_f32_16x16x32_bf16 v[160:163], v[2:5], v[36:39], v[160:163]
    ds_read_b64_tr_b16 v[152:153], v122 offset:15360
    ds_read_b64_tr_b16 v[154:155], v122 offset:16640
    buffer_load_dwordx4 v[76:79], v14, s[24:27], s80 offen offset:3840 sc1
    s_waitcnt lgkmcnt(10)
    v_mfma_f32_16x16x32_bf16 v[164:167], v[6:9], v[36:39], v[164:167]
    ds_read_b64_tr_b16 v[156:157], v122 offset:15392
    ds_read_b64_tr_b16 v[158:159], v122 offset:16672
    buffer_load_dwordx2 v[80:81], v15, s[24:27], s80 offen offset:512 sc1
    buffer_load_dwordx2 v[82:83], v15, s[24:27], s80 offen offset:3072 sc1
    s_waitcnt lgkmcnt(10)
    v_mfma_f32_16x16x32_bf16 v[168:171], v[10:13], v[36:39], v[168:171]
    ds_read_b64_tr_b16 v[116:117], v122 offset:15424
    ds_read_b64_tr_b16 v[118:119], v122 offset:16704
    buffer_load_dwordx4 v[84:87], v14, s[24:27], s81 offen offset:0 sc1
    s_waitcnt lgkmcnt(10)
    v_mfma_f32_16x16x32_bf16 v[160:163], v[244:247], v[40:43], v[160:163]
    ds_read_b64_tr_b16 v[2:3], v126 offset:0
    ds_read_b64_tr_b16 v[4:5], v126 offset:2560
    buffer_load_dwordx4 v[88:91], v14, s[24:27], s81 offen offset:1280 sc1
    s_waitcnt lgkmcnt(10)
    v_mfma_f32_16x16x32_bf16 v[164:167], v[248:251], v[40:43], v[164:167]
    ds_read_b64_tr_b16 v[6:7], v126 offset:32
    ds_read_b64_tr_b16 v[8:9], v126 offset:2592
    buffer_load_dwordx4 v[92:95], v14, s[24:27], s81 offen offset:2560 sc1
    s_waitcnt lgkmcnt(10)
    v_mfma_f32_16x16x32_bf16 v[168:171], v[252:255], v[40:43], v[168:171]
    ds_read_b64_tr_b16 v[10:11], v126 offset:64
    ds_read_b64_tr_b16 v[12:13], v126 offset:2624
    buffer_load_dwordx4 v[96:99], v14, s[24:27], s81 offen offset:3840 sc1
    s_waitcnt lgkmcnt(10)
    v_mfma_f32_16x16x32_bf16 v[160:163], v[152:155], v[44:47], v[160:163]
    ds_read_b64_tr_b16 v[244:245], v123 offset:0
    ds_read_b64_tr_b16 v[246:247], v123 offset:1280
    buffer_load_dwordx2 v[100:101], v15, s[24:27], s81 offen offset:512 sc1
    buffer_load_dwordx2 v[102:103], v15, s[24:27], s81 offen offset:3072 sc1
    s_waitcnt lgkmcnt(10)
    v_mfma_f32_16x16x32_bf16 v[164:167], v[156:159], v[44:47], v[164:167]
    ds_read_b64_tr_b16 v[248:249], v123 offset:32
    ds_read_b64_tr_b16 v[250:251], v123 offset:1312
    s_waitcnt lgkmcnt(10)
    v_mfma_f32_16x16x32_bf16 v[168:171], v[116:119], v[44:47], v[168:171]
    ds_read_b64_tr_b16 v[252:253], v123 offset:64
    ds_read_b64_tr_b16 v[254:255], v123 offset:1344
    s_waitcnt lgkmcnt(10)
    v_mfma_f32_16x16x32_bf16 v[160:163], v[2:5], v[48:51], v[160:163]
    ds_read_b64_tr_b16 v[152:153], v123 offset:5120
    ds_read_b64_tr_b16 v[154:155], v123 offset:6400
    s_waitcnt lgkmcnt(10)
    v_mfma_f32_16x16x32_bf16 v[164:167], v[6:9], v[48:51], v[164:167]
    ds_read_b64_tr_b16 v[156:157], v123 offset:5152
    ds_read_b64_tr_b16 v[158:159], v123 offset:6432
    s_waitcnt lgkmcnt(10)
    v_mfma_f32_16x16x32_bf16 v[168:171], v[10:13], v[48:51], v[168:171]
    ds_read_b64_tr_b16 v[116:117], v123 offset:5184
    ds_read_b64_tr_b16 v[118:119], v123 offset:6464
    s_waitcnt lgkmcnt(10)
    v_mfma_f32_16x16x32_bf16 v[160:163], v[244:247], v[212:215], v[160:163]
    ds_read_b64_tr_b16 v[2:3], v123 offset:10240
    ds_read_b64_tr_b16 v[4:5], v123 offset:11520
    s_waitcnt lgkmcnt(10)
    v_mfma_f32_16x16x32_bf16 v[164:167], v[248:251], v[212:215], v[164:167]
    ds_read_b64_tr_b16 v[6:7], v123 offset:10272
    ds_read_b64_tr_b16 v[8:9], v123 offset:11552
    s_waitcnt lgkmcnt(10)
    v_mfma_f32_16x16x32_bf16 v[168:171], v[252:255], v[212:215], v[168:171]
    ds_read_b64_tr_b16 v[10:11], v123 offset:10304
    ds_read_b64_tr_b16 v[12:13], v123 offset:11584
    s_waitcnt lgkmcnt(10)
    v_mfma_f32_16x16x32_bf16 v[160:163], v[152:155], v[216:219], v[160:163]
    ds_read_b64_tr_b16 v[244:245], v123 offset:15360
    ds_read_b64_tr_b16 v[246:247], v123 offset:16640
    s_waitcnt lgkmcnt(10)
    v_mfma_f32_16x16x32_bf16 v[164:167], v[156:159], v[216:219], v[164:167]
    ds_read_b64_tr_b16 v[248:249], v123 offset:15392
    ds_read_b64_tr_b16 v[250:251], v123 offset:16672
    s_waitcnt lgkmcnt(10)
    v_mfma_f32_16x16x32_bf16 v[168:171], v[116:119], v[216:219], v[168:171]
    ds_read_b64_tr_b16 v[252:253], v123 offset:15424
    ds_read_b64_tr_b16 v[254:255], v123 offset:16704
    s_waitcnt lgkmcnt(10)
    v_mfma_f32_16x16x32_bf16 v[160:163], v[2:5], v[220:223], v[160:163]
    ds_read_b64_tr_b16 v[152:153], v127 offset:0
    ds_read_b64_tr_b16 v[154:155], v127 offset:2560
    s_waitcnt lgkmcnt(10)
    v_mfma_f32_16x16x32_bf16 v[164:167], v[6:9], v[220:223], v[164:167]
    ds_read_b64_tr_b16 v[156:157], v127 offset:32
    ds_read_b64_tr_b16 v[158:159], v127 offset:2592
    s_waitcnt lgkmcnt(10)
    v_mfma_f32_16x16x32_bf16 v[168:171], v[10:13], v[220:223], v[168:171]
    ds_read_b64_tr_b16 v[116:117], v127 offset:64
    ds_read_b64_tr_b16 v[118:119], v127 offset:2624
    s_waitcnt lgkmcnt(10)
    v_mfma_f32_16x16x32_bf16 v[160:163], v[244:247], v[52:55], v[160:163]
    s_waitcnt lgkmcnt(8)
    v_mfma_f32_16x16x32_bf16 v[164:167], v[248:251], v[52:55], v[164:167]
    s_waitcnt lgkmcnt(6)
    v_mfma_f32_16x16x32_bf16 v[168:171], v[252:255], v[52:55], v[168:171]
    s_waitcnt lgkmcnt(4)
    v_mfma_f32_16x16x32_bf16 v[160:163], v[152:155], v[56:59], v[160:163]
    s_waitcnt lgkmcnt(2)
    v_mfma_f32_16x16x32_bf16 v[164:167], v[156:159], v[56:59], v[164:167]
    s_waitcnt lgkmcnt(0)
    v_mfma_f32_16x16x32_bf16 v[168:171], v[116:119], v[56:59], v[168:171]
    s_nop 5
    v_cmp_u_f32 vcc, v160, v160
    s_nop 3
    s_cmp_eq_u64 vcc, 0
    s_cbranch_scc0 L_redo_a
L_done_a:
    ds_read_b64_tr_b16 v[244:245], v120 offset:40960
    ds_read_b64_tr_b16 v[246:247], v120 offset:42240
    ds_read_b64_tr_b16 v[248:249], v120 offset:40992
    ds_read_b64_tr_b16 v[250:251], v120 offset:42272
    ds_read_b64_tr_b16 v[252:253], v120 offset:41024
    ds_read_b64_tr_b16 v[254:255], v120 offset:42304
    ds_read_b64_tr_b16 v[152:153], v120 offset:46080
    ds_read_b64_tr_b16 v[154:155], v120 offset:47360
    ds_read_b64_tr_b16 v[156:157], v120 offset:46112
    ds_read_b64_tr_b16 v[158:159], v120 offset:47392
    ds_read_b64_tr_b16 v[116:117], v120 offset:46144
    ds_read_b64_tr_b16 v[118:119], v120 offset:47424
    s_waitcnt vmcnt(11) lgkmcnt(10)
    v_mfma_f32_16x16x32_bf16 v[104:107], v[244:247], v[64:67], 0
    ds_read_b64_tr_b16 v[2:3], v120 offset:51200
    ds_read_b64_tr_b16 v[4:5], v120 offset:52480
    s_waitcnt lgkmcnt(10)
    v_mfma_f32_16x16x32_bf16 v[108:111], v[248:251], v[64:67], 0
    ds_read_b64_tr_b16 v[6:7], v120 offset:51232
    ds_read_b64_tr_b16 v[8:9], v120 offset:52512
    s_waitcnt lgkmcnt(10)
    v_mfma_f32_16x16x32_bf16 v[112:115], v[252:255], v[64:67], 0
    ds_read_b64_tr_b16 v[10:11], v120 offset:51264
    ds_read_b64_tr_b16 v[12:13], v120 offset:52544
    s_waitcnt vmcnt(10) lgkmcnt(10)
    v_mfma_f32_16x16x32_bf16 v[104:107], v[152:155], v[68:71], v[104:107]
    ds_read_b64_tr_b16 v[244:245], v120 offset:56320
    ds_read_b64_tr_b16 v[246:247], v120 offset:57600
    s_waitcnt lgkmcnt(10)
    v_mfma_f32_16x16x32_bf16 v[108:111], v[156:159], v[68:71], v[108:111]
    ds_read_b64_tr_b16 v[248:249], v120 offset:56352
    ds_read_b64_tr_b16 v[250:251], v120 offset:57632
    s_waitcnt lgkmcnt(10)
    v_mfma_f32_16x16x32_bf16 v[112:115], v[116:119], v[68:71], v[112:115]
    ds_read_b64_tr_b16 v[252:253], v120 offset:56384
    ds_read_b64_tr_b16 v[254:255], v120 offset:57664
    s_waitcnt vmcnt(9) lgkmcnt(10)
    v_mfma_f32_16x16x32_bf16 v[104:107], v[2:5], v[72:75], v[104:107]
    ds_read_b64_tr_b16 v[152:153], v124 offset:10240
    ds_read_b64_tr_b16 v[154:155], v124 offset:12800
    s_waitcnt lgkmcnt(10)
    v_mfma_f32_16x16x32_bf16 v[108:111], v[6:9], v[72:75], v[108:111]
    ds_read_b64_tr_b16 v[156:157], v124 offset:10272
    ds_read_b64_tr_b16 v[158:159], v124 offset:12832
    s_waitcnt lgkmcnt(10)
    v_mfma_f32_16x16x32_bf16 v[112:115], v[10:13], v[72:75], v[112:115]
    ds_read_b64_tr_b16 v[116:117], v124 offset:10304
    ds_read_b64_tr_b16 v[118:119], v124 offset:12864
    s_waitcnt vmcnt(8) lgkmcnt(10)
    v_mfma_f32_16x16x32_bf16 v[104:107], v[244:247], v[76:79], v[104:107]
    ds_read_b64_tr_b16 v[2:3], v121 offset:40960
    ds_read_b64_tr_b16 v[4:5], v121 offset:42240
    buffer_load_dwordx4 v[132:135], v14, s[24:27], s82 offen offset:0 sc1
    s_waitcnt lgkmcnt(10)
    v_mfma_f32_16x16x32_bf16 v[108:111], v[248:251], v[76:79], v[108:111]
    ds_read_b64_tr_b16 v[6:7], v121 offset:40992
    ds_read_b64_tr_b16 v[8:9], v121 offset:42272
    buffer_load_dwordx4 v[136:139], v14, s[24:27], s82 offen offset:1280 sc1
    s_waitcnt lgkmcnt(10)
    v_mfma_f32_16x16x32_bf16 v[112:115], v[252:255], v[76:79], v[112:115]
    ds_read_b64_tr_b16 v[10:11], v121 offset:41024
    ds_read_b64_tr_b16 v[12:13], v121 offset:42304
    buffer_load_dwordx4 v[140:143], v14, s[24:27], s82 offen offset:2560 sc1
    s_waitcnt vmcnt(9) lgkmcnt(10)
    v_mfma_f32_16x16x32_bf16 v[104:107], v[152:155], v[80:83], v[104:107]
    ds_read_b64_tr_b16 v[244:245], v121 offset:46080
    ds_read_b64_tr_b16 v[246:247], v121 offset:47360
    buffer_load_dwordx4 v[144:147], v14, s[24:27], s82 offen offset:3840 sc1
    s_waitcnt lgkmcnt(10)
    v_mfma_f32_16x16x32_bf16 v[108:111], v[156:159], v[80:83], v[108:111]
    ds_read_b64_tr_b16 v[248:249], v121 offset:46112
    ds_read_b64_tr_b16 v[250:251], v121 offset:47392
    buffer_load_dwordx2 v[148:149], v15, s[24:27], s82 offen offset:512 sc1
    buffer_load_dwordx2 v[150:151], v15, s[24:27], s82 offen offset:3072 sc1
    s_waitcnt lgkmcnt(10)
    v_mfma_f32_16x16x32_bf16 v[112:115], v[116:119], v[80:83], v[112:115]
    ds_read_b64_tr_b16 v[252:253], v121 offset:46144
    ds_read_b64_tr_b16 v[254:255], v121 offset:47424
    s_waitcnt vmcnt(11) lgkmcnt(10)
    v_mfma_f32_16x16x32_bf16 v[104:107], v[2:5], v[84:87], v[104:107]
    ds_read_b64_tr_b16 v[152:153], v121 offset:51200
    ds_read_b64_tr_b16 v[154:155], v121 offset:52480
    s_waitcnt lgkmcnt(10)
    v_mfma_f32_16x16x32_bf16 v[108:111], v[6:9], v[84:87], v[108:111]
    ds_read_b64_tr_b16 v[156:157], v121 offset:51232
    ds_read_b64_tr_b16 v[158:159], v121 offset:52512
    s_waitcnt lgkmcnt(10)
    v_mfma_f32_16x16x32_bf16 v[112:115], v[10:13], v[84:87], v[112:115]
    ds_read_b64_tr_b16 v[116:117], v121 offset:51264
    ds_read_b64_tr_b16 v[118:119], v121 offset:52544
    s_waitcnt vmcnt(10) lgkmcnt(10)
    v_mfma_f32_16x16x32_bf16 v[104:107], v[244:247], v[88:91], v[104:107]
    ds_read_b64_tr_b16 v[2:3], v121 offset:56320
    ds_read_b64_tr_b16 v[4:5], v121 offset:57600
    s_waitcnt lgkmcnt(10)
    v_mfma_f32_16x16x32_bf16 v[108:111], v[248:251], v[88:91], v[108:111]
    ds_read_b64_tr_b16 v[6:7], v121 offset:56352
    ds_read_b64_tr_b16 v[8:9], v121 offset:57632
    s_waitcnt lgkmcnt(10)
    v_mfma_f32_16x16x32_bf16 v[112:115], v[252:255], v[88:91], v[112:115]
    ds_read_b64_tr_b16 v[10:11], v121 offset:56384
    ds_read_b64_tr_b16 v[12:13], v121 offset:57664
    s_waitcnt vmcnt(9) lgkmcnt(10)
    v_mfma_f32_16x16x32_bf16 v[104:107], v[152:155], v[92:95], v[104:107]
    ds_read_b64_tr_b16 v[244:245], v125 offset:10240
    ds_read_b64_tr_b16 v[246:247], v125 offset:12800
    s_waitcnt lgkmcnt(10)
    v_mfma_f32_16x16x32_bf16 v[108:111], v[156:159], v[92:95], v[108:111]
    ds_read_b64_tr_b16 v[248:249], v125 offset:10272
    ds_read_b64_tr_b16 v[250:251], v125 offset:12832
    s_waitcnt lgkmcnt(10)
    v_mfma_f32_16x16x32_bf16 v[112:115], v[116:119], v[92:95], v[112:115]
    ds_read_b64_tr_b16 v[252:253], v125 offset:10304
    ds_read_b64_tr_b16 v[254:255], v125 offset:12864
    s_waitcnt vmcnt(8) lgkmcnt(10)
    v_mfma_f32_16x16x32_bf16 v[104:107], v[2:5], v[96:99], v[104:107]
    ds_read_b64_tr_b16 v[152:153], v122 offset:40960
    ds_read_b64_tr_b16 v[154:155], v122 offset:42240
    buffer_load_dwordx4 v[224:227], v14, s[24:27], s83 offen offset:0 sc1
    s_waitcnt lgkmcnt(10)
    v_mfma_f32_16x16x32_bf16 v[108:111], v[6:9], v[96:99], v[108:111]
    ds_read_b64_tr_b16 v[156:157], v122 offset:40992
    ds_read_b64_tr_b16 v[158:159], v122 offset:42272
    buffer_load_dwordx4 v[228:231], v14, s[24:27], s83 offen offset:1280 sc1
    s_waitcnt lgkmcnt(10)
    v_mfma_f32_16x16x32_bf16 v[112:115], v[10:13], v[96:99], v[112:115]
    ds_read_b64_tr_b16 v[116:117], v122 offset:41024
    ds_read_b64_tr_b16 v[118:119], v122 offset:42304
    buffer_load_dwordx4 v[232:235], v14, s[24:27], s83 offen offset:2560 sc1
    s_waitcnt vmcnt(9) lgkmcnt(10)
    v_mfma_f32_16x16x32_bf16 v[104:107], v[244:247], v[100:103], v[104:107]
    ds_read_b64_tr_b16 v[2:3], v122 offset:46080
    ds_read_b64_tr_b16 v[4:5], v122 offset:47360
    buffer_load_dwordx4 v[236:239], v14, s[24:27], s83 offen offset:3840 sc1
    s_waitcnt lgkmcnt(10)
    v_mfma_f32_16x16x32_bf16 v[108:111], v[248:251], v[100:103], v[108:111]
    ds_read_b64_tr_b16 v[6:7], v122 offset:46112
    ds_read_b64_tr_b16 v[8:9], v122 offset:47392
    buffer_load_dwordx2 v[240:241], v15, s[24:27], s83 offen offset:512 sc1
    buffer_load_dwordx2 v[242:243], v15, s[24:27], s83 offen offset:3072 sc1
    s_waitcnt lgkmcnt(10)
    v_mfma_f32_16x16x32_bf16 v[112:115], v[252:255], v[100:103], v[112:115]
    ds_read_b64_tr_b16 v[10:11], v122 offset:46144
    ds_read_b64_tr_b16 v[12:13], v122 offset:47424
    s_waitcnt vmcnt(11) lgkmcnt(10)
    v_mfma_f32_16x16x32_bf16 v[104:107], v[152:155], v[132:135], v[104:107]
    ds_read_b64_tr_b16 v[244:245], v122 offset:51200
    ds_read_b64_tr_b16 v[246:247], v122 offset:52480
    s_waitcnt lgkmcnt(10)
    v_mfma_f32_16x16x32_bf16 v[108:111], v[156:159], v[132:135], v[108:111]
    ds_read_b64_tr_b16 v[248:249], v122 offset:51232
    ds_read_b64_tr_b16 v[250:251], v122 offset:52512
    s_waitcnt lgkmcnt(10)
    v_mfma_f32_16x16x32_bf16 v[112:115], v[116:119], v[132:135], v[112:115]
    ds_read_b64_tr_b16 v[252:253], v122 offset:51264
    ds_read_b64_tr_b16 v[254:255], v122 offset:52544
    s_waitcnt vmcnt(10) lgkmcnt(10)
    v_mfma_f32_16x16x32_bf16 v[104:107], v[2:5], v[136:139], v[104:107]
    ds_read_b64_tr_b16 v[152:153], v122 offset:56320
    ds_read_b64_tr_b16 v[154:155], v122 offset:57600
    s_waitcnt lgkmcnt(10)
    v_mfma_f32_16x16x32_bf16 v[108:111], v[6:9], v[136:139], v[108:111]
    ds_read_b64_tr_b16 v[156:157], v122 offset:56352
    ds_read_b64_tr_b16 v[158:159], v122 offset:57632
    s_waitcnt lgkmcnt(10)
    v_mfma_f32_16x16x32_bf16 v[112:115], v[10:13], v[136:139], v[112:115]
    ds_read_b64_tr_b16 v[116:117], v122 offset:56384
    ds_read_b64_tr_b16 v[118:119], v122 offset:57664
    s_waitcnt vmcnt(9) lgkmcnt(10)
    v_mfma_f32_16x16x32_bf16 v[104:107], v[244:247], v[140:143], v[104:107]
    ds_read_b64_tr_b16 v[2:3], v126 offset:10240
    ds_read_b64_tr_b16 v[4:5], v126 offset:12800
    s_waitcnt lgkmcnt(10)
    v_mfma_f32_16x16x32_bf16 v[108:111], v[248:251], v[140:143], v[108:111]
    ds_read_b64_tr_b16 v[6:7], v126 offset:10272
    ds_read_b64_tr_b16 v[8:9], v126 offset:12832
    s_waitcnt lgkmcnt(10)
    v_mfma_f32_16x16x32_bf16 v[112:115], v[252:255], v[140:143], v[112:115]
    ds_read_b64_tr_b16 v[10:11], v126 offset:10304
    ds_read_b64_tr_b16 v[12:13], v126 offset:12864
    s_waitcnt vmcnt(8) lgkmcnt(10)
    v_mfma_f32_16x16x32_bf16 v[104:107], v[152:155], v[144:147], v[104:107]
    ds_read_b64_tr_b16 v[244:245], v123 offset:40960
    ds_read_b64_tr_b16 v[246:247], v123 offset:42240
    s_waitcnt lgkmcnt(10)
    v_mfma_f32_16x16x32_bf16 v[108:111], v[156:159], v[144:147], v[108:111]
    ds_read_b64_tr_b16 v[248:249], v123 offset:40992
    ds_read_b64_tr_b16 v[250:251], v123 offset:42272
    s_waitcnt lgkmcnt(10)
    v_mfma_f32_16x16x32_bf16 v[112:115], v[116:119], v[144:147], v[112:115]
    ds_read_b64_tr_b16 v[252:253], v123 offset:41024
    ds_read_b64_tr_b16 v[254:255], v123 offset:42304
    s_waitcnt vmcnt(6) lgkmcnt(10)
    v_mfma_f32_16x16x32_bf16 v[104:107], v[2:5], v[148:151], v[104:107]
    ds_read_b64_tr_b16 v[152:153], v123 offset:46080
    ds_read_b64_tr_b16 v[154:155], v123 offset:47360
    s_waitcnt lgkmcnt(10)
    v_mfma_f32_16x16x32_bf16 v[108:111], v[6:9], v[148:151], v[108:111]
    ds_read_b64_tr_b16 v[156:157], v123 offset:46112
    ds_read_b64_tr_b16 v[158:159], v123 offset:47392
    s_waitcnt lgkmcnt(10)
    v_mfma_f32_16x16x32_bf16 v[112:115], v[10:13], v[148:151], v[112:115]
    ds_read_b64_tr_b16 v[116:117], v123 offset:46144
    ds_read_b64_tr_b16 v[118:119], v123 offset:47424
    s_waitcnt vmcnt(5) lgkmcnt(10)
    v_mfma_f32_16x16x32_bf16 v[104:107], v[244:247], v[224:227], v[104:107]
    ds_read_b64_tr_b16 v[2:3], v123 offset:51200
    ds_read_b64_tr_b16 v[4:5], v123 offset:52480
    s_waitcnt lgkmcnt(10)
    v_mfma_f32_16x16x32_bf16 v[108:111], v[248:251], v[224:227], v[108:111]
    ds_read_b64_tr_b16 v[6:7], v123 offset:51232
    ds_read_b64_tr_b16 v[8:9], v123 offset:52512
    s_waitcnt lgkmcnt(10)
    v_mfma_f32_16x16x32_bf16 v[112:115], v[252:255], v[224:227], v[112:115]
    ds_read_b64_tr_b16 v[10:11], v123 offset:51264
    ds_read_b64_tr_b16 v[12:13], v123 offset:52544
    s_waitcnt vmcnt(4) lgkmcnt(10)
    v_mfma_f32_16x16x32_bf16 v[104:107], v[152:155], v[228:231], v[104:107]
    ds_read_b64_tr_b16 v[244:245], v123 offset:56320
    ds_read_b64_tr_b16 v[246:247], v123 offset:57600
    s_waitcnt lgkmcnt(10)
    v_mfma_f32_16x16x32_bf16 v[108:111], v[156:159], v[228:231], v[108:111]
    ds_read_b64_tr_b16 v[248:249], v123 offset:56352
    ds_read_b64_tr_b16 v[250:251], v123 offset:57632
    s_waitcnt lgkmcnt(10)
    v_mfma_f32_16x16x32_bf16 v[112:115], v[116:119], v[228:231], v[112:115]
    ds_read_b64_tr_b16 v[252:253], v123 offset:56384
    ds_read_b64_tr_b16 v[254:255], v123 offset:57664
    s_waitcnt vmcnt(3) lgkmcnt(10)
    v_mfma_f32_16x16x32_bf16 v[104:107], v[2:5], v[232:235], v[104:107]
    ds_read_b64_tr_b16 v[152:153], v127 offset:10240
    ds_read_b64_tr_b16 v[154:155], v127 offset:12800
    s_waitcnt lgkmcnt(10)
    v_mfma_f32_16x16x32_bf16 v[108:111], v[6:9], v[232:235], v[108:111]
    ds_read_b64_tr_b16 v[156:157], v127 offset:10272
    ds_read_b64_tr_b16 v[158:159], v127 offset:12832
    s_waitcnt lgkmcnt(10)
    v_mfma_f32_16x16x32_bf16 v[112:115], v[10:13], v[232:235], v[112:115]
    ds_read_b64_tr_b16 v[116:117], v127 offset:10304
    ds_read_b64_tr_b16 v[118:119], v127 offset:12864
    s_waitcnt vmcnt(2) lgkmcnt(10)
    v_mfma_f32_16x16x32_bf16 v[104:107], v[244:247], v[236:239], v[104:107]
    s_waitcnt lgkmcnt(8)
    v_mfma_f32_16x16x32_bf16 v[108:111], v[248:251], v[236:239], v[108:111]
    s_waitcnt lgkmcnt(6)
    v_mfma_f32_16x16x32_bf16 v[112:115], v[252:255], v[236:239], v[112:115]
    s_waitcnt vmcnt(0) lgkmcnt(4)
    v_mfma_f32_16x16x32_bf16 v[104:107], v[152:155], v[240:243], v[104:107]
    s_waitcnt lgkmcnt(2)
    v_mfma_f32_16x16x32_bf16 v[108:111], v[156:159], v[240:243], v[108:111]
    s_waitcnt lgkmcnt(0)
    v_mfma_f32_16x16x32_bf16 v[112:115], v[116:119], v[240:243], v[112:115]
    s_nop 5
    v_cmp_u_f32 vcc, v104, v104
    s_nop 3
    s_cmp_eq_u64 vcc, 0
    s_cbranch_scc0 L_redo_b
L_done_b:
    v_pk_add_f32 v[160:161], v[160:161], v[104:105]
    v_pk_add_f32 v[162:163], v[162:163], v[106:107]
    v_pk_add_f32 v[164:165], v[164:165], v[108:109]
    v_pk_add_f32 v[166:167], v[166:167], v[110:111]
    v_pk_add_f32 v[168:169], v[168:169], v[112:113]
    v_pk_add_f32 v[170:171], v[170:171], v[114:115]
    v_cvt_pk_bf16_f32 v2, v160, v161
    v_cvt_pk_bf16_f32 v3, v162, v163
    v_cvt_pk_bf16_f32 v4, v164, v165
    v_cvt_pk_bf16_f32 v5, v166, v167
    v_cvt_pk_bf16_f32 v6, v168, v169
    v_cvt_pk_bf16_f32 v7, v170, v171
    buffer_store_dwordx2 v[2:3], v131, s[76:79], s40 offen
    buffer_store_dwordx2 v[4:5], v131, s[76:79], s40 offen offset:32
    s_mov_b32 exec_hi, 0
    buffer_store_dwordx2 v[6:7], v131, s[76:79], s40 offen offset:64
    s_mov_b64 exec, -1
L_end:
    s_endpgm
    L_av0:
    s_cmp_eq_u32 s46, 0
    s_cbranch_scc1 L_ar0
    buffer_store_dwordx4 v[40:43], v32, s[24:27], s64 offen offset:1280 sc1
    s_branch L_ar0
    L_av1:
    s_cmp_eq_u32 s46, 0
    s_cbranch_scc1 L_ar1
    buffer_store_dwordx4 v[44:47], v32, s[24:27], s64 offen offset:1920 sc1
    s_branch L_ar1
    L_av2:
    s_cmp_eq_u32 s46, 0
    s_cbranch_scc1 L_ar2
    buffer_store_dwordx4 v[48:51], v33, s[24:27], s64 offen offset:1280 sc1
    s_branch L_ar2
    L_av3:
    s_cmp_eq_u32 s46, 0
    s_cbranch_scc1 L_ar3
    buffer_store_dwordx4 v[52:55], v33, s[24:27], s64 offen offset:1920 sc1
    s_branch L_ar3
L_sl_nonk:
    s_add_u32 s59, s59, 1
    s_cmp_gt_u32 s59, 20000
    s_cbranch_scc1 L_ok_nonk
    s_sleep 6
    buffer_load_dwordx2 v[24:25], v46, s[28:31], 0 offen sc1
    s_waitcnt vmcnt(0)
    s_branch L_ck_nonk
L_sl_ask:
    s_add_u32 s59, s59, 1
    s_cmp_gt_u32 s59, 20000
    s_cbranch_scc1 L_ok_ask
    s_sleep 6
    buffer_load_dwordx2 v[26:27], v30, s[24:27], s61 offen offset:0 sc1
    buffer_load_dwordx2 v[28:29], v31, s[24:27], s61 offen offset:0 sc1
    s_waitcnt vmcnt(0)
    s_branch L_ck_ask
L_sl_nonv:
    s_add_u32 s59, s59, 1
    s_cmp_gt_u32 s59, 20000
    s_cbranch_scc1 L_ok_nonv
    s_sleep 6
    buffer_load_dwordx2 v[24:25], v46, s[28:31], 0 offen sc1
    s_waitcnt vmcnt(0)
    s_branch L_ck_nonv
L_sl_asv:
    s_add_u32 s59, s59, 1
    s_cmp_gt_u32 s59, 20000
    s_cbranch_scc1 L_ok_asv
    s_sleep 6
    buffer_load_dwordx2 v[26:27], v30, s[24:27], s61 offen offset:0 sc1
    buffer_load_dwordx2 v[28:29], v31, s[24:27], s61 offen offset:0 sc1
    s_waitcnt vmcnt(0)
    s_branch L_ck_asv
L_sl_nong:
    s_add_u32 s59, s59, 1
    s_cmp_gt_u32 s59, 20000
    s_cbranch_scc1 L_ok_nong
    s_sleep 8
    buffer_load_dwordx2 v[24:25], v46, s[28:31], 0 offen sc1
    s_waitcnt vmcnt(0)
    s_branch L_ck_nong
L_sl_asg0:
    s_add_u32 s59, s59, 1
    s_cmp_gt_u32 s59, 20000
    s_cbranch_scc1 L_ok_asg0
    s_sleep 24
    buffer_load_dwordx2 v[26:27], v30, s[24:27], s61 offen offset:0 sc1
    buffer_load_dwordx2 v[28:29], v31, s[24:27], s61 offen offset:0 sc1
    s_waitcnt vmcnt(0)
    s_branch L_ck_asg0
L_sl_asg:
    s_add_u32 s59, s59, 1
    s_cmp_gt_u32 s59, 20000
    s_cbranch_scc1 L_ok_asg
    s_sleep 6
    buffer_load_dwordx2 v[26:27], v30, s[24:27], s61 offen offset:0 sc1
    buffer_load_dwordx2 v[28:29], v31, s[24:27], s61 offen offset:0 sc1
    s_waitcnt vmcnt(0)
    s_branch L_ck_asg
L_sl_b0:
    s_add_u32 s59, s59, 1
    s_cmp_gt_u32 s59, 20000
    s_cbranch_scc1 L_ok_b0
    s_sleep 6
    buffer_load_dwordx2 v[26:27], v30, s[24:27], s61 offen sc1
    s_waitcnt vmcnt(0)
    s_branch L_ck_b0
L_sl_b:
    s_add_u32 s59, s59, 1
    s_cmp_gt_u32 s59, 20000
    s_cbranch_scc1 L_ok_b
    s_sleep 6
    buffer_load_dwordx2 v[26:27], v30, s[24:27], s61 offen offset:0 sc1
    buffer_load_dwordx2 v[28:29], v31, s[24:27], s61 offen offset:0 sc1
    s_waitcnt vmcnt(0)
    s_branch L_ck_b
L_sl_a:
    s_add_u32 s59, s59, 1
    s_cmp_gt_u32 s59, 20000
    s_cbranch_scc1 L_ok_a
    s_sleep 6
    buffer_load_dwordx2 v[26:27], v130, s[24:27], s92 offen sc1
    s_waitcnt vmcnt(0)
    s_branch L_ck_a
L_sl_p:
    s_add_u32 s59, s59, 1
    s_cmp_gt_u32 s59, 20000
    s_cbranch_scc1 L_ok_p
    s_sleep 6
    buffer_load_dwordx2 v[26:27], v17, s[24:27], s62 offen sc1
    buffer_load_dwordx2 v[28:29], v130, s[24:27], s3 offen sc1
    s_waitcnt vmcnt(0)
    s_branch L_ck_p
L_sl_c:
    s_add_u32 s59, s59, 1
    s_cmp_gt_u32 s59, 20000
    s_cbranch_scc1 L_ok_c
    s_sleep 6
    s_mov_b32 exec_hi, 0xff
    s_add_u32 s42, s63, 0
    buffer_load_dwordx4 v[172:175], v10, s[24:27], s42 offen sc1
    s_add_u32 s42, s63, 5120
    buffer_load_dwordx4 v[176:179], v10, s[24:27], s42 offen sc1
    s_add_u32 s42, s63, 10240
    buffer_load_dwordx4 v[180:183], v10, s[24:27], s42 offen sc1
    s_add_u32 s42, s63, 15360
    buffer_load_dwordx4 v[184:187], v10, s[24:27], s42 offen sc1
    s_mov_b32 exec_hi, -1
    s_mov_b32 exec_hi, 0xff
    s_add_u32 s42, s63, 20480
    buffer_load_dwordx4 v[188:191], v10, s[24:27], s42 offen sc1
    s_add_u32 s42, s63, 25600
    buffer_load_dwordx4 v[192:195], v10, s[24:27], s42 offen sc1
    s_add_u32 s42, s63, 30720
    buffer_load_dwordx4 v[196:199], v10, s[24:27], s42 offen sc1
    s_add_u32 s42, s63, 35840
    buffer_load_dwordx4 v[200:203], v10, s[24:27], s42 offen sc1
    s_mov_b32 exec_hi, -1
    s_waitcnt vmcnt(0)
    s_branch L_ck_c
L_sl_d:
    s_add_u32 s59, s59, 1
    s_cmp_gt_u32 s59, 20000
    s_cbranch_scc1 L_ok_d
    s_sleep 6
    buffer_load_dword v26, v130, s[24:27], s85 offen offset:636 sc1
    s_waitcnt vmcnt(0)
    s_branch L_ck_d
L_sl_e:
    s_add_u32 s59, s59, 1
    s_cmp_gt_u32 s59, 20000
    s_cbranch_scc1 L_ok_e
    s_sleep 2
    buffer_load_dword v26, v130, s[24:27], s45 offen offset:636 sc1
    s_waitcnt vmcnt(0)
    s_branch L_ck_e
L_redo_a:
    s_add_u32 s59, s59, 1
    s_cmp_gt_u32 s59, 20000
    s_cbranch_scc1 L_done_a
    s_sleep 4
    buffer_load_dwordx4 v[172:175], v128, s[24:27], s80 offen offset:0 sc1
    buffer_load_dwordx4 v[176:179], v128, s[24:27], s80 offen offset:1280 sc1
    buffer_load_dwordx4 v[180:183], v128, s[24:27], s80 offen offset:2560 sc1
    buffer_load_dwordx4 v[184:187], v128, s[24:27], s80 offen offset:3840 sc1
    buffer_load_dwordx2 v[188:189], v129, s[24:27], s80 offen offset:512 sc1
    buffer_load_dwordx2 v[190:191], v129, s[24:27], s80 offen offset:3072 sc1
    buffer_load_dwordx4 v[192:195], v128, s[24:27], s81 offen offset:0 sc1
    buffer_load_dwordx4 v[196:199], v128, s[24:27], s81 offen offset:1280 sc1
    buffer_load_dwordx4 v[200:203], v128, s[24:27], s81 offen offset:2560 sc1
    buffer_load_dwordx4 v[204:207], v128, s[24:27], s81 offen offset:3840 sc1
    buffer_load_dwordx2 v[208:209], v129, s[24:27], s81 offen offset:512 sc1
    buffer_load_dwordx2 v[210:211], v129, s[24:27], s81 offen offset:3072 sc1
    buffer_load_dwordx4 v[32:35], v128, s[24:27], s82 offen offset:0 sc1
    buffer_load_dwordx4 v[36:39], v128, s[24:27], s82 offen offset:1280 sc1
    buffer_load_dwordx4 v[40:43], v128, s[24:27], s82 offen offset:2560 sc1
    buffer_load_dwordx4 v[44:47], v128, s[24:27], s82 offen offset:3840 sc1
    buffer_load_dwordx2 v[48:49], v129, s[24:27], s82 offen offset:512 sc1
    buffer_load_dwordx2 v[50:51], v129, s[24:27], s82 offen offset:3072 sc1
    buffer_load_dwordx4 v[212:215], v128, s[24:27], s83 offen offset:0 sc1
    buffer_load_dwordx4 v[216:219], v128, s[24:27], s83 offen offset:1280 sc1
    buffer_load_dwordx4 v[220:223], v128, s[24:27], s83 offen offset:2560 sc1
    buffer_load_dwordx4 v[52:55], v128, s[24:27], s83 offen offset:3840 sc1
    buffer_load_dwordx2 v[56:57], v129, s[24:27], s83 offen offset:512 sc1
    buffer_load_dwordx2 v[58:59], v129, s[24:27], s83 offen offset:3072 sc1
    ds_read_b64_tr_b16 v[244:245], v120 offset:0
    ds_read_b64_tr_b16 v[246:247], v120 offset:1280
    ds_read_b64_tr_b16 v[248:249], v120 offset:32
    ds_read_b64_tr_b16 v[250:251], v120 offset:1312
    ds_read_b64_tr_b16 v[252:253], v120 offset:64
    ds_read_b64_tr_b16 v[254:255], v120 offset:1344
    ds_read_b64_tr_b16 v[152:153], v120 offset:5120
    ds_read_b64_tr_b16 v[154:155], v120 offset:6400
    ds_read_b64_tr_b16 v[156:157], v120 offset:5152
    ds_read_b64_tr_b16 v[158:159], v120 offset:6432
    ds_read_b64_tr_b16 v[116:117], v120 offset:5184
    ds_read_b64_tr_b16 v[118:119], v120 offset:6464
    s_waitcnt vmcnt(23) lgkmcnt(10)
    v_mfma_f32_16x16x32_bf16 v[160:163], v[244:247], v[172:175], 0
    ds_read_b64_tr_b16 v[2:3], v120 offset:10240
    ds_read_b64_tr_b16 v[4:5], v120 offset:11520
    s_waitcnt lgkmcnt(10)
    v_mfma_f32_16x16x32_bf16 v[164:167], v[248:251], v[172:175], 0
    ds_read_b64_tr_b16 v[6:7], v120 offset:10272
    ds_read_b64_tr_b16 v[8:9], v120 offset:11552
    s_waitcnt lgkmcnt(10)
    v_mfma_f32_16x16x32_bf16 v[168:171], v[252:255], v[172:175], 0
    ds_read_b64_tr_b16 v[10:11], v120 offset:10304
    ds_read_b64_tr_b16 v[12:13], v120 offset:11584
    s_waitcnt vmcnt(22) lgkmcnt(10)
    v_mfma_f32_16x16x32_bf16 v[160:163], v[152:155], v[176:179], v[160:163]
    ds_read_b64_tr_b16 v[244:245], v120 offset:15360
    ds_read_b64_tr_b16 v[246:247], v120 offset:16640
    s_waitcnt lgkmcnt(10)
    v_mfma_f32_16x16x32_bf16 v[164:167], v[156:159], v[176:179], v[164:167]
    ds_read_b64_tr_b16 v[248:249], v120 offset:15392
    ds_read_b64_tr_b16 v[250:251], v120 offset:16672
    s_waitcnt lgkmcnt(10)
    v_mfma_f32_16x16x32_bf16 v[168:171], v[116:119], v[176:179], v[168:171]
    ds_read_b64_tr_b16 v[252:253], v120 offset:15424
    ds_read_b64_tr_b16 v[254:255], v120 offset:16704
    s_waitcnt vmcnt(21) lgkmcnt(10)
    v_mfma_f32_16x16x32_bf16 v[160:163], v[2:5], v[180:183], v[160:163]
    ds_read_b64_tr_b16 v[152:153], v124 offset:0
    ds_read_b64_tr_b16 v[154:155], v124 offset:2560
    s_waitcnt lgkmcnt(10)
    v_mfma_f32_16x16x32_bf16 v[164:167], v[6:9], v[180:183], v[164:167]
    ds_read_b64_tr_b16 v[156:157], v124 offset:32
    ds_read_b64_tr_b16 v[158:159], v124 offset:2592
    s_waitcnt lgkmcnt(10)
    v_mfma_f32_16x16x32_bf16 v[168:171], v[10:13], v[180:183], v[168:171]
    ds_read_b64_tr_b16 v[116:117], v124 offset:64
    ds_read_b64_tr_b16 v[118:119], v124 offset:2624
    s_waitcnt vmcnt(20) lgkmcnt(10)
    v_mfma_f32_16x16x32_bf16 v[160:163], v[244:247], v[184:187], v[160:163]
    ds_read_b64_tr_b16 v[2:3], v121 offset:0
    ds_read_b64_tr_b16 v[4:5], v121 offset:1280
    s_waitcnt lgkmcnt(10)
    v_mfma_f32_16x16x32_bf16 v[164:167], v[248:251], v[184:187], v[164:167]
    ds_read_b64_tr_b16 v[6:7], v121 offset:32
    ds_read_b64_tr_b16 v[8:9], v121 offset:1312
    s_waitcnt lgkmcnt(10)
    v_mfma_f32_16x16x32_bf16 v[168:171], v[252:255], v[184:187], v[168:171]
    ds_read_b64_tr_b16 v[10:11], v121 offset:64
    ds_read_b64_tr_b16 v[12:13], v121 offset:1344
    s_waitcnt vmcnt(18) lgkmcnt(10)
    v_mfma_f32_16x16x32_bf16 v[160:163], v[152:155], v[188:191], v[160:163]
    ds_read_b64_tr_b16 v[244:245], v121 offset:5120
    ds_read_b64_tr_b16 v[246:247], v121 offset:6400
    s_waitcnt lgkmcnt(10)
    v_mfma_f32_16x16x32_bf16 v[164:167], v[156:159], v[188:191], v[164:167]
    ds_read_b64_tr_b16 v[248:249], v121 offset:5152
    ds_read_b64_tr_b16 v[250:251], v121 offset:6432
    s_waitcnt lgkmcnt(10)
    v_mfma_f32_16x16x32_bf16 v[168:171], v[116:119], v[188:191], v[168:171]
    ds_read_b64_tr_b16 v[252:253], v121 offset:5184
    ds_read_b64_tr_b16 v[254:255], v121 offset:6464
    s_waitcnt vmcnt(17) lgkmcnt(10)
    v_mfma_f32_16x16x32_bf16 v[160:163], v[2:5], v[192:195], v[160:163]
    ds_read_b64_tr_b16 v[152:153], v121 offset:10240
    ds_read_b64_tr_b16 v[154:155], v121 offset:11520
    s_waitcnt lgkmcnt(10)
    v_mfma_f32_16x16x32_bf16 v[164:167], v[6:9], v[192:195], v[164:167]
    ds_read_b64_tr_b16 v[156:157], v121 offset:10272
    ds_read_b64_tr_b16 v[158:159], v121 offset:11552
    s_waitcnt lgkmcnt(10)
    v_mfma_f32_16x16x32_bf16 v[168:171], v[10:13], v[192:195], v[168:171]
    ds_read_b64_tr_b16 v[116:117], v121 offset:10304
    ds_read_b64_tr_b16 v[118:119], v121 offset:11584
    s_waitcnt vmcnt(16) lgkmcnt(10)
    v_mfma_f32_16x16x32_bf16 v[160:163], v[244:247], v[196:199], v[160:163]
    ds_read_b64_tr_b16 v[2:3], v121 offset:15360
    ds_read_b64_tr_b16 v[4:5], v121 offset:16640
    s_waitcnt lgkmcnt(10)
    v_mfma_f32_16x16x32_bf16 v[164:167], v[248:251], v[196:199], v[164:167]
    ds_read_b64_tr_b16 v[6:7], v121 offset:15392
    ds_read_b64_tr_b16 v[8:9], v121 offset:16672
    s_waitcnt lgkmcnt(10)
    v_mfma_f32_16x16x32_bf16 v[168:171], v[252:255], v[196:199], v[168:171]
    ds_read_b64_tr_b16 v[10:11], v121 offset:15424
    ds_read_b64_tr_b16 v[12:13], v121 offset:16704
    s_waitcnt vmcnt(15) lgkmcnt(10)
    v_mfma_f32_16x16x32_bf16 v[160:163], v[152:155], v[200:203], v[160:163]
    ds_read_b64_tr_b16 v[244:245], v125 offset:0
    ds_read_b64_tr_b16 v[246:247], v125 offset:2560
    s_waitcnt lgkmcnt(10)
    v_mfma_f32_16x16x32_bf16 v[164:167], v[156:159], v[200:203], v[164:167]
    ds_read_b64_tr_b16 v[248:249], v125 offset:32
    ds_read_b64_tr_b16 v[250:251], v125 offset:2592
    s_waitcnt lgkmcnt(10)
    v_mfma_f32_16x16x32_bf16 v[168:171], v[116:119], v[200:203], v[168:171]
    ds_read_b64_tr_b16 v[252:253], v125 offset:64
    ds_read_b64_tr_b16 v[254:255], v125 offset:2624
    s_waitcnt vmcnt(14) lgkmcnt(10)
    v_mfma_f32_16x16x32_bf16 v[160:163], v[2:5], v[204:207], v[160:163]
    ds_read_b64_tr_b16 v[152:153], v122 offset:0
    ds_read_b64_tr_b16 v[154:155], v122 offset:1280
    s_waitcnt lgkmcnt(10)
    v_mfma_f32_16x16x32_bf16 v[164:167], v[6:9], v[204:207], v[164:167]
    ds_read_b64_tr_b16 v[156:157], v122 offset:32
    ds_read_b64_tr_b16 v[158:159], v122 offset:1312
    s_waitcnt lgkmcnt(10)
    v_mfma_f32_16x16x32_bf16 v[168:171], v[10:13], v[204:207], v[168:171]
    ds_read_b64_tr_b16 v[116:117], v122 offset:64
    ds_read_b64_tr_b16 v[118:119], v122 offset:1344
    s_waitcnt vmcnt(12) lgkmcnt(10)
    v_mfma_f32_16x16x32_bf16 v[160:163], v[244:247], v[208:211], v[160:163]
    ds_read_b64_tr_b16 v[2:3], v122 offset:5120
    ds_read_b64_tr_b16 v[4:5], v122 offset:6400
    s_waitcnt lgkmcnt(10)
    v_mfma_f32_16x16x32_bf16 v[164:167], v[248:251], v[208:211], v[164:167]
    ds_read_b64_tr_b16 v[6:7], v122 offset:5152
    ds_read_b64_tr_b16 v[8:9], v122 offset:6432
    s_waitcnt lgkmcnt(10)
    v_mfma_f32_16x16x32_bf16 v[168:171], v[252:255], v[208:211], v[168:171]
    ds_read_b64_tr_b16 v[10:11], v122 offset:5184
    ds_read_b64_tr_b16 v[12:13], v122 offset:6464
    s_waitcnt vmcnt(11) lgkmcnt(10)
    v_mfma_f32_16x16x32_bf16 v[160:163], v[152:155], v[32:35], v[160:163]
    ds_read_b64_tr_b16 v[244:245], v122 offset:10240
    ds_read_b64_tr_b16 v[246:247], v122 offset:11520
    s_waitcnt lgkmcnt(10)
    v_mfma_f32_16x16x32_bf16 v[164:167], v[156:159], v[32:35], v[164:167]
    ds_read_b64_tr_b16 v[248:249], v122 offset:10272
    ds_read_b64_tr_b16 v[250:251], v122 offset:11552
    s_waitcnt lgkmcnt(10)
    v_mfma_f32_16x16x32_bf16 v[168:171], v[116:119], v[32:35], v[168:171]
    ds_read_b64_tr_b16 v[252:253], v122 offset:10304
    ds_read_b64_tr_b16 v[254:255], v122 offset:11584
    s_waitcnt vmcnt(10) lgkmcnt(10)
    v_mfma_f32_16x16x32_bf16 v[160:163], v[2:5], v[36:39], v[160:163]
    ds_read_b64_tr_b16 v[152:153], v122 offset:15360
    ds_read_b64_tr_b16 v[154:155], v122 offset:16640
    s_waitcnt lgkmcnt(10)
    v_mfma_f32_16x16x32_bf16 v[164:167], v[6:9], v[36:39], v[164:167]
    ds_read_b64_tr_b16 v[156:157], v122 offset:15392
    ds_read_b64_tr_b16 v[158:159], v122 offset:16672
    s_waitcnt lgkmcnt(10)
    v_mfma_f32_16x16x32_bf16 v[168:171], v[10:13], v[36:39], v[168:171]
    ds_read_b64_tr_b16 v[116:117], v122 offset:15424
    ds_read_b64_tr_b16 v[118:119], v122 offset:16704
    s_waitcnt vmcnt(9) lgkmcnt(10)
    v_mfma_f32_16x16x32_bf16 v[160:163], v[244:247], v[40:43], v[160:163]
    ds_read_b64_tr_b16 v[2:3], v126 offset:0
    ds_read_b64_tr_b16 v[4:5], v126 offset:2560
    s_waitcnt lgkmcnt(10)
    v_mfma_f32_16x16x32_bf16 v[164:167], v[248:251], v[40:43], v[164:167]
    ds_read_b64_tr_b16 v[6:7], v126 offset:32
    ds_read_b64_tr_b16 v[8:9], v126 offset:2592
    s_waitcnt lgkmcnt(10)
    v_mfma_f32_16x16x32_bf16 v[168:171], v[252:255], v[40:43], v[168:171]
    ds_read_b64_tr_b16 v[10:11], v126 offset:64
    ds_read_b64_tr_b16 v[12:13], v126 offset:2624
    s_waitcnt vmcnt(8) lgkmcnt(10)
    v_mfma_f32_16x16x32_bf16 v[160:163], v[152:155], v[44:47], v[160:163]
    ds_read_b64_tr_b16 v[244:245], v123 offset:0
    ds_read_b64_tr_b16 v[246:247], v123 offset:1280
    s_waitcnt lgkmcnt(10)
    v_mfma_f32_16x16x32_bf16 v[164:167], v[156:159], v[44:47], v[164:167]
    ds_read_b64_tr_b16 v[248:249], v123 offset:32
    ds_read_b64_tr_b16 v[250:251], v123 offset:1312
    s_waitcnt lgkmcnt(10)
    v_mfma_f32_16x16x32_bf16 v[168:171], v[116:119], v[44:47], v[168:171]
    ds_read_b64_tr_b16 v[252:253], v123 offset:64
    ds_read_b64_tr_b16 v[254:255], v123 offset:1344
    s_waitcnt vmcnt(6) lgkmcnt(10)
    v_mfma_f32_16x16x32_bf16 v[160:163], v[2:5], v[48:51], v[160:163]
    ds_read_b64_tr_b16 v[152:153], v123 offset:5120
    ds_read_b64_tr_b16 v[154:155], v123 offset:6400
    s_waitcnt lgkmcnt(10)
    v_mfma_f32_16x16x32_bf16 v[164:167], v[6:9], v[48:51], v[164:167]
    ds_read_b64_tr_b16 v[156:157], v123 offset:5152
    ds_read_b64_tr_b16 v[158:159], v123 offset:6432
    s_waitcnt lgkmcnt(10)
    v_mfma_f32_16x16x32_bf16 v[168:171], v[10:13], v[48:51], v[168:171]
    ds_read_b64_tr_b16 v[116:117], v123 offset:5184
    ds_read_b64_tr_b16 v[118:119], v123 offset:6464
    s_waitcnt vmcnt(5) lgkmcnt(10)
    v_mfma_f32_16x16x32_bf16 v[160:163], v[244:247], v[212:215], v[160:163]
    ds_read_b64_tr_b16 v[2:3], v123 offset:10240
    ds_read_b64_tr_b16 v[4:5], v123 offset:11520
    s_waitcnt lgkmcnt(10)
    v_mfma_f32_16x16x32_bf16 v[164:167], v[248:251], v[212:215], v[164:167]
    ds_read_b64_tr_b16 v[6:7], v123 offset:10272
    ds_read_b64_tr_b16 v[8:9], v123 offset:11552
    s_waitcnt lgkmcnt(10)
    v_mfma_f32_16x16x32_bf16 v[168:171], v[252:255], v[212:215], v[168:171]
    ds_read_b64_tr_b16 v[10:11], v123 offset:10304
    ds_read_b64_tr_b16 v[12:13], v123 offset:11584
    s_waitcnt vmcnt(4) lgkmcnt(10)
    v_mfma_f32_16x16x32_bf16 v[160:163], v[152:155], v[216:219], v[160:163]
    ds_read_b64_tr_b16 v[244:245], v123 offset:15360
    ds_read_b64_tr_b16 v[246:247], v123 offset:16640
    s_waitcnt lgkmcnt(10)
    v_mfma_f32_16x16x32_bf16 v[164:167], v[156:159], v[216:219], v[164:167]
    ds_read_b64_tr_b16 v[248:249], v123 offset:15392
    ds_read_b64_tr_b16 v[250:251], v123 offset:16672
    s_waitcnt lgkmcnt(10)
    v_mfma_f32_16x16x32_bf16 v[168:171], v[116:119], v[216:219], v[168:171]
    ds_read_b64_tr_b16 v[252:253], v123 offset:15424
    ds_read_b64_tr_b16 v[254:255], v123 offset:16704
    s_waitcnt vmcnt(3) lgkmcnt(10)
    v_mfma_f32_16x16x32_bf16 v[160:163], v[2:5], v[220:223], v[160:163]
    ds_read_b64_tr_b16 v[152:153], v127 offset:0
    ds_read_b64_tr_b16 v[154:155], v127 offset:2560
    s_waitcnt lgkmcnt(10)
    v_mfma_f32_16x16x32_bf16 v[164:167], v[6:9], v[220:223], v[164:167]
    ds_read_b64_tr_b16 v[156:157], v127 offset:32
    ds_read_b64_tr_b16 v[158:159], v127 offset:2592
    s_waitcnt lgkmcnt(10)
    v_mfma_f32_16x16x32_bf16 v[168:171], v[10:13], v[220:223], v[168:171]
    ds_read_b64_tr_b16 v[116:117], v127 offset:64
    ds_read_b64_tr_b16 v[118:119], v127 offset:2624
    s_waitcnt vmcnt(2) lgkmcnt(10)
    v_mfma_f32_16x16x32_bf16 v[160:163], v[244:247], v[52:55], v[160:163]
    s_waitcnt lgkmcnt(8)
    v_mfma_f32_16x16x32_bf16 v[164:167], v[248:251], v[52:55], v[164:167]
    s_waitcnt lgkmcnt(6)
    v_mfma_f32_16x16x32_bf16 v[168:171], v[252:255], v[52:55], v[168:171]
    s_waitcnt vmcnt(0) lgkmcnt(4)
    v_mfma_f32_16x16x32_bf16 v[160:163], v[152:155], v[56:59], v[160:163]
    s_waitcnt lgkmcnt(2)
    v_mfma_f32_16x16x32_bf16 v[164:167], v[156:159], v[56:59], v[164:167]
    s_waitcnt lgkmcnt(0)
    v_mfma_f32_16x16x32_bf16 v[168:171], v[116:119], v[56:59], v[168:171]
    s_nop 5
    v_cmp_u_f32 vcc, v160, v160
    s_nop 3
    s_cmp_eq_u64 vcc, 0
    s_cbranch_scc0 L_redo_a
    s_branch L_done_a
L_redo_b:
    s_add_u32 s59, s59, 1
    s_cmp_gt_u32 s59, 20000
    s_cbranch_scc1 L_done_b
    s_sleep 4
    buffer_load_dwordx4 v[64:67], v14, s[24:27], s80 offen offset:0 sc1
    buffer_load_dwordx4 v[68:71], v14, s[24:27], s80 offen offset:1280 sc1
    buffer_load_dwordx4 v[72:75], v14, s[24:27], s80 offen offset:2560 sc1
    buffer_load_dwordx4 v[76:79], v14, s[24:27], s80 offen offset:3840 sc1
    buffer_load_dwordx2 v[80:81], v15, s[24:27], s80 offen offset:512 sc1
    buffer_load_dwordx2 v[82:83], v15, s[24:27], s80 offen offset:3072 sc1
    buffer_load_dwordx4 v[84:87], v14, s[24:27], s81 offen offset:0 sc1
    buffer_load_dwordx4 v[88:91], v14, s[24:27], s81 offen offset:1280 sc1
    buffer_load_dwordx4 v[92:95], v14, s[24:27], s81 offen offset:2560 sc1
    buffer_load_dwordx4 v[96:99], v14, s[24:27], s81 offen offset:3840 sc1
    buffer_load_dwordx2 v[100:101], v15, s[24:27], s81 offen offset:512 sc1
    buffer_load_dwordx2 v[102:103], v15, s[24:27], s81 offen offset:3072 sc1
    buffer_load_dwordx4 v[132:135], v14, s[24:27], s82 offen offset:0 sc1
    buffer_load_dwordx4 v[136:139], v14, s[24:27], s82 offen offset:1280 sc1
    buffer_load_dwordx4 v[140:143], v14, s[24:27], s82 offen offset:2560 sc1
    buffer_load_dwordx4 v[144:147], v14, s[24:27], s82 offen offset:3840 sc1
    buffer_load_dwordx2 v[148:149], v15, s[24:27], s82 offen offset:512 sc1
    buffer_load_dwordx2 v[150:151], v15, s[24:27], s82 offen offset:3072 sc1
    buffer_load_dwordx4 v[224:227], v14, s[24:27], s83 offen offset:0 sc1
    buffer_load_dwordx4 v[228:231], v14, s[24:27], s83 offen offset:1280 sc1
    buffer_load_dwordx4 v[232:235], v14, s[24:27], s83 offen offset:2560 sc1
    buffer_load_dwordx4 v[236:239], v14, s[24:27], s83 offen offset:3840 sc1
    buffer_load_dwordx2 v[240:241], v15, s[24:27], s83 offen offset:512 sc1
    buffer_load_dwordx2 v[242:243], v15, s[24:27], s83 offen offset:3072 sc1
    ds_read_b64_tr_b16 v[244:245], v120 offset:40960
    ds_read_b64_tr_b16 v[246:247], v120 offset:42240
    ds_read_b64_tr_b16 v[248:249], v120 offset:40992
    ds_read_b64_tr_b16 v[250:251], v120 offset:42272
    ds_read_b64_tr_b16 v[252:253], v120 offset:41024
    ds_read_b64_tr_b16 v[254:255], v120 offset:42304
    ds_read_b64_tr_b16 v[152:153], v120 offset:46080
    ds_read_b64_tr_b16 v[154:155], v120 offset:47360
    ds_read_b64_tr_b16 v[156:157], v120 offset:46112
    ds_read_b64_tr_b16 v[158:159], v120 offset:47392
    ds_read_b64_tr_b16 v[116:117], v120 offset:46144
    ds_read_b64_tr_b16 v[118:119], v120 offset:47424
    s_waitcnt vmcnt(23) lgkmcnt(10)
    v_mfma_f32_16x16x32_bf16 v[104:107], v[244:247], v[64:67], 0
    ds_read_b64_tr_b16 v[2:3], v120 offset:51200
    ds_read_b64_tr_b16 v[4:5], v120 offset:52480
    s_waitcnt lgkmcnt(10)
    v_mfma_f32_16x16x32_bf16 v[108:111], v[248:251], v[64:67], 0
    ds_read_b64_tr_b16 v[6:7], v120 offset:51232
    ds_read_b64_tr_b16 v[8:9], v120 offset:52512
    s_waitcnt lgkmcnt(10)
    v_mfma_f32_16x16x32_bf16 v[112:115], v[252:255], v[64:67], 0
    ds_read_b64_tr_b16 v[10:11], v120 offset:51264
    ds_read_b64_tr_b16 v[12:13], v120 offset:52544
    s_waitcnt vmcnt(22) lgkmcnt(10)
    v_mfma_f32_16x16x32_bf16 v[104:107], v[152:155], v[68:71], v[104:107]
    ds_read_b64_tr_b16 v[244:245], v120 offset:56320
    ds_read_b64_tr_b16 v[246:247], v120 offset:57600
    s_waitcnt lgkmcnt(10)
    v_mfma_f32_16x16x32_bf16 v[108:111], v[156:159], v[68:71], v[108:111]
    ds_read_b64_tr_b16 v[248:249], v120 offset:56352
    ds_read_b64_tr_b16 v[250:251], v120 offset:57632
    s_waitcnt lgkmcnt(10)
    v_mfma_f32_16x16x32_bf16 v[112:115], v[116:119], v[68:71], v[112:115]
    ds_read_b64_tr_b16 v[252:253], v120 offset:56384
    ds_read_b64_tr_b16 v[254:255], v120 offset:57664
    s_waitcnt vmcnt(21) lgkmcnt(10)
    v_mfma_f32_16x16x32_bf16 v[104:107], v[2:5], v[72:75], v[104:107]
    ds_read_b64_tr_b16 v[152:153], v124 offset:10240
    ds_read_b64_tr_b16 v[154:155], v124 offset:12800
    s_waitcnt lgkmcnt(10)
    v_mfma_f32_16x16x32_bf16 v[108:111], v[6:9], v[72:75], v[108:111]
    ds_read_b64_tr_b16 v[156:157], v124 offset:10272
    ds_read_b64_tr_b16 v[158:159], v124 offset:12832
    s_waitcnt lgkmcnt(10)
    v_mfma_f32_16x16x32_bf16 v[112:115], v[10:13], v[72:75], v[112:115]
    ds_read_b64_tr_b16 v[116:117], v124 offset:10304
    ds_read_b64_tr_b16 v[118:119], v124 offset:12864
    s_waitcnt vmcnt(20) lgkmcnt(10)
    v_mfma_f32_16x16x32_bf16 v[104:107], v[244:247], v[76:79], v[104:107]
    ds_read_b64_tr_b16 v[2:3], v121 offset:40960
    ds_read_b64_tr_b16 v[4:5], v121 offset:42240
    s_waitcnt lgkmcnt(10)
    v_mfma_f32_16x16x32_bf16 v[108:111], v[248:251], v[76:79], v[108:111]
    ds_read_b64_tr_b16 v[6:7], v121 offset:40992
    ds_read_b64_tr_b16 v[8:9], v121 offset:42272
    s_waitcnt lgkmcnt(10)
    v_mfma_f32_16x16x32_bf16 v[112:115], v[252:255], v[76:79], v[112:115]
    ds_read_b64_tr_b16 v[10:11], v121 offset:41024
    ds_read_b64_tr_b16 v[12:13], v121 offset:42304
    s_waitcnt vmcnt(18) lgkmcnt(10)
    v_mfma_f32_16x16x32_bf16 v[104:107], v[152:155], v[80:83], v[104:107]
    ds_read_b64_tr_b16 v[244:245], v121 offset:46080
    ds_read_b64_tr_b16 v[246:247], v121 offset:47360
    s_waitcnt lgkmcnt(10)
    v_mfma_f32_16x16x32_bf16 v[108:111], v[156:159], v[80:83], v[108:111]
    ds_read_b64_tr_b16 v[248:249], v121 offset:46112
    ds_read_b64_tr_b16 v[250:251], v121 offset:47392
    s_waitcnt lgkmcnt(10)
    v_mfma_f32_16x16x32_bf16 v[112:115], v[116:119], v[80:83], v[112:115]
    ds_read_b64_tr_b16 v[252:253], v121 offset:46144
    ds_read_b64_tr_b16 v[254:255], v121 offset:47424
    s_waitcnt vmcnt(17) lgkmcnt(10)
    v_mfma_f32_16x16x32_bf16 v[104:107], v[2:5], v[84:87], v[104:107]
    ds_read_b64_tr_b16 v[152:153], v121 offset:51200
    ds_read_b64_tr_b16 v[154:155], v121 offset:52480
    s_waitcnt lgkmcnt(10)
    v_mfma_f32_16x16x32_bf16 v[108:111], v[6:9], v[84:87], v[108:111]
    ds_read_b64_tr_b16 v[156:157], v121 offset:51232
    ds_read_b64_tr_b16 v[158:159], v121 offset:52512
    s_waitcnt lgkmcnt(10)
    v_mfma_f32_16x16x32_bf16 v[112:115], v[10:13], v[84:87], v[112:115]
    ds_read_b64_tr_b16 v[116:117], v121 offset:51264
    ds_read_b64_tr_b16 v[118:119], v121 offset:52544
    s_waitcnt vmcnt(16) lgkmcnt(10)
    v_mfma_f32_16x16x32_bf16 v[104:107], v[244:247], v[88:91], v[104:107]
    ds_read_b64_tr_b16 v[2:3], v121 offset:56320
    ds_read_b64_tr_b16 v[4:5], v121 offset:57600
    s_waitcnt lgkmcnt(10)
    v_mfma_f32_16x16x32_bf16 v[108:111], v[248:251], v[88:91], v[108:111]
    ds_read_b64_tr_b16 v[6:7], v121 offset:56352
    ds_read_b64_tr_b16 v[8:9], v121 offset:57632
    s_waitcnt lgkmcnt(10)
    v_mfma_f32_16x16x32_bf16 v[112:115], v[252:255], v[88:91], v[112:115]
    ds_read_b64_tr_b16 v[10:11], v121 offset:56384
    ds_read_b64_tr_b16 v[12:13], v121 offset:57664
    s_waitcnt vmcnt(15) lgkmcnt(10)
    v_mfma_f32_16x16x32_bf16 v[104:107], v[152:155], v[92:95], v[104:107]
    ds_read_b64_tr_b16 v[244:245], v125 offset:10240
    ds_read_b64_tr_b16 v[246:247], v125 offset:12800
    s_waitcnt lgkmcnt(10)
    v_mfma_f32_16x16x32_bf16 v[108:111], v[156:159], v[92:95], v[108:111]
    ds_read_b64_tr_b16 v[248:249], v125 offset:10272
    ds_read_b64_tr_b16 v[250:251], v125 offset:12832
    s_waitcnt lgkmcnt(10)
    v_mfma_f32_16x16x32_bf16 v[112:115], v[116:119], v[92:95], v[112:115]
    ds_read_b64_tr_b16 v[252:253], v125 offset:10304
    ds_read_b64_tr_b16 v[254:255], v125 offset:12864
    s_waitcnt vmcnt(14) lgkmcnt(10)
    v_mfma_f32_16x16x32_bf16 v[104:107], v[2:5], v[96:99], v[104:107]
    ds_read_b64_tr_b16 v[152:153], v122 offset:40960
    ds_read_b64_tr_b16 v[154:155], v122 offset:42240
    s_waitcnt lgkmcnt(10)
    v_mfma_f32_16x16x32_bf16 v[108:111], v[6:9], v[96:99], v[108:111]
    ds_read_b64_tr_b16 v[156:157], v122 offset:40992
    ds_read_b64_tr_b16 v[158:159], v122 offset:42272
    s_waitcnt lgkmcnt(10)
    v_mfma_f32_16x16x32_bf16 v[112:115], v[10:13], v[96:99], v[112:115]
    ds_read_b64_tr_b16 v[116:117], v122 offset:41024
    ds_read_b64_tr_b16 v[118:119], v122 offset:42304
    s_waitcnt vmcnt(12) lgkmcnt(10)
    v_mfma_f32_16x16x32_bf16 v[104:107], v[244:247], v[100:103], v[104:107]
    ds_read_b64_tr_b16 v[2:3], v122 offset:46080
    ds_read_b64_tr_b16 v[4:5], v122 offset:47360
    s_waitcnt lgkmcnt(10)
    v_mfma_f32_16x16x32_bf16 v[108:111], v[248:251], v[100:103], v[108:111]
    ds_read_b64_tr_b16 v[6:7], v122 offset:46112
    ds_read_b64_tr_b16 v[8:9], v122 offset:47392
    s_waitcnt lgkmcnt(10)
    v_mfma_f32_16x16x32_bf16 v[112:115], v[252:255], v[100:103], v[112:115]
    ds_read_b64_tr_b16 v[10:11], v122 offset:46144
    ds_read_b64_tr_b16 v[12:13], v122 offset:47424
    s_waitcnt vmcnt(11) lgkmcnt(10)
    v_mfma_f32_16x16x32_bf16 v[104:107], v[152:155], v[132:135], v[104:107]
    ds_read_b64_tr_b16 v[244:245], v122 offset:51200
    ds_read_b64_tr_b16 v[246:247], v122 offset:52480
    s_waitcnt lgkmcnt(10)
    v_mfma_f32_16x16x32_bf16 v[108:111], v[156:159], v[132:135], v[108:111]
    ds_read_b64_tr_b16 v[248:249], v122 offset:51232
    ds_read_b64_tr_b16 v[250:251], v122 offset:52512
    s_waitcnt lgkmcnt(10)
    v_mfma_f32_16x16x32_bf16 v[112:115], v[116:119], v[132:135], v[112:115]
    ds_read_b64_tr_b16 v[252:253], v122 offset:51264
    ds_read_b64_tr_b16 v[254:255], v122 offset:52544
    s_waitcnt vmcnt(10) lgkmcnt(10)
    v_mfma_f32_16x16x32_bf16 v[104:107], v[2:5], v[136:139], v[104:107]
    ds_read_b64_tr_b16 v[152:153], v122 offset:56320
    ds_read_b64_tr_b16 v[154:155], v122 offset:57600
    s_waitcnt lgkmcnt(10)
    v_mfma_f32_16x16x32_bf16 v[108:111], v[6:9], v[136:139], v[108:111]
    ds_read_b64_tr_b16 v[156:157], v122 offset:56352
    ds_read_b64_tr_b16 v[158:159], v122 offset:57632
    s_waitcnt lgkmcnt(10)
    v_mfma_f32_16x16x32_bf16 v[112:115], v[10:13], v[136:139], v[112:115]
    ds_read_b64_tr_b16 v[116:117], v122 offset:56384
    ds_read_b64_tr_b16 v[118:119], v122 offset:57664
    s_waitcnt vmcnt(9) lgkmcnt(10)
    v_mfma_f32_16x16x32_bf16 v[104:107], v[244:247], v[140:143], v[104:107]
    ds_read_b64_tr_b16 v[2:3], v126 offset:10240
    ds_read_b64_tr_b16 v[4:5], v126 offset:12800
    s_waitcnt lgkmcnt(10)
    v_mfma_f32_16x16x32_bf16 v[108:111], v[248:251], v[140:143], v[108:111]
    ds_read_b64_tr_b16 v[6:7], v126 offset:10272
    ds_read_b64_tr_b16 v[8:9], v126 offset:12832
    s_waitcnt lgkmcnt(10)
    v_mfma_f32_16x16x32_bf16 v[112:115], v[252:255], v[140:143], v[112:115]
    ds_read_b64_tr_b16 v[10:11], v126 offset:10304
    ds_read_b64_tr_b16 v[12:13], v126 offset:12864
    s_waitcnt vmcnt(8) lgkmcnt(10)
    v_mfma_f32_16x16x32_bf16 v[104:107], v[152:155], v[144:147], v[104:107]
    ds_read_b64_tr_b16 v[244:245], v123 offset:40960
    ds_read_b64_tr_b16 v[246:247], v123 offset:42240
    s_waitcnt lgkmcnt(10)
    v_mfma_f32_16x16x32_bf16 v[108:111], v[156:159], v[144:147], v[108:111]
    ds_read_b64_tr_b16 v[248:249], v123 offset:40992
    ds_read_b64_tr_b16 v[250:251], v123 offset:42272
    s_waitcnt lgkmcnt(10)
    v_mfma_f32_16x16x32_bf16 v[112:115], v[116:119], v[144:147], v[112:115]
    ds_read_b64_tr_b16 v[252:253], v123 offset:41024
    ds_read_b64_tr_b16 v[254:255], v123 offset:42304
    s_waitcnt vmcnt(6) lgkmcnt(10)
    v_mfma_f32_16x16x32_bf16 v[104:107], v[2:5], v[148:151], v[104:107]
    ds_read_b64_tr_b16 v[152:153], v123 offset:46080
    ds_read_b64_tr_b16 v[154:155], v123 offset:47360
    s_waitcnt lgkmcnt(10)
    v_mfma_f32_16x16x32_bf16 v[108:111], v[6:9], v[148:151], v[108:111]
    ds_read_b64_tr_b16 v[156:157], v123 offset:46112
    ds_read_b64_tr_b16 v[158:159], v123 offset:47392
    s_waitcnt lgkmcnt(10)
    v_mfma_f32_16x16x32_bf16 v[112:115], v[10:13], v[148:151], v[112:115]
    ds_read_b64_tr_b16 v[116:117], v123 offset:46144
    ds_read_b64_tr_b16 v[118:119], v123 offset:47424
    s_waitcnt vmcnt(5) lgkmcnt(10)
    v_mfma_f32_16x16x32_bf16 v[104:107], v[244:247], v[224:227], v[104:107]
    ds_read_b64_tr_b16 v[2:3], v123 offset:51200
    ds_read_b64_tr_b16 v[4:5], v123 offset:52480
    s_waitcnt lgkmcnt(10)
    v_mfma_f32_16x16x32_bf16 v[108:111], v[248:251], v[224:227], v[108:111]
    ds_read_b64_tr_b16 v[6:7], v123 offset:51232
    ds_read_b64_tr_b16 v[8:9], v123 offset:52512
    s_waitcnt lgkmcnt(10)
    v_mfma_f32_16x16x32_bf16 v[112:115], v[252:255], v[224:227], v[112:115]
    ds_read_b64_tr_b16 v[10:11], v123 offset:51264
    ds_read_b64_tr_b16 v[12:13], v123 offset:52544
    s_waitcnt vmcnt(4) lgkmcnt(10)
    v_mfma_f32_16x16x32_bf16 v[104:107], v[152:155], v[228:231], v[104:107]
    ds_read_b64_tr_b16 v[244:245], v123 offset:56320
    ds_read_b64_tr_b16 v[246:247], v123 offset:57600
    s_waitcnt lgkmcnt(10)
    v_mfma_f32_16x16x32_bf16 v[108:111], v[156:159], v[228:231], v[108:111]
    ds_read_b64_tr_b16 v[248:249], v123 offset:56352
    ds_read_b64_tr_b16 v[250:251], v123 offset:57632
    s_waitcnt lgkmcnt(10)
    v_mfma_f32_16x16x32_bf16 v[112:115], v[116:119], v[228:231], v[112:115]
    ds_read_b64_tr_b16 v[252:253], v123 offset:56384
    ds_read_b64_tr_b16 v[254:255], v123 offset:57664
    s_waitcnt vmcnt(3) lgkmcnt(10)
    v_mfma_f32_16x16x32_bf16 v[104:107], v[2:5], v[232:235], v[104:107]
    ds_read_b64_tr_b16 v[152:153], v127 offset:10240
    ds_read_b64_tr_b16 v[154:155], v127 offset:12800
    s_waitcnt lgkmcnt(10)
    v_mfma_f32_16x16x32_bf16 v[108:111], v[6:9], v[232:235], v[108:111]
    ds_read_b64_tr_b16 v[156:157], v127 offset:10272
    ds_read_b64_tr_b16 v[158:159], v127 offset:12832
    s_waitcnt lgkmcnt(10)
    v_mfma_f32_16x16x32_bf16 v[112:115], v[10:13], v[232:235], v[112:115]
    ds_read_b64_tr_b16 v[116:117], v127 offset:10304
    ds_read_b64_tr_b16 v[118:119], v127 offset:12864
    s_waitcnt vmcnt(2) lgkmcnt(10)
    v_mfma_f32_16x16x32_bf16 v[104:107], v[244:247], v[236:239], v[104:107]
    s_waitcnt lgkmcnt(8)
    v_mfma_f32_16x16x32_bf16 v[108:111], v[248:251], v[236:239], v[108:111]
    s_waitcnt lgkmcnt(6)
    v_mfma_f32_16x16x32_bf16 v[112:115], v[252:255], v[236:239], v[112:115]
    s_waitcnt vmcnt(0) lgkmcnt(4)
    v_mfma_f32_16x16x32_bf16 v[104:107], v[152:155], v[240:243], v[104:107]
    s_waitcnt lgkmcnt(2)
    v_mfma_f32_16x16x32_bf16 v[108:111], v[156:159], v[240:243], v[108:111]
    s_waitcnt lgkmcnt(0)
    v_mfma_f32_16x16x32_bf16 v[112:115], v[116:119], v[240:243], v[112:115]
    s_nop 5
    v_cmp_u_f32 vcc, v104, v104
    s_nop 3
    s_cmp_eq_u64 vcc, 0
    s_cbranch_scc0 L_redo_b
    s_branch L_done_b
L_fallback:
    s_waitcnt vmcnt(0) lgkmcnt(0)
    s_nop 15
    v_cndmask_b32 v100, v100, 0, s[50:51]
    v_cndmask_b32 v101, v101, 0, s[50:51]
    v_mov_b32 v156, 0xff800000
    v_cndmask_b32 v106, v106, 0, s[50:51]
    v_cndmask_b32 v107, v107, 0, s[50:51]
    v_mov_b32 v157, 0xff800000
    v_mul_u32_u24 v120, 5632, v1
    v_add_u32 v120, 5120, v120
    v_mov_b32 v122, 0x3f803f80
    v_mov_b32 v136, 0
    v_mov_b32 v152, 0
    v_mov_b32 v123, 0x3f803f80
    v_mov_b32 v137, 0
    v_mov_b32 v153, 0
    v_mov_b32 v124, 0x3f803f80
    v_mov_b32 v138, 0
    v_mov_b32 v154, 0
    v_mov_b32 v125, 0x3f803f80
    v_mov_b32 v139, 0
    v_mov_b32 v155, 0
    v_mov_b32 v224, 0
    v_mov_b32 v225, 0
    v_mov_b32 v226, 0
    v_mov_b32 v227, 0
    v_mov_b32 v228, 0
    v_mov_b32 v229, 0
    v_mov_b32 v230, 0
    v_mov_b32 v231, 0
    v_mov_b32 v232, 0
    v_mov_b32 v233, 0
    v_mov_b32 v234, 0
    v_mov_b32 v235, 0
    v_mov_b32 v236, 0
    v_mov_b32 v237, 0
    v_mov_b32 v238, 0
    v_mov_b32 v239, 0
    v_mov_b32 v240, 0
    v_mov_b32 v241, 0
    v_mov_b32 v242, 0
    v_mov_b32 v243, 0
    v_mov_b32 v244, 0
    v_mov_b32 v245, 0
    v_mov_b32 v246, 0
    v_mov_b32 v247, 0
    v_mov_b32 v248, 0
    v_mov_b32 v249, 0
    v_mov_b32 v250, 0
    v_mov_b32 v251, 0
    v_mov_b32 v252, 0
    v_mov_b32 v253, 0
    v_mov_b32 v254, 0
    v_mov_b32 v255, 0
    s_barrier
    s_mov_b64 exec, 0xfff
    ds_write_b128 v120, v[122:125]
    ds_write_b128 v120, v[152:155] offset:16
    s_mov_b64 exec, -1
    s_waitcnt lgkmcnt(0)
    s_mov_b32 s54, 0
    s_mov_b32 s60, 81920
    s_mov_b32 s58, s57
L_fb:
    s_barrier
    s_mov_b32 s61, 0
    s_add_u32 m0, s61, s88
    s_nop 0
    buffer_load_dwordx4 v112, s[24:27], s58 offen sc1 lds
    s_add_u32 m0, s61, s89
    s_nop 0
    buffer_load_dwordx4 v113, s[24:27], s58 offen sc1 lds
    s_add_u32 m0, s61, s90
    s_nop 0
    buffer_load_dwordx4 v114, s[24:27], s58 offen sc1 lds
    s_add_u32 s58, s58, s60
    s_sub_u32 s60, 20480, s60
    s_add_u32 s61, s61, 22528
    s_cmp_eq_u32 s61, 67584
    s_cselect_b32 s61, 0, s61
    s_waitcnt vmcnt(0)
    s_barrier
    v_mov_b32 v2, v117
    v_mov_b32 v3, v118
    s_mov_b32 s55, 0
L_fb2:
    ds_read2st64_b64 v[140:143], v2 offset0:0 offset1:1
    ds_read_b64 v[144:145], v3
    s_waitcnt lgkmcnt(1)
    v_mfma_f32_32x32x16_bf16 v[64:79], v[140:143], v[96:99], 0
    v_mfma_f32_32x32x16_bf16 v[80:95], v[140:143], v[102:105], 0
    s_waitcnt lgkmcnt(0)
    v_mfma_f32_32x32x8_bf16 v[64:79], v[144:145], v[100:101], v[64:79]
    v_mfma_f32_32x32x8_bf16 v[80:95], v[144:145], v[106:107], v[80:95]
    s_nop 10
    v_max3_f32 v156, v156, v64, v65
    v_max3_f32 v156, v156, v66, v67
    v_max3_f32 v156, v156, v68, v69
    v_max3_f32 v156, v156, v70, v71
    v_max3_f32 v156, v156, v72, v73
    v_max3_f32 v156, v156, v74, v75
    v_max3_f32 v156, v156, v76, v77
    v_max3_f32 v156, v156, v78, v79
    v_max3_f32 v157, v157, v80, v81
    v_max3_f32 v157, v157, v82, v83
    v_max3_f32 v157, v157, v84, v85
    v_max3_f32 v157, v157, v86, v87
    v_max3_f32 v157, v157, v88, v89
    v_max3_f32 v157, v157, v90, v91
    v_max3_f32 v157, v157, v92, v93
    v_max3_f32 v157, v157, v94, v95
    s_bitcmp1_b32 s55, 0
    s_cselect_b32 s42, 6, 5
    s_lshl_b32 s42, s42, 9
    v_add_u32 v2, s42, v2
    v_add_u32 v3, s42, v3
    s_add_u32 s55, s55, 1
    s_cmp_lt_u32 s55, 8
    s_cbranch_scc1 L_fb2
    s_add_u32 s54, s54, 1
    s_cmp_lt_u32 s54, 8
    s_cbranch_scc1 L_fb
    s_barrier
    s_mov_b32 s61, 0
    s_mov_b32 s60, 81920
    s_mov_b32 s58, s57
    s_add_u32 m0, s61, s88
    s_nop 0
    buffer_load_dwordx4 v112, s[24:27], s58 offen sc1 lds
    s_add_u32 m0, s61, s89
    s_nop 0
    buffer_load_dwordx4 v113, s[24:27], s58 offen sc1 lds
    s_add_u32 m0, s61, s90
    s_nop 0
    buffer_load_dwordx4 v114, s[24:27], s58 offen sc1 lds
    s_add_u32 s58, s58, s60
    s_sub_u32 s60, 20480, s60
    s_add_u32 s61, s61, 22528
    s_cmp_eq_u32 s61, 67584
    s_cselect_b32 s61, 0, s61
    s_add_u32 m0, s61, s88
    s_nop 0
    buffer_load_dwordx4 v112, s[24:27], s58 offen sc1 lds
    s_add_u32 m0, s61, s89
    s_nop 0
    buffer_load_dwordx4 v113, s[24:27], s58 offen sc1 lds
    s_add_u32 m0, s61, s90
    s_nop 0
    buffer_load_dwordx4 v114, s[24:27], s58 offen sc1 lds
    s_add_u32 s58, s58, s60
    s_sub_u32 s60, 20480, s60
    s_add_u32 s61, s61, 22528
    s_cmp_eq_u32 s61, 67584
    s_cselect_b32 s61, 0, s61
    s_waitcnt vmcnt(0)
    s_barrier
    s_mov_b32 s54, 16
    s_mov_b32 s55, 0
    ds_read2st64_b64 v[140:143], v108 offset0:0 offset1:1
    ds_read_b64 v[144:145], v109
    ds_read_b128 v[148:151], v110
    v_mov_b32 v158, v156
    s_waitcnt lgkmcnt(2)
    v_mfma_f32_32x32x16_bf16 v[64:79], v[140:143], v[96:99], 0
    s_nop 0
    v_permlane32_swap_b32 v156, v158
    v_max_f32 v156, v156, v158
    v_sub_f32 v156, 0, v156
    v_and_b32 v158, 0xffff0000, v156
    v_sub_f32 v156, v156, v158
    v_and_b32 v159, 0xffff0000, v156
    v_sub_f32 v156, v156, v159
    v_lshrrev_b32 v158, 16, v158
    v_or_b32 v158, v158, v159
    v_lshrrev_b32 v156, 16, v156
    v_cndmask_b32 v100, v100, v158, s[50:51]
    v_cndmask_b32 v101, v101, v156, s[50:51]
    v_mov_b32 v170, v157
    s_waitcnt lgkmcnt(1)
    v_mfma_f32_32x32x8_bf16 v[64:79], v[144:145], v[100:101], v[64:79]
    v_permlane32_swap_b32 v157, v170
    v_max_f32 v157, v157, v170
    v_sub_f32 v157, 0, v157
    v_and_b32 v170, 0xffff0000, v157
    v_sub_f32 v157, v157, v170
    v_and_b32 v171, 0xffff0000, v157
    v_sub_f32 v157, v157, v171
    v_lshrrev_b32 v170, 16, v170
    v_or_b32 v170, v170, v171
    v_lshrrev_b32 v157, 16, v157
    v_cndmask_b32 v106, v106, v170, s[50:51]
    v_cndmask_b32 v107, v107, v157, s[50:51]
L_att2:
    s_add_u32 s55, s55, 1
    s_cmp_eq_u32 s55, 3
    s_cselect_b32 s55, 0, s55
    s_cselect_b32 s56, -2, 1
    s_mul_i32 s56, s56, 22528
    v_mfma_f32_32x32x16_bf16 v[80:95], v[140:143], v[102:105], 0
    ds_read2st64_b64 v[140:143], v108 offset0:11 offset1:12
    v_exp_f32 v64, v64
    v_exp_f32 v65, v65
    v_exp_f32 v66, v66
    v_exp_f32 v67, v67
    v_cvt_pk_bf16_f32 v132, v64, v65
    v_cvt_pk_bf16_f32 v133, v66, v67
    v_mfma_f32_32x32x16_bf16 v[240:255], v[152:155], v[136:139], v[240:255]
    ds_read_b128 v[152:155], v111 offset:0
    v_exp_f32 v68, v68
    v_exp_f32 v69, v69
    v_exp_f32 v70, v70
    v_exp_f32 v71, v71
    v_cvt_pk_bf16_f32 v134, v68, v69
    v_cvt_pk_bf16_f32 v135, v70, v71
    v_mfma_f32_32x32x8_bf16 v[80:95], v[144:145], v[106:107], v[80:95]
    ds_read_b64 v[144:145], v109 offset:5632
    v_exp_f32 v72, v72
    v_exp_f32 v73, v73
    v_exp_f32 v74, v74
    v_exp_f32 v75, v75
    v_cvt_pk_bf16_f32 v136, v72, v73
    v_cvt_pk_bf16_f32 v137, v74, v75
    s_waitcnt lgkmcnt(3)
    v_mfma_f32_32x32x16_bf16 v[224:239], v[148:151], v[132:135], v[224:239]
    v_exp_f32 v76, v76
    v_exp_f32 v77, v77
    v_exp_f32 v78, v78
    v_exp_f32 v79, v79
    v_cvt_pk_bf16_f32 v138, v76, v77
    v_cvt_pk_bf16_f32 v139, v78, v79
    s_waitcnt lgkmcnt(0)
    v_mfma_f32_32x32x16_bf16 v[64:79], v[140:143], v[96:99], 0
    v_exp_f32 v80, v80
    v_exp_f32 v81, v81
    v_exp_f32 v82, v82
    v_exp_f32 v83, v83
    v_cvt_pk_bf16_f32 v132, v80, v81
    v_cvt_pk_bf16_f32 v133, v82, v83
    v_mfma_f32_32x32x16_bf16 v[224:239], v[152:155], v[136:139], v[224:239]
    v_exp_f32 v84, v84
    v_exp_f32 v85, v85
    v_exp_f32 v86, v86
    v_exp_f32 v87, v87
    v_cvt_pk_bf16_f32 v134, v84, v85
    v_cvt_pk_bf16_f32 v135, v86, v87
    v_mfma_f32_32x32x8_bf16 v[64:79], v[144:145], v[100:101], v[64:79]
    v_exp_f32 v88, v88
    v_exp_f32 v89, v89
    v_exp_f32 v90, v90
    v_exp_f32 v91, v91
    v_cvt_pk_bf16_f32 v136, v88, v89
    v_cvt_pk_bf16_f32 v137, v90, v91
    v_mfma_f32_32x32x16_bf16 v[240:255], v[148:151], v[132:135], v[240:255]
    ds_read_b128 v[148:151], v110 offset:5632
    v_exp_f32 v92, v92
    v_exp_f32 v93, v93
    v_exp_f32 v94, v94
    v_exp_f32 v95, v95
    v_cvt_pk_bf16_f32 v138, v92, v93
    v_cvt_pk_bf16_f32 v139, v94, v95
    v_mfma_f32_32x32x16_bf16 v[80:95], v[140:143], v[102:105], 0
    ds_read2st64_b64 v[140:143], v108 offset0:22 offset1:23
    v_exp_f32 v64, v64
    v_exp_f32 v65, v65
    v_exp_f32 v66, v66
    v_exp_f32 v67, v67
    v_cvt_pk_bf16_f32 v132, v64, v65
    v_cvt_pk_bf16_f32 v133, v66, v67
    v_mfma_f32_32x32x16_bf16 v[240:255], v[152:155], v[136:139], v[240:255]
    ds_read_b128 v[152:155], v111 offset:5632
    v_exp_f32 v68, v68
    v_exp_f32 v69, v69
    v_exp_f32 v70, v70
    v_exp_f32 v71, v71
    v_cvt_pk_bf16_f32 v134, v68, v69
    v_cvt_pk_bf16_f32 v135, v70, v71
    v_mfma_f32_32x32x8_bf16 v[80:95], v[144:145], v[106:107], v[80:95]
    ds_read_b64 v[144:145], v109 offset:11264
    v_exp_f32 v72, v72
    v_exp_f32 v73, v73
    v_exp_f32 v74, v74
    v_exp_f32 v75, v75
    v_cvt_pk_bf16_f32 v136, v72, v73
    v_cvt_pk_bf16_f32 v137, v74, v75
    s_waitcnt lgkmcnt(3)
    v_mfma_f32_32x32x16_bf16 v[224:239], v[148:151], v[132:135], v[224:239]
    v_exp_f32 v76, v76
    v_exp_f32 v77, v77
    v_exp_f32 v78, v78
    v_exp_f32 v79, v79
    v_cvt_pk_bf16_f32 v138, v76, v77
    v_cvt_pk_bf16_f32 v139, v78, v79
    s_waitcnt lgkmcnt(0)
    v_mfma_f32_32x32x16_bf16 v[64:79], v[140:143], v[96:99], 0
    v_exp_f32 v80, v80
    v_exp_f32 v81, v81
    v_exp_f32 v82, v82
    v_exp_f32 v83, v83
    v_cvt_pk_bf16_f32 v132, v80, v81
    v_cvt_pk_bf16_f32 v133, v82, v83
    v_mfma_f32_32x32x16_bf16 v[224:239], v[152:155], v[136:139], v[224:239]
    v_exp_f32 v84, v84
    v_exp_f32 v85, v85
    v_exp_f32 v86, v86
    v_exp_f32 v87, v87
    v_cvt_pk_bf16_f32 v134, v84, v85
    v_cvt_pk_bf16_f32 v135, v86, v87
    v_mfma_f32_32x32x8_bf16 v[64:79], v[144:145], v[100:101], v[64:79]
    v_exp_f32 v88, v88
    v_exp_f32 v89, v89
    v_exp_f32 v90, v90
    v_exp_f32 v91, v91
    v_cvt_pk_bf16_f32 v136, v88, v89
    v_cvt_pk_bf16_f32 v137, v90, v91
    v_mfma_f32_32x32x16_bf16 v[240:255], v[148:151], v[132:135], v[240:255]
    ds_read_b128 v[148:151], v110 offset:11264
    v_exp_f32 v92, v92
    v_exp_f32 v93, v93
    v_exp_f32 v94, v94
    v_exp_f32 v95, v95
    v_cvt_pk_bf16_f32 v138, v92, v93
    v_cvt_pk_bf16_f32 v139, v94, v95
    v_mfma_f32_32x32x16_bf16 v[80:95], v[140:143], v[102:105], 0
    ds_read2st64_b64 v[140:143], v108 offset0:33 offset1:34
    v_exp_f32 v64, v64
    v_exp_f32 v65, v65
    v_exp_f32 v66, v66
    v_exp_f32 v67, v67
    v_cvt_pk_bf16_f32 v132, v64, v65
    v_cvt_pk_bf16_f32 v133, v66, v67
    v_mfma_f32_32x32x16_bf16 v[240:255], v[152:155], v[136:139], v[240:255]
    ds_read_b128 v[152:155], v111 offset:11264
    v_exp_f32 v68, v68
    v_exp_f32 v69, v69
    v_exp_f32 v70, v70
    v_exp_f32 v71, v71
    v_cvt_pk_bf16_f32 v134, v68, v69
    v_cvt_pk_bf16_f32 v135, v70, v71
    v_mfma_f32_32x32x8_bf16 v[80:95], v[144:145], v[106:107], v[80:95]
    ds_read_b64 v[144:145], v109 offset:16896
    v_exp_f32 v72, v72
    v_exp_f32 v73, v73
    v_exp_f32 v74, v74
    v_exp_f32 v75, v75
    v_cvt_pk_bf16_f32 v136, v72, v73
    v_cvt_pk_bf16_f32 v137, v74, v75
    s_waitcnt lgkmcnt(3)
    v_mfma_f32_32x32x16_bf16 v[224:239], v[148:151], v[132:135], v[224:239]
    v_exp_f32 v76, v76
    v_exp_f32 v77, v77
    v_exp_f32 v78, v78
    v_exp_f32 v79, v79
    v_cvt_pk_bf16_f32 v138, v76, v77
    v_cvt_pk_bf16_f32 v139, v78, v79
    s_waitcnt lgkmcnt(0)
    v_mfma_f32_32x32x16_bf16 v[64:79], v[140:143], v[96:99], 0
    v_exp_f32 v80, v80
    v_exp_f32 v81, v81
    v_exp_f32 v82, v82
    v_exp_f32 v83, v83
    v_cvt_pk_bf16_f32 v132, v80, v81
    v_cvt_pk_bf16_f32 v133, v82, v83
    v_mfma_f32_32x32x16_bf16 v[224:239], v[152:155], v[136:139], v[224:239]
    v_exp_f32 v84, v84
    v_exp_f32 v85, v85
    v_exp_f32 v86, v86
    v_exp_f32 v87, v87
    v_cvt_pk_bf16_f32 v134, v84, v85
    v_cvt_pk_bf16_f32 v135, v86, v87
    v_mfma_f32_32x32x8_bf16 v[64:79], v[144:145], v[100:101], v[64:79]
    v_exp_f32 v88, v88
    v_exp_f32 v89, v89
    v_exp_f32 v90, v90
    v_exp_f32 v91, v91
    v_cvt_pk_bf16_f32 v136, v88, v89
    v_cvt_pk_bf16_f32 v137, v90, v91
    v_mfma_f32_32x32x16_bf16 v[240:255], v[148:151], v[132:135], v[240:255]
    ds_read_b128 v[148:151], v110 offset:16896
    v_exp_f32 v92, v92
    v_exp_f32 v93, v93
    v_exp_f32 v94, v94
    v_exp_f32 v95, v95
    v_cvt_pk_bf16_f32 v138, v92, v93
    v_cvt_pk_bf16_f32 v139, v94, v95
    v_add_u32 v108, s56, v108
    v_add_u32 v109, s56, v109
    v_add_u32 v110, s56, v110
    s_waitcnt vmcnt(0)
    s_barrier
    s_cmp_ge_u32 s54, 22
    s_cbranch_scc1 L_p2n
    s_add_u32 m0, s61, s88
    s_nop 0
    buffer_load_dwordx4 v112, s[24:27], s58 offen sc1 lds
    s_add_u32 m0, s61, s89
    s_nop 0
    buffer_load_dwordx4 v113, s[24:27], s58 offen sc1 lds
    s_add_u32 m0, s61, s90
    s_nop 0
    buffer_load_dwordx4 v114, s[24:27], s58 offen sc1 lds
    s_add_u32 s58, s58, s60
    s_sub_u32 s60, 20480, s60
    s_add_u32 s61, s61, 22528
    s_cmp_eq_u32 s61, 67584
    s_cselect_b32 s61, 0, s61
L_p2n:
    v_mfma_f32_32x32x16_bf16 v[80:95], v[140:143], v[102:105], 0
    ds_read2st64_b64 v[140:143], v108 offset0:0 offset1:1
    v_exp_f32 v64, v64
    v_exp_f32 v65, v65
    v_exp_f32 v66, v66
    v_exp_f32 v67, v67
    v_cvt_pk_bf16_f32 v132, v64, v65
    v_cvt_pk_bf16_f32 v133, v66, v67
    v_mfma_f32_32x32x16_bf16 v[240:255], v[152:155], v[136:139], v[240:255]
    ds_read_b128 v[152:155], v111 offset:16896
    v_exp_f32 v68, v68
    v_exp_f32 v69, v69
    v_exp_f32 v70, v70
    v_exp_f32 v71, v71
    v_cvt_pk_bf16_f32 v134, v68, v69
    v_cvt_pk_bf16_f32 v135, v70, v71
    v_mfma_f32_32x32x8_bf16 v[80:95], v[144:145], v[106:107], v[80:95]
    ds_read_b64 v[144:145], v109 offset:0
    v_exp_f32 v72, v72
    v_exp_f32 v73, v73
    v_exp_f32 v74, v74
    v_exp_f32 v75, v75
    v_cvt_pk_bf16_f32 v136, v72, v73
    v_cvt_pk_bf16_f32 v137, v74, v75
    s_waitcnt lgkmcnt(3)
    v_mfma_f32_32x32x16_bf16 v[224:239], v[148:151], v[132:135], v[224:239]
    v_exp_f32 v76, v76
    v_exp_f32 v77, v77
    v_exp_f32 v78, v78
    v_exp_f32 v79, v79
    v_cvt_pk_bf16_f32 v138, v76, v77
    v_cvt_pk_bf16_f32 v139, v78, v79
    s_waitcnt lgkmcnt(0)
    v_mfma_f32_32x32x16_bf16 v[64:79], v[140:143], v[96:99], 0
    v_exp_f32 v80, v80
    v_exp_f32 v81, v81
    v_exp_f32 v82, v82
    v_exp_f32 v83, v83
    v_cvt_pk_bf16_f32 v132, v80, v81
    v_cvt_pk_bf16_f32 v133, v82, v83
    v_mfma_f32_32x32x16_bf16 v[224:239], v[152:155], v[136:139], v[224:239]
    v_exp_f32 v84, v84
    v_exp_f32 v85, v85
    v_exp_f32 v86, v86
    v_exp_f32 v87, v87
    v_cvt_pk_bf16_f32 v134, v84, v85
    v_cvt_pk_bf16_f32 v135, v86, v87
    v_mfma_f32_32x32x8_bf16 v[64:79], v[144:145], v[100:101], v[64:79]
    v_exp_f32 v88, v88
    v_exp_f32 v89, v89
    v_exp_f32 v90, v90
    v_exp_f32 v91, v91
    v_cvt_pk_bf16_f32 v136, v88, v89
    v_cvt_pk_bf16_f32 v137, v90, v91
    v_mfma_f32_32x32x16_bf16 v[240:255], v[148:151], v[132:135], v[240:255]
    ds_read_b128 v[148:151], v110 offset:0
    v_exp_f32 v92, v92
    v_exp_f32 v93, v93
    v_exp_f32 v94, v94
    v_exp_f32 v95, v95
    v_cvt_pk_bf16_f32 v138, v92, v93
    v_cvt_pk_bf16_f32 v139, v94, v95
    v_add_u32 v111, s56, v111
    s_add_u32 s54, s54, 1
    s_cmp_lt_u32 s54, 24
    s_cbranch_scc1 L_att2
    s_add_u32 m0, s96, 0
    s_add_u32 s42, s97, 20480
    s_mov_b32 exec_hi, 0xff
    buffer_load_dwordx4 v119, s[68:71], s42 offen lds
    s_mov_b32 exec_hi, -1
    s_add_u32 m0, s96, 640
    s_add_u32 s42, s97, 46080
    s_mov_b32 exec_hi, 0xff
    buffer_load_dwordx4 v119, s[68:71], s42 offen lds
    s_mov_b32 exec_hi, -1
    s_add_u32 m0, s96, 10240
    s_add_u32 s42, s97, 20480
    s_mov_b32 exec_hi, 0xff
    buffer_load_dwordx4 v119, s[72:75], s42 offen lds
    s_mov_b32 exec_hi, -1
    s_add_u32 m0, s96, 10880
    s_add_u32 s42, s97, 46080
    s_mov_b32 exec_hi, 0xff
    buffer_load_dwordx4 v119, s[72:75], s42 offen lds
    s_mov_b32 exec_hi, -1
    s_waitcnt vmcnt(0) lgkmcnt(0)
    s_nop 15
    s_branch L_final
L_gemm_v:
    s_lshl_b32 s42, s65, 6
    v_add_u32 v64, s42, v19
    v_mul_u32_u24 v67, 320, v18
    v_add_u32 v65, 0, v64
    v_mul_u32_u24 v66, 3277, v65
    v_lshrrev_b32 v66, 16, v66
    v_mad_u32_u24 v32, v66, s43, v67
    v_lshl_add_u32 v32, v65, 4, v32
    v_mul_u32_u24 v66, 320, v66
    v_sub_u32 v32, v32, v66
    v_add_u32 v65, 32, v64
    v_mul_u32_u24 v66, 3277, v65
    v_lshrrev_b32 v66, 16, v66
    v_mad_u32_u24 v33, v66, s43, v67
    v_lshl_add_u32 v33, v65, 4, v33
    v_mul_u32_u24 v66, 320, v66
    v_sub_u32 v33, v33, v66
    buffer_load_dword v46, v20, s[16:19], s55 offen
    s_waitcnt vmcnt(5)
    s_barrier
    ds_read_b128 v[96:99], v4 offset:0
    ds_read_b64_tr_b16 v[48:49], v40 offset:16384
    ds_read_b64_tr_b16 v[50:51], v40 offset:17408
    ds_read_b64_tr_b16 v[52:53], v41 offset:16384
    ds_read_b64_tr_b16 v[54:55], v41 offset:17408
    ds_read_b128 v[100:103], v5 offset:0
    ds_read_b64_tr_b16 v[56:57], v40 offset:20480
    ds_read_b64_tr_b16 v[58:59], v40 offset:21504
    ds_read_b64_tr_b16 v[60:61], v41 offset:20480
    ds_read_b64_tr_b16 v[62:63], v41 offset:21504
    s_waitcnt lgkmcnt(7)
    v_mfma_f32_32x32x16_bf16 v[64:79], v[96:99], v[48:51], 0
    ds_read_b128 v[104:107], v6 offset:0
    ds_read_b64_tr_b16 v[48:49], v40 offset:24576
    ds_read_b64_tr_b16 v[50:51], v40 offset:25600
    s_add_u32 m0, s46, 65536
    s_add_u32 s91, s38, s60
    buffer_load_dwordx4 v2, s[4:7], s91 offen lds
    s_waitcnt lgkmcnt(8)
    v_mfma_f32_32x32x16_bf16 v[80:95], v[96:99], v[52:55], 0
    ds_read_b64_tr_b16 v[52:53], v41 offset:24576
    ds_read_b64_tr_b16 v[54:55], v41 offset:25600
    s_add_u32 m0, s46, 66560
    s_nop 0
    buffer_load_dwordx4 v3, s[4:7], s91 offen lds
    s_waitcnt lgkmcnt(7)
    v_mfma_f32_32x32x16_bf16 v[64:79], v[100:103], v[56:59], v[64:79]
    ds_read_b128 v[108:111], v7 offset:0
    ds_read_b64_tr_b16 v[56:57], v40 offset:28672
    ds_read_b64_tr_b16 v[58:59], v40 offset:29696
    s_mul_i32 s92, s60, 1920
    s_add_u32 m0, s46, 81920
    s_add_u32 s92, s92, s39
    buffer_load_dwordx4 v0, s[8:11], s92 offen lds
    s_waitcnt lgkmcnt(8)
    v_mfma_f32_32x32x16_bf16 v[80:95], v[100:103], v[60:63], v[80:95]
    ds_read_b64_tr_b16 v[60:61], v41 offset:28672
    ds_read_b64_tr_b16 v[62:63], v41 offset:29696
    s_add_u32 m0, s46, 82944
    s_add_u32 s92, s92, 15360
    buffer_load_dwordx4 v0, s[8:11], s92 offen lds
    s_add_u32 s60, s60, 128
    s_cmp_eq_u32 s60, 1280
    s_cselect_b32 s60, 0, s60
    s_waitcnt vmcnt(5)
    s_barrier
    s_waitcnt lgkmcnt(7)
    v_mfma_f32_32x32x16_bf16 v[64:79], v[104:107], v[48:51], v[64:79]
    ds_read_b128 v[112:115], v4 offset:32768
    ds_read_b64_tr_b16 v[48:49], v40 offset:49152
    ds_read_b64_tr_b16 v[50:51], v40 offset:50176
    s_add_u32 m0, s46, 98304
    s_add_u32 s91, s38, s60
    buffer_load_dwordx4 v2, s[4:7], s91 offen lds
    s_waitcnt lgkmcnt(8)
    v_mfma_f32_32x32x16_bf16 v[80:95], v[104:107], v[52:55], v[80:95]
    ds_read_b64_tr_b16 v[52:53], v41 offset:49152
    ds_read_b64_tr_b16 v[54:55], v41 offset:50176
    s_add_u32 m0, s46, 99328
    s_nop 0
    buffer_load_dwordx4 v3, s[4:7], s91 offen lds
    s_waitcnt lgkmcnt(7)
    v_mfma_f32_32x32x16_bf16 v[64:79], v[108:111], v[56:59], v[64:79]
    ds_read_b128 v[116:119], v5 offset:32768
    ds_read_b64_tr_b16 v[56:57], v40 offset:53248
    ds_read_b64_tr_b16 v[58:59], v40 offset:54272
    s_mul_i32 s92, s60, 1920
    s_add_u32 m0, s46, 114688
    s_add_u32 s92, s92, s39
    buffer_load_dwordx4 v0, s[8:11], s92 offen lds
    s_waitcnt lgkmcnt(8)
    v_mfma_f32_32x32x16_bf16 v[80:95], v[108:111], v[60:63], v[80:95]
    ds_read_b64_tr_b16 v[60:61], v41 offset:53248
    ds_read_b64_tr_b16 v[62:63], v41 offset:54272
    s_add_u32 m0, s46, 115712
    s_add_u32 s92, s92, 15360
    buffer_load_dwordx4 v0, s[8:11], s92 offen lds
    s_add_u32 s60, s60, 128
    s_cmp_eq_u32 s60, 1280
    s_cselect_b32 s60, 0, s60
    s_waitcnt lgkmcnt(7)
    v_mfma_f32_32x32x16_bf16 v[64:79], v[112:115], v[48:51], v[64:79]
    ds_read_b128 v[120:123], v6 offset:32768
    ds_read_b64_tr_b16 v[48:49], v40 offset:57344
    ds_read_b64_tr_b16 v[50:51], v40 offset:58368
    s_waitcnt lgkmcnt(8)
    v_mfma_f32_32x32x16_bf16 v[80:95], v[112:115], v[52:55], v[80:95]
    ds_read_b64_tr_b16 v[52:53], v41 offset:57344
    ds_read_b64_tr_b16 v[54:55], v41 offset:58368
    s_add_u32 m0, s46, 131072
    s_add_u32 s91, s38, s60
    buffer_load_dwordx4 v2, s[4:7], s91 offen lds
    s_waitcnt lgkmcnt(7)
    v_mfma_f32_32x32x16_bf16 v[64:79], v[116:119], v[56:59], v[64:79]
    ds_read_b128 v[124:127], v7 offset:32768
    ds_read_b64_tr_b16 v[56:57], v40 offset:61440
    ds_read_b64_tr_b16 v[58:59], v40 offset:62464
    s_waitcnt lgkmcnt(8)
    v_mfma_f32_32x32x16_bf16 v[80:95], v[116:119], v[60:63], v[80:95]
    ds_read_b64_tr_b16 v[60:61], v41 offset:61440
    ds_read_b64_tr_b16 v[62:63], v41 offset:62464
    s_add_u32 m0, s46, 132096
    s_nop 0
    buffer_load_dwordx4 v3, s[4:7], s91 offen lds
    s_waitcnt vmcnt(6)
    s_barrier
    s_waitcnt lgkmcnt(7)
    v_mfma_f32_32x32x16_bf16 v[64:79], v[120:123], v[48:51], v[64:79]
    ds_read_b128 v[128:131], v8 offset:0
    ds_read_b64_tr_b16 v[48:49], v42 offset:16384
    ds_read_b64_tr_b16 v[50:51], v42 offset:17408
    s_waitcnt lgkmcnt(8)
    v_mfma_f32_32x32x16_bf16 v[80:95], v[120:123], v[52:55], v[80:95]
    ds_read_b64_tr_b16 v[52:53], v43 offset:16384
    ds_read_b64_tr_b16 v[54:55], v43 offset:17408
    s_mul_i32 s92, s60, 1920
    s_add_u32 m0, s46, 147456
    s_add_u32 s92, s92, s39
    buffer_load_dwordx4 v0, s[8:11], s92 offen lds
    s_waitcnt lgkmcnt(7)
    v_mfma_f32_32x32x16_bf16 v[64:79], v[124:127], v[56:59], v[64:79]
    ds_read_b128 v[132:135], v9 offset:0
    ds_read_b64_tr_b16 v[56:57], v42 offset:20480
    ds_read_b64_tr_b16 v[58:59], v42 offset:21504
    s_waitcnt lgkmcnt(8)
    v_mfma_f32_32x32x16_bf16 v[80:95], v[124:127], v[60:63], v[80:95]
    ds_read_b64_tr_b16 v[60:61], v43 offset:20480
    ds_read_b64_tr_b16 v[62:63], v43 offset:21504
    s_add_u32 m0, s46, 148480
    s_add_u32 s92, s92, 15360
    buffer_load_dwordx4 v0, s[8:11], s92 offen lds
    s_add_u32 s60, s60, 128
    s_cmp_eq_u32 s60, 1280
    s_cselect_b32 s60, 0, s60
    s_waitcnt lgkmcnt(7)
    v_mfma_f32_32x32x16_bf16 v[64:79], v[128:131], v[48:51], v[64:79]
    ds_read_b128 v[136:139], v10 offset:0
    ds_read_b64_tr_b16 v[48:49], v42 offset:24576
    ds_read_b64_tr_b16 v[50:51], v42 offset:25600
    s_waitcnt lgkmcnt(8)
    v_mfma_f32_32x32x16_bf16 v[80:95], v[128:131], v[52:55], v[80:95]
    ds_read_b64_tr_b16 v[52:53], v43 offset:24576
    ds_read_b64_tr_b16 v[54:55], v43 offset:25600
    s_add_u32 m0, s46, 0
    s_add_u32 s91, s38, s60
    buffer_load_dwordx4 v2, s[4:7], s91 offen lds
    s_waitcnt lgkmcnt(7)
    v_mfma_f32_32x32x16_bf16 v[64:79], v[132:135], v[56:59], v[64:79]
    ds_read_b128 v[140:143], v11 offset:0
    ds_read_b64_tr_b16 v[56:57], v42 offset:28672
    ds_read_b64_tr_b16 v[58:59], v42 offset:29696
    s_waitcnt lgkmcnt(8)
    v_mfma_f32_32x32x16_bf16 v[80:95], v[132:135], v[60:63], v[80:95]
    ds_read_b64_tr_b16 v[60:61], v43 offset:28672
    ds_read_b64_tr_b16 v[62:63], v43 offset:29696
    s_add_u32 m0, s46, 1024
    s_nop 0
    buffer_load_dwordx4 v3, s[4:7], s91 offen lds
    s_waitcnt vmcnt(6)
    s_barrier
    s_waitcnt lgkmcnt(7)
    v_mfma_f32_32x32x16_bf16 v[64:79], v[136:139], v[48:51], v[64:79]
    ds_read_b128 v[144:147], v8 offset:32768
    ds_read_b64_tr_b16 v[48:49], v42 offset:49152
    ds_read_b64_tr_b16 v[50:51], v42 offset:50176
    s_waitcnt lgkmcnt(8)
    v_mfma_f32_32x32x16_bf16 v[80:95], v[136:139], v[52:55], v[80:95]
    ds_read_b64_tr_b16 v[52:53], v43 offset:49152
    ds_read_b64_tr_b16 v[54:55], v43 offset:50176
    s_mul_i32 s92, s60, 1920
    s_add_u32 m0, s46, 16384
    s_add_u32 s92, s92, s39
    buffer_load_dwordx4 v0, s[8:11], s92 offen lds
    s_waitcnt lgkmcnt(7)
    v_mfma_f32_32x32x16_bf16 v[64:79], v[140:143], v[56:59], v[64:79]
    ds_read_b128 v[148:151], v9 offset:32768
    ds_read_b64_tr_b16 v[56:57], v42 offset:53248
    ds_read_b64_tr_b16 v[58:59], v42 offset:54272
    s_waitcnt lgkmcnt(8)
    v_mfma_f32_32x32x16_bf16 v[80:95], v[140:143], v[60:63], v[80:95]
    ds_read_b64_tr_b16 v[60:61], v43 offset:53248
    ds_read_b64_tr_b16 v[62:63], v43 offset:54272
    s_add_u32 m0, s46, 17408
    s_add_u32 s92, s92, 15360
    buffer_load_dwordx4 v0, s[8:11], s92 offen lds
    s_add_u32 s60, s60, 128
    s_cmp_eq_u32 s60, 1280
    s_cselect_b32 s60, 0, s60
    s_waitcnt lgkmcnt(7)
    v_mfma_f32_32x32x16_bf16 v[64:79], v[144:147], v[48:51], v[64:79]
    ds_read_b128 v[152:155], v10 offset:32768
    ds_read_b64_tr_b16 v[48:49], v42 offset:57344
    ds_read_b64_tr_b16 v[50:51], v42 offset:58368
    s_waitcnt lgkmcnt(8)
    v_mfma_f32_32x32x16_bf16 v[80:95], v[144:147], v[52:55], v[80:95]
    ds_read_b64_tr_b16 v[52:53], v43 offset:57344
    ds_read_b64_tr_b16 v[54:55], v43 offset:58368
    s_add_u32 m0, s46, 32768
    s_add_u32 s91, s38, s60
    buffer_load_dwordx4 v2, s[4:7], s91 offen lds
    s_waitcnt lgkmcnt(7)
    v_mfma_f32_32x32x16_bf16 v[64:79], v[148:151], v[56:59], v[64:79]
    ds_read_b128 v[156:159], v11 offset:32768
    ds_read_b64_tr_b16 v[56:57], v42 offset:61440
    ds_read_b64_tr_b16 v[58:59], v42 offset:62464
    s_waitcnt lgkmcnt(8)
    v_mfma_f32_32x32x16_bf16 v[80:95], v[148:151], v[60:63], v[80:95]
    ds_read_b64_tr_b16 v[60:61], v43 offset:61440
    ds_read_b64_tr_b16 v[62:63], v43 offset:62464
    s_add_u32 m0, s46, 33792
    s_nop 0
    buffer_load_dwordx4 v3, s[4:7], s91 offen lds
    s_waitcnt vmcnt(6)
    s_barrier
    s_waitcnt lgkmcnt(7)
    v_mfma_f32_32x32x16_bf16 v[64:79], v[152:155], v[48:51], v[64:79]
    ds_read_b128 v[160:163], v12 offset:0
    ds_read_b64_tr_b16 v[48:49], v44 offset:16384
    ds_read_b64_tr_b16 v[50:51], v44 offset:17408
    s_waitcnt lgkmcnt(8)
    v_mfma_f32_32x32x16_bf16 v[80:95], v[152:155], v[52:55], v[80:95]
    ds_read_b64_tr_b16 v[52:53], v45 offset:16384
    ds_read_b64_tr_b16 v[54:55], v45 offset:17408
    s_mul_i32 s92, s60, 1920
    s_add_u32 m0, s46, 49152
    s_add_u32 s92, s92, s39
    buffer_load_dwordx4 v0, s[8:11], s92 offen lds
    s_waitcnt lgkmcnt(7)
    v_mfma_f32_32x32x16_bf16 v[64:79], v[156:159], v[56:59], v[64:79]
    ds_read_b128 v[164:167], v13 offset:0
    ds_read_b64_tr_b16 v[56:57], v44 offset:20480
    ds_read_b64_tr_b16 v[58:59], v44 offset:21504
    s_waitcnt lgkmcnt(8)
    v_mfma_f32_32x32x16_bf16 v[80:95], v[156:159], v[60:63], v[80:95]
    ds_read_b64_tr_b16 v[60:61], v45 offset:20480
    ds_read_b64_tr_b16 v[62:63], v45 offset:21504
    s_add_u32 m0, s46, 50176
    s_add_u32 s92, s92, 15360
    buffer_load_dwordx4 v0, s[8:11], s92 offen lds
    s_add_u32 s60, s60, 128
    s_cmp_eq_u32 s60, 1280
    s_cselect_b32 s60, 0, s60
    s_waitcnt lgkmcnt(7)
    v_mfma_f32_32x32x16_bf16 v[64:79], v[160:163], v[48:51], v[64:79]
    ds_read_b128 v[168:171], v14 offset:0
    ds_read_b64_tr_b16 v[48:49], v44 offset:24576
    ds_read_b64_tr_b16 v[50:51], v44 offset:25600
    s_waitcnt lgkmcnt(8)
    v_mfma_f32_32x32x16_bf16 v[80:95], v[160:163], v[52:55], v[80:95]
    ds_read_b64_tr_b16 v[52:53], v45 offset:24576
    ds_read_b64_tr_b16 v[54:55], v45 offset:25600
    s_add_u32 m0, s46, 65536
    s_add_u32 s91, s38, s60
    buffer_load_dwordx4 v2, s[4:7], s91 offen lds
    s_waitcnt lgkmcnt(7)
    v_mfma_f32_32x32x16_bf16 v[64:79], v[164:167], v[56:59], v[64:79]
    ds_read_b128 v[172:175], v15 offset:0
    ds_read_b64_tr_b16 v[56:57], v44 offset:28672
    ds_read_b64_tr_b16 v[58:59], v44 offset:29696
    s_waitcnt lgkmcnt(8)
    v_mfma_f32_32x32x16_bf16 v[80:95], v[164:167], v[60:63], v[80:95]
    ds_read_b64_tr_b16 v[60:61], v45 offset:28672
    ds_read_b64_tr_b16 v[62:63], v45 offset:29696
    s_add_u32 m0, s46, 66560
    s_nop 0
    buffer_load_dwordx4 v3, s[4:7], s91 offen lds
    s_waitcnt vmcnt(6)
    s_barrier
    s_waitcnt lgkmcnt(7)
    v_mfma_f32_32x32x16_bf16 v[64:79], v[168:171], v[48:51], v[64:79]
    ds_read_b128 v[176:179], v4 offset:0
    ds_read_b64_tr_b16 v[48:49], v40 offset:16384
    ds_read_b64_tr_b16 v[50:51], v40 offset:17408
    s_waitcnt lgkmcnt(8)
    v_mfma_f32_32x32x16_bf16 v[80:95], v[168:171], v[52:55], v[80:95]
    ds_read_b64_tr_b16 v[52:53], v41 offset:16384
    ds_read_b64_tr_b16 v[54:55], v41 offset:17408
    s_mul_i32 s92, s60, 1920
    s_add_u32 m0, s46, 81920
    s_add_u32 s92, s92, s39
    buffer_load_dwordx4 v0, s[8:11], s92 offen lds
    s_waitcnt lgkmcnt(7)
    v_mfma_f32_32x32x16_bf16 v[64:79], v[172:175], v[56:59], v[64:79]
    ds_read_b128 v[180:183], v5 offset:0
    ds_read_b64_tr_b16 v[56:57], v40 offset:20480
    ds_read_b64_tr_b16 v[58:59], v40 offset:21504
    s_waitcnt lgkmcnt(8)
    v_mfma_f32_32x32x16_bf16 v[80:95], v[172:175], v[60:63], v[80:95]
    ds_read_b64_tr_b16 v[60:61], v41 offset:20480
    ds_read_b64_tr_b16 v[62:63], v41 offset:21504
    s_add_u32 m0, s46, 82944
    s_add_u32 s92, s92, 15360
    buffer_load_dwordx4 v0, s[8:11], s92 offen lds
    s_add_u32 s60, s60, 128
    s_cmp_eq_u32 s60, 1280
    s_cselect_b32 s60, 0, s60
    s_waitcnt lgkmcnt(7)
    v_mfma_f32_32x32x16_bf16 v[64:79], v[176:179], v[48:51], v[64:79]
    ds_read_b128 v[184:187], v6 offset:0
    ds_read_b64_tr_b16 v[48:49], v40 offset:24576
    ds_read_b64_tr_b16 v[50:51], v40 offset:25600
    s_waitcnt lgkmcnt(8)
    v_mfma_f32_32x32x16_bf16 v[80:95], v[176:179], v[52:55], v[80:95]
    ds_read_b64_tr_b16 v[52:53], v41 offset:24576
    ds_read_b64_tr_b16 v[54:55], v41 offset:25600
    s_add_u32 m0, s46, 98304
    s_add_u32 s91, s38, s60
    buffer_load_dwordx4 v2, s[4:7], s91 offen lds
    s_waitcnt lgkmcnt(7)
    v_mfma_f32_32x32x16_bf16 v[64:79], v[180:183], v[56:59], v[64:79]
    ds_read_b128 v[188:191], v7 offset:0
    ds_read_b64_tr_b16 v[56:57], v40 offset:28672
    ds_read_b64_tr_b16 v[58:59], v40 offset:29696
    s_waitcnt lgkmcnt(8)
    v_mfma_f32_32x32x16_bf16 v[80:95], v[180:183], v[60:63], v[80:95]
    ds_read_b64_tr_b16 v[60:61], v41 offset:28672
    ds_read_b64_tr_b16 v[62:63], v41 offset:29696
    s_add_u32 m0, s46, 99328
    s_nop 0
    buffer_load_dwordx4 v3, s[4:7], s91 offen lds
    s_waitcnt vmcnt(6)
    s_barrier
    s_waitcnt lgkmcnt(7)
    v_mfma_f32_32x32x16_bf16 v[64:79], v[184:187], v[48:51], v[64:79]
    ds_read_b128 v[192:195], v4 offset:32768
    ds_read_b64_tr_b16 v[48:49], v40 offset:49152
    ds_read_b64_tr_b16 v[50:51], v40 offset:50176
    s_waitcnt lgkmcnt(8)
    v_mfma_f32_32x32x16_bf16 v[80:95], v[184:187], v[52:55], v[80:95]
    ds_read_b64_tr_b16 v[52:53], v41 offset:49152
    ds_read_b64_tr_b16 v[54:55], v41 offset:50176
    s_mul_i32 s92, s60, 1920
    s_add_u32 m0, s46, 114688
    s_add_u32 s92, s92, s39
    buffer_load_dwordx4 v0, s[8:11], s92 offen lds
    s_waitcnt lgkmcnt(7)
    v_mfma_f32_32x32x16_bf16 v[64:79], v[188:191], v[56:59], v[64:79]
    ds_read_b128 v[196:199], v5 offset:32768
    ds_read_b64_tr_b16 v[56:57], v40 offset:53248
    ds_read_b64_tr_b16 v[58:59], v40 offset:54272
    s_waitcnt lgkmcnt(8)
    v_mfma_f32_32x32x16_bf16 v[80:95], v[188:191], v[60:63], v[80:95]
    ds_read_b64_tr_b16 v[60:61], v41 offset:53248
    ds_read_b64_tr_b16 v[62:63], v41 offset:54272
    s_add_u32 m0, s46, 115712
    s_add_u32 s92, s92, 15360
    buffer_load_dwordx4 v0, s[8:11], s92 offen lds
    s_add_u32 s60, s60, 128
    s_cmp_eq_u32 s60, 1280
    s_cselect_b32 s60, 0, s60
    s_waitcnt lgkmcnt(7)
    v_mfma_f32_32x32x16_bf16 v[64:79], v[192:195], v[48:51], v[64:79]
    ds_read_b128 v[200:203], v6 offset:32768
    ds_read_b64_tr_b16 v[48:49], v40 offset:57344
    ds_read_b64_tr_b16 v[50:51], v40 offset:58368
    s_waitcnt lgkmcnt(8)
    v_mfma_f32_32x32x16_bf16 v[80:95], v[192:195], v[52:55], v[80:95]
    ds_read_b64_tr_b16 v[52:53], v41 offset:57344
    ds_read_b64_tr_b16 v[54:55], v41 offset:58368
    s_add_u32 m0, s46, 131072
    s_add_u32 s91, s38, s60
    buffer_load_dwordx4 v2, s[4:7], s91 offen lds
    s_waitcnt lgkmcnt(7)
    v_mfma_f32_32x32x16_bf16 v[64:79], v[196:199], v[56:59], v[64:79]
    ds_read_b128 v[204:207], v7 offset:32768
    ds_read_b64_tr_b16 v[56:57], v40 offset:61440
    ds_read_b64_tr_b16 v[58:59], v40 offset:62464
    s_waitcnt lgkmcnt(8)
    v_mfma_f32_32x32x16_bf16 v[80:95], v[196:199], v[60:63], v[80:95]
    ds_read_b64_tr_b16 v[60:61], v41 offset:61440
    ds_read_b64_tr_b16 v[62:63], v41 offset:62464
    s_add_u32 m0, s46, 132096
    s_nop 0
    buffer_load_dwordx4 v3, s[4:7], s91 offen lds
    s_waitcnt vmcnt(6)
    s_barrier
    s_waitcnt lgkmcnt(7)
    v_mfma_f32_32x32x16_bf16 v[64:79], v[200:203], v[48:51], v[64:79]
    ds_read_b128 v[208:211], v8 offset:0
    ds_read_b64_tr_b16 v[48:49], v42 offset:16384
    ds_read_b64_tr_b16 v[50:51], v42 offset:17408
    s_waitcnt lgkmcnt(8)
    v_mfma_f32_32x32x16_bf16 v[80:95], v[200:203], v[52:55], v[80:95]
    ds_read_b64_tr_b16 v[52:53], v43 offset:16384
    ds_read_b64_tr_b16 v[54:55], v43 offset:17408
    s_mul_i32 s92, s60, 1920
    s_add_u32 m0, s46, 147456
    s_add_u32 s92, s92, s39
    buffer_load_dwordx4 v0, s[8:11], s92 offen lds
    s_waitcnt lgkmcnt(7)
    v_mfma_f32_32x32x16_bf16 v[64:79], v[204:207], v[56:59], v[64:79]
    ds_read_b128 v[212:215], v9 offset:0
    ds_read_b64_tr_b16 v[56:57], v42 offset:20480
    ds_read_b64_tr_b16 v[58:59], v42 offset:21504
    s_waitcnt lgkmcnt(8)
    v_mfma_f32_32x32x16_bf16 v[80:95], v[204:207], v[60:63], v[80:95]
    ds_read_b64_tr_b16 v[60:61], v43 offset:20480
    ds_read_b64_tr_b16 v[62:63], v43 offset:21504
    s_add_u32 m0, s46, 148480
    s_add_u32 s92, s92, 15360
    buffer_load_dwordx4 v0, s[8:11], s92 offen lds
    s_add_u32 s60, s60, 128
    s_cmp_eq_u32 s60, 1280
    s_cselect_b32 s60, 0, s60
    s_mov_b64 exec, 0xfffff
    buffer_load_dword v46, v47, s[12:15], s37 offen
    s_mov_b64 exec, -1
    s_waitcnt lgkmcnt(7)
    v_mfma_f32_32x32x16_bf16 v[64:79], v[208:211], v[48:51], v[64:79]
    ds_read_b128 v[216:219], v10 offset:0
    ds_read_b64_tr_b16 v[48:49], v42 offset:24576
    ds_read_b64_tr_b16 v[50:51], v42 offset:25600
    s_waitcnt lgkmcnt(8)
    v_mfma_f32_32x32x16_bf16 v[80:95], v[208:211], v[52:55], v[80:95]
    ds_read_b64_tr_b16 v[52:53], v43 offset:24576
    ds_read_b64_tr_b16 v[54:55], v43 offset:25600
    s_mul_i32 s92, s60, 1920
    s_add_u32 m0, s46, 0
    s_add_u32 s92, s92, s39
    buffer_load_dwordx4 v0, s[12:15], s92 offen lds
    s_waitcnt lgkmcnt(7)
    v_mfma_f32_32x32x16_bf16 v[64:79], v[212:215], v[56:59], v[64:79]
    ds_read_b128 v[220:223], v11 offset:0
    ds_read_b64_tr_b16 v[56:57], v42 offset:28672
    ds_read_b64_tr_b16 v[58:59], v42 offset:29696
    s_waitcnt lgkmcnt(8)
    v_mfma_f32_32x32x16_bf16 v[80:95], v[212:215], v[60:63], v[80:95]
    ds_read_b64_tr_b16 v[60:61], v43 offset:28672
    ds_read_b64_tr_b16 v[62:63], v43 offset:29696
    s_add_u32 m0, s46, 1024
    s_add_u32 s92, s92, 15360
    buffer_load_dwordx4 v0, s[12:15], s92 offen lds
    s_add_u32 s60, s60, 128
    s_cmp_eq_u32 s60, 1280
    s_cselect_b32 s60, 0, s60
    s_waitcnt vmcnt(7)
    s_barrier
    s_waitcnt lgkmcnt(7)
    v_mfma_f32_32x32x16_bf16 v[64:79], v[216:219], v[48:51], v[64:79]
    ds_read_b128 v[224:227], v8 offset:32768
    ds_read_b64_tr_b16 v[48:49], v42 offset:49152
    ds_read_b64_tr_b16 v[50:51], v42 offset:50176
    s_waitcnt lgkmcnt(8)
    v_mfma_f32_32x32x16_bf16 v[80:95], v[216:219], v[52:55], v[80:95]
    ds_read_b64_tr_b16 v[52:53], v43 offset:49152
    ds_read_b64_tr_b16 v[54:55], v43 offset:50176
    s_mul_i32 s92, s60, 1920
    s_add_u32 m0, s46, 16384
    s_add_u32 s92, s92, s39
    buffer_load_dwordx4 v0, s[12:15], s92 offen lds
    s_waitcnt lgkmcnt(7)
    v_mfma_f32_32x32x16_bf16 v[64:79], v[220:223], v[56:59], v[64:79]
    ds_read_b128 v[228:231], v9 offset:32768
    ds_read_b64_tr_b16 v[56:57], v42 offset:53248
    ds_read_b64_tr_b16 v[58:59], v42 offset:54272
    s_waitcnt lgkmcnt(8)
    v_mfma_f32_32x32x16_bf16 v[80:95], v[220:223], v[60:63], v[80:95]
    ds_read_b64_tr_b16 v[60:61], v43 offset:53248
    ds_read_b64_tr_b16 v[62:63], v43 offset:54272
    s_add_u32 m0, s46, 17408
    s_add_u32 s92, s92, 15360
    buffer_load_dwordx4 v0, s[12:15], s92 offen lds
    s_add_u32 s60, s60, 128
    s_cmp_eq_u32 s60, 1280
    s_cselect_b32 s60, 0, s60
    s_waitcnt lgkmcnt(7)
    v_mfma_f32_32x32x16_bf16 v[64:79], v[224:227], v[48:51], v[64:79]
    ds_read_b128 v[232:235], v10 offset:32768
    ds_read_b64_tr_b16 v[48:49], v42 offset:57344
    ds_read_b64_tr_b16 v[50:51], v42 offset:58368
    s_waitcnt lgkmcnt(8)
    v_mfma_f32_32x32x16_bf16 v[80:95], v[224:227], v[52:55], v[80:95]
    ds_read_b64_tr_b16 v[52:53], v43 offset:57344
    ds_read_b64_tr_b16 v[54:55], v43 offset:58368
    s_mul_i32 s92, s60, 1920
    s_add_u32 m0, s46, 32768
    s_add_u32 s92, s92, s39
    buffer_load_dwordx4 v0, s[12:15], s92 offen lds
    s_waitcnt lgkmcnt(7)
    v_mfma_f32_32x32x16_bf16 v[64:79], v[228:231], v[56:59], v[64:79]
    ds_read_b128 v[236:239], v11 offset:32768
    ds_read_b64_tr_b16 v[56:57], v42 offset:61440
    ds_read_b64_tr_b16 v[58:59], v42 offset:62464
    s_waitcnt lgkmcnt(8)
    v_mfma_f32_32x32x16_bf16 v[80:95], v[228:231], v[60:63], v[80:95]
    ds_read_b64_tr_b16 v[60:61], v43 offset:61440
    ds_read_b64_tr_b16 v[62:63], v43 offset:62464
    s_add_u32 m0, s46, 33792
    s_add_u32 s92, s92, 15360
    buffer_load_dwordx4 v0, s[12:15], s92 offen lds
    s_add_u32 s60, s60, 128
    s_cmp_eq_u32 s60, 1280
    s_cselect_b32 s60, 0, s60
    s_waitcnt vmcnt(7)
    s_barrier
    s_waitcnt lgkmcnt(7)
    v_mfma_f32_32x32x16_bf16 v[64:79], v[232:235], v[48:51], v[64:79]
    ds_read_b128 v[240:243], v12 offset:0
    ds_read_b64_tr_b16 v[48:49], v44 offset:16384
    ds_read_b64_tr_b16 v[50:51], v44 offset:17408
    s_waitcnt lgkmcnt(8)
    v_mfma_f32_32x32x16_bf16 v[80:95], v[232:235], v[52:55], v[80:95]
    ds_read_b64_tr_b16 v[52:53], v45 offset:16384
    ds_read_b64_tr_b16 v[54:55], v45 offset:17408
    s_mul_i32 s92, s60, 1920
    s_add_u32 m0, s46, 49152
    s_add_u32 s92, s92, s39
    buffer_load_dwordx4 v0, s[12:15], s92 offen lds
    s_waitcnt lgkmcnt(7)
    v_mfma_f32_32x32x16_bf16 v[64:79], v[236:239], v[56:59], v[64:79]
    ds_read_b128 v[244:247], v13 offset:0
    ds_read_b64_tr_b16 v[56:57], v44 offset:20480
    ds_read_b64_tr_b16 v[58:59], v44 offset:21504
    s_waitcnt lgkmcnt(8)
    v_mfma_f32_32x32x16_bf16 v[80:95], v[236:239], v[60:63], v[80:95]
    ds_read_b64_tr_b16 v[60:61], v45 offset:20480
    ds_read_b64_tr_b16 v[62:63], v45 offset:21504
    s_add_u32 m0, s46, 50176
    s_add_u32 s92, s92, 15360
    buffer_load_dwordx4 v0, s[12:15], s92 offen lds
    s_add_u32 s60, s60, 128
    s_cmp_eq_u32 s60, 1280
    s_cselect_b32 s60, 0, s60
    s_waitcnt lgkmcnt(7)
    v_mfma_f32_32x32x16_bf16 v[64:79], v[240:243], v[48:51], v[64:79]
    ds_read_b128 v[248:251], v14 offset:0
    ds_read_b64_tr_b16 v[48:49], v44 offset:24576
    ds_read_b64_tr_b16 v[50:51], v44 offset:25600
    s_waitcnt lgkmcnt(8)
    v_mfma_f32_32x32x16_bf16 v[80:95], v[240:243], v[52:55], v[80:95]
    ds_read_b64_tr_b16 v[52:53], v45 offset:24576
    ds_read_b64_tr_b16 v[54:55], v45 offset:25600
    s_mul_i32 s92, s60, 1920
    s_add_u32 m0, s46, 65536
    s_add_u32 s92, s92, s39
    buffer_load_dwordx4 v0, s[12:15], s92 offen lds
    s_waitcnt lgkmcnt(7)
    v_mfma_f32_32x32x16_bf16 v[64:79], v[244:247], v[56:59], v[64:79]
    ds_read_b128 v[252:255], v15 offset:0
    ds_read_b64_tr_b16 v[56:57], v44 offset:28672
    ds_read_b64_tr_b16 v[58:59], v44 offset:29696
    s_waitcnt lgkmcnt(8)
    v_mfma_f32_32x32x16_bf16 v[80:95], v[244:247], v[60:63], v[80:95]
    ds_read_b64_tr_b16 v[60:61], v45 offset:28672
    ds_read_b64_tr_b16 v[62:63], v45 offset:29696
    s_add_u32 m0, s46, 66560
    s_add_u32 s92, s92, 15360
    buffer_load_dwordx4 v0, s[12:15], s92 offen lds
    s_add_u32 s60, s60, 128
    s_cmp_eq_u32 s60, 1280
    s_cselect_b32 s60, 0, s60
    s_waitcnt vmcnt(6)
    s_barrier
    s_waitcnt lgkmcnt(7)
    v_mfma_f32_32x32x16_bf16 v[64:79], v[248:251], v[48:51], v[64:79]
    ds_read_b64_tr_b16 v[48:49], v40 offset:0
    ds_read_b64_tr_b16 v[50:51], v40 offset:1024
    s_waitcnt lgkmcnt(7)
    v_mfma_f32_32x32x16_bf16 v[80:95], v[248:251], v[52:55], v[80:95]
    ds_read_b64_tr_b16 v[52:53], v41 offset:0
    ds_read_b64_tr_b16 v[54:55], v41 offset:1024
    s_mul_i32 s92, s60, 1920
    s_add_u32 m0, s46, 81920
    s_add_u32 s92, s92, s39
    buffer_load_dwordx4 v0, s[12:15], s92 offen lds
    s_waitcnt lgkmcnt(6)
    v_mfma_f32_32x32x16_bf16 v[64:79], v[252:255], v[56:59], v[64:79]
    ds_read_b64_tr_b16 v[56:57], v40 offset:4096
    ds_read_b64_tr_b16 v[58:59], v40 offset:5120
    s_waitcnt lgkmcnt(6)
    v_mfma_f32_32x32x16_bf16 v[80:95], v[252:255], v[60:63], v[80:95]
    ds_read_b64_tr_b16 v[60:61], v41 offset:4096
    ds_read_b64_tr_b16 v[62:63], v41 offset:5120
    s_add_u32 m0, s46, 82944
    s_add_u32 s92, s92, 15360
    buffer_load_dwordx4 v0, s[12:15], s92 offen lds
    s_add_u32 s60, s60, 128
    s_cmp_eq_u32 s60, 1280
    s_cselect_b32 s60, 0, s60
    s_nop 0
    v_cvt_pk_bf16_f32 v2, v64, v65
    v_cvt_pk_bf16_f32 v3, v66, v67
    v_cvt_pk_bf16_f32 v4, v68, v69
    v_cvt_pk_bf16_f32 v5, v70, v71
    v_cvt_pk_bf16_f32 v6, v72, v73
    v_cvt_pk_bf16_f32 v7, v74, v75
    v_cvt_pk_bf16_f32 v8, v76, v77
    v_cvt_pk_bf16_f32 v9, v78, v79
    v_cvt_pk_bf16_f32 v10, v80, v81
    v_cvt_pk_bf16_f32 v11, v82, v83
    v_cvt_pk_bf16_f32 v12, v84, v85
    v_cvt_pk_bf16_f32 v13, v86, v87
    v_cvt_pk_bf16_f32 v14, v88, v89
    v_cvt_pk_bf16_f32 v15, v90, v91
    v_cvt_pk_bf16_f32 v16, v92, v93
    v_cvt_pk_bf16_f32 v17, v94, v95
    s_waitcnt lgkmcnt(6)
    v_mfma_f32_32x32x16_bf16 v[64:79], v[96:99], v[48:51], 0
    ds_read_b64_tr_b16 v[48:49], v40 offset:8192
    ds_read_b64_tr_b16 v[50:51], v40 offset:9216
    buffer_store_dwordx4 v[2:5], v32, s[24:27], s47 offen offset:1280 sc1
    s_waitcnt lgkmcnt(6)
    v_mfma_f32_32x32x16_bf16 v[80:95], v[96:99], v[52:55], 0
    ds_read_b64_tr_b16 v[52:53], v41 offset:8192
    ds_read_b64_tr_b16 v[54:55], v41 offset:9216
    s_mul_i32 s92, s60, 1920
    s_add_u32 m0, s46, 98304
    s_add_u32 s92, s92, s39
    buffer_load_dwordx4 v0, s[12:15], s92 offen lds
    s_waitcnt lgkmcnt(6)
    v_mfma_f32_32x32x16_bf16 v[64:79], v[100:103], v[56:59], v[64:79]
    ds_read_b64_tr_b16 v[56:57], v40 offset:12288
    ds_read_b64_tr_b16 v[58:59], v40 offset:13312
    s_waitcnt lgkmcnt(6)
    v_mfma_f32_32x32x16_bf16 v[80:95], v[100:103], v[60:63], v[80:95]
    ds_read_b64_tr_b16 v[60:61], v41 offset:12288
    ds_read_b64_tr_b16 v[62:63], v41 offset:13312
    s_add_u32 m0, s46, 99328
    s_add_u32 s92, s92, 15360
    buffer_load_dwordx4 v0, s[12:15], s92 offen lds
    s_add_u32 s60, s60, 128
    s_cmp_eq_u32 s60, 1280
    s_cselect_b32 s60, 0, s60
    s_waitcnt lgkmcnt(6)
    v_mfma_f32_32x32x16_bf16 v[64:79], v[104:107], v[48:51], v[64:79]
    ds_read_b64_tr_b16 v[48:49], v40 offset:16384
    ds_read_b64_tr_b16 v[50:51], v40 offset:17408
    buffer_store_dwordx4 v[6:9], v32, s[24:27], s47 offen offset:1920 sc1
    s_waitcnt lgkmcnt(6)
    v_mfma_f32_32x32x16_bf16 v[80:95], v[104:107], v[52:55], v[80:95]
    ds_read_b64_tr_b16 v[52:53], v41 offset:16384
    ds_read_b64_tr_b16 v[54:55], v41 offset:17408
    s_mul_i32 s92, s60, 1920
    s_add_u32 m0, s46, 114688
    s_add_u32 s92, s92, s39
    buffer_load_dwordx4 v0, s[12:15], s92 offen lds
    s_waitcnt lgkmcnt(6)
    v_mfma_f32_32x32x16_bf16 v[64:79], v[108:111], v[56:59], v[64:79]
    ds_read_b64_tr_b16 v[56:57], v40 offset:20480
    ds_read_b64_tr_b16 v[58:59], v40 offset:21504
    s_waitcnt lgkmcnt(6)
    v_mfma_f32_32x32x16_bf16 v[80:95], v[108:111], v[60:63], v[80:95]
    ds_read_b64_tr_b16 v[60:61], v41 offset:20480
    ds_read_b64_tr_b16 v[62:63], v41 offset:21504
    s_add_u32 m0, s46, 115712
    s_add_u32 s92, s92, 15360
    buffer_load_dwordx4 v0, s[12:15], s92 offen lds
    s_add_u32 s60, s60, 128
    s_cmp_eq_u32 s60, 1280
    s_cselect_b32 s60, 0, s60
    s_waitcnt lgkmcnt(6)
    v_mfma_f32_32x32x16_bf16 v[64:79], v[112:115], v[48:51], v[64:79]
    ds_read_b64_tr_b16 v[48:49], v40 offset:24576
    ds_read_b64_tr_b16 v[50:51], v40 offset:25600
    buffer_store_dwordx4 v[10:13], v33, s[24:27], s47 offen offset:1280 sc1
    s_waitcnt lgkmcnt(6)
    v_mfma_f32_32x32x16_bf16 v[80:95], v[112:115], v[52:55], v[80:95]
    ds_read_b64_tr_b16 v[52:53], v41 offset:24576
    ds_read_b64_tr_b16 v[54:55], v41 offset:25600
    v_mov_b32 v46, 0
    buffer_load_dwordx2 v[24:25], v46, s[28:31], 0 offen sc1
    s_waitcnt lgkmcnt(6)
    v_mfma_f32_32x32x16_bf16 v[64:79], v[116:119], v[56:59], v[64:79]
    ds_read_b64_tr_b16 v[56:57], v40 offset:28672
    ds_read_b64_tr_b16 v[58:59], v40 offset:29696
    s_waitcnt lgkmcnt(6)
    v_mfma_f32_32x32x16_bf16 v[80:95], v[116:119], v[60:63], v[80:95]
    ds_read_b64_tr_b16 v[60:61], v41 offset:28672
    ds_read_b64_tr_b16 v[62:63], v41 offset:29696
    s_waitcnt vmcnt(12)
    s_barrier
    s_waitcnt lgkmcnt(6)
    v_mfma_f32_32x32x16_bf16 v[64:79], v[120:123], v[48:51], v[64:79]
    ds_read_b64_tr_b16 v[48:49], v40 offset:32768
    ds_read_b64_tr_b16 v[50:51], v40 offset:33792
    buffer_store_dwordx4 v[14:17], v33, s[24:27], s47 offen offset:1920 sc1
    s_waitcnt lgkmcnt(6)
    v_mfma_f32_32x32x16_bf16 v[80:95], v[120:123], v[52:55], v[80:95]
    ds_read_b64_tr_b16 v[52:53], v41 offset:32768
    ds_read_b64_tr_b16 v[54:55], v41 offset:33792
    s_waitcnt lgkmcnt(6)
    v_mfma_f32_32x32x16_bf16 v[64:79], v[124:127], v[56:59], v[64:79]
    ds_read_b64_tr_b16 v[56:57], v40 offset:36864
    ds_read_b64_tr_b16 v[58:59], v40 offset:37888
    s_waitcnt lgkmcnt(6)
    v_mfma_f32_32x32x16_bf16 v[80:95], v[124:127], v[60:63], v[80:95]
    ds_read_b64_tr_b16 v[60:61], v41 offset:36864
    ds_read_b64_tr_b16 v[62:63], v41 offset:37888
    s_waitcnt lgkmcnt(6)
    v_mfma_f32_32x32x16_bf16 v[64:79], v[128:131], v[48:51], v[64:79]
    ds_read_b64_tr_b16 v[48:49], v40 offset:40960
    ds_read_b64_tr_b16 v[50:51], v40 offset:41984
    s_mul_i32 s92, s60, 1920
    s_add_u32 m0, s46, 131072
    s_add_u32 s92, s92, s39
    buffer_load_dwordx4 v0, s[12:15], s92 offen lds
    s_waitcnt lgkmcnt(6)
    v_mfma_f32_32x32x16_bf16 v[80:95], v[128:131], v[52:55], v[80:95]
    ds_read_b64_tr_b16 v[52:53], v41 offset:40960
    ds_read_b64_tr_b16 v[54:55], v41 offset:41984
    s_add_u32 m0, s46, 132096
    s_add_u32 s92, s92, 15360
    buffer_load_dwordx4 v0, s[12:15], s92 offen lds
    s_add_u32 s60, s60, 128
    s_cmp_eq_u32 s60, 1280
    s_cselect_b32 s60, 0, s60
    s_waitcnt lgkmcnt(6)
    v_mfma_f32_32x32x16_bf16 v[64:79], v[132:135], v[56:59], v[64:79]
    ds_read_b64_tr_b16 v[56:57], v40 offset:45056
    ds_read_b64_tr_b16 v[58:59], v40 offset:46080
    s_mul_i32 s92, s60, 1920
    s_add_u32 m0, s46, 147456
    s_add_u32 s92, s92, s39
    buffer_load_dwordx4 v0, s[12:15], s92 offen lds
    s_waitcnt lgkmcnt(6)
    v_mfma_f32_32x32x16_bf16 v[80:95], v[132:135], v[60:63], v[80:95]
    ds_read_b64_tr_b16 v[60:61], v41 offset:45056
    ds_read_b64_tr_b16 v[62:63], v41 offset:46080
    s_add_u32 m0, s46, 148480
    s_add_u32 s92, s92, 15360
    buffer_load_dwordx4 v0, s[12:15], s92 offen lds
    s_add_u32 s60, s60, 128
    s_cmp_eq_u32 s60, 1280
    s_cselect_b32 s60, 0, s60
    s_waitcnt lgkmcnt(6)
    v_mfma_f32_32x32x16_bf16 v[64:79], v[136:139], v[48:51], v[64:79]
    ds_read_b64_tr_b16 v[48:49], v40 offset:49152
    ds_read_b64_tr_b16 v[50:51], v40 offset:50176
    s_waitcnt lgkmcnt(6)
    v_mfma_f32_32x32x16_bf16 v[80:95], v[136:139], v[52:55], v[80:95]
    ds_read_b64_tr_b16 v[52:53], v41 offset:49152
    ds_read_b64_tr_b16 v[54:55], v41 offset:50176
    s_waitcnt lgkmcnt(6)
    v_mfma_f32_32x32x16_bf16 v[64:79], v[140:143], v[56:59], v[64:79]
    ds_read_b64_tr_b16 v[56:57], v40 offset:53248
    ds_read_b64_tr_b16 v[58:59], v40 offset:54272
    s_waitcnt lgkmcnt(6)
    v_mfma_f32_32x32x16_bf16 v[80:95], v[140:143], v[60:63], v[80:95]
    ds_read_b64_tr_b16 v[60:61], v41 offset:53248
    ds_read_b64_tr_b16 v[62:63], v41 offset:54272
    s_waitcnt lgkmcnt(6)
    v_mfma_f32_32x32x16_bf16 v[64:79], v[144:147], v[48:51], v[64:79]
    ds_read_b64_tr_b16 v[48:49], v40 offset:57344
    ds_read_b64_tr_b16 v[50:51], v40 offset:58368
    s_waitcnt lgkmcnt(6)
    v_mfma_f32_32x32x16_bf16 v[80:95], v[144:147], v[52:55], v[80:95]
    ds_read_b64_tr_b16 v[52:53], v41 offset:57344
    ds_read_b64_tr_b16 v[54:55], v41 offset:58368
    s_waitcnt lgkmcnt(6)
    v_mfma_f32_32x32x16_bf16 v[64:79], v[148:151], v[56:59], v[64:79]
    ds_read_b64_tr_b16 v[56:57], v40 offset:61440
    ds_read_b64_tr_b16 v[58:59], v40 offset:62464
    s_waitcnt lgkmcnt(6)
    v_mfma_f32_32x32x16_bf16 v[80:95], v[148:151], v[60:63], v[80:95]
    ds_read_b64_tr_b16 v[60:61], v41 offset:61440
    ds_read_b64_tr_b16 v[62:63], v41 offset:62464
    s_waitcnt vmcnt(4)
    s_barrier
L_ck_nonv:
    v_cmp_ne_u32 vcc, 0, v24
    v_cmp_ne_u32 s[66:67], 0, v25
    s_nop 3
    s_and_b64 vcc, vcc, s[66:67]
    s_cbranch_scc0 L_sl_nonv
L_ok_nonv:
    s_cmp_lg_u32 s34, 0
    s_cbranch_scc1 L_fbv
    s_mov_b64 exec, 1
    buffer_store_dwordx2 v[24:25], v46, s[24:27], s56 offen offset:0 sc1
    s_mov_b64 exec, -1
L_fbv:
    s_waitcnt lgkmcnt(6)
    v_mfma_f32_32x32x16_bf16 v[64:79], v[152:155], v[48:51], v[64:79]
    ds_read_b64_tr_b16 v[48:49], v42 offset:0
    ds_read_b64_tr_b16 v[50:51], v42 offset:1024
    s_lshl_b32 s44, s34, 10
    v_add_u32 v112, s44, v20
    v_add_u32 v113, 8192, v112
    s_lshr_b32 s44, s34, 2
    s_lshl_b32 s44, s44, 13
    s_waitcnt lgkmcnt(6)
    v_mfma_f32_32x32x16_bf16 v[80:95], v[152:155], v[52:55], v[80:95]
    ds_read_b64_tr_b16 v[52:53], v43 offset:0
    ds_read_b64_tr_b16 v[54:55], v43 offset:1024
    s_sub_u32 s44, 8192, s44
    v_add_u32 v114, s44, v113
    v_lshlrev_b32 v117, 3, v1
    v_lshlrev_b32 v130, 3, v19
    v_add_u32 v118, 1024, v130
    s_waitcnt lgkmcnt(6)
    v_mfma_f32_32x32x16_bf16 v[64:79], v[156:159], v[56:59], v[64:79]
    ds_read_b64_tr_b16 v[56:57], v42 offset:4096
    ds_read_b64_tr_b16 v[58:59], v42 offset:5120
    v_lshrrev_b32 v120, 2, v19
    v_lshlrev_b32 v120, 2, v120
    v_mov_b32 v121, 0x43120
    v_bfe_u32 v120, v121, v120, 4
    v_lshlrev_b32 v120, 6, v120
    s_waitcnt lgkmcnt(6)
    v_mfma_f32_32x32x16_bf16 v[80:95], v[156:159], v[60:63], v[80:95]
    ds_read_b64_tr_b16 v[60:61], v43 offset:4096
    ds_read_b64_tr_b16 v[62:63], v43 offset:5120
    v_lshl_add_u32 v120, v21, 1, v120
    v_mul_u32_u24 v121, 320, v18
    v_add_u32 v115, v120, v121
    v_add_u32 v115, 1280, v115
    v_and_b32 v120, 27, v19
    s_waitcnt lgkmcnt(6)
    v_mfma_f32_32x32x16_bf16 v[64:79], v[160:163], v[48:51], v[64:79]
    ds_read_b64_tr_b16 v[48:49], v42 offset:8192
    ds_read_b64_tr_b16 v[50:51], v42 offset:9216
    v_cmp_eq_u32 vcc, 24, v120
    v_mov_b32 v122, 0x3f803f80
    v_mov_b32 v123, 5120
    v_mov_b32 v124, 5136
    v_cndmask_b32 v121, v124, v123, vcc
    s_waitcnt lgkmcnt(6)
    v_mfma_f32_32x32x16_bf16 v[80:95], v[160:163], v[52:55], v[80:95]
    ds_read_b64_tr_b16 v[52:53], v43 offset:8192
    ds_read_b64_tr_b16 v[54:55], v43 offset:9216
    v_cndmask_b32 v146, 0, v122, vcc
    s_and_b32 s44, s34, 1
    s_mul_i32 s44, s44, 2560
    v_add_u32 v108, s44, v117
    v_add_u32 v109, s44, v118
    s_waitcnt lgkmcnt(6)
    v_mfma_f32_32x32x16_bf16 v[64:79], v[164:167], v[56:59], v[64:79]
    ds_read_b64_tr_b16 v[56:57], v42 offset:12288
    ds_read_b64_tr_b16 v[58:59], v42 offset:13312
    v_cndmask_b32 v109, v109, v123, s[50:51]
    v_add_u32 v110, s44, v115
    v_add_u32 v111, 640, v110
    v_cmp_gt_u32 vcc, 20, v19
    v_mul_u32_u24 v120, 5632, v1
    s_waitcnt lgkmcnt(6)
    v_mfma_f32_32x32x16_bf16 v[80:95], v[164:167], v[60:63], v[80:95]
    ds_read_b64_tr_b16 v[60:61], v43 offset:12288
    ds_read_b64_tr_b16 v[62:63], v43 offset:13312
    v_add_u32 v120, 5120, v120
    v_cndmask_b32 v110, v121, v110, vcc
    v_cndmask_b32 v111, v121, v111, vcc
    v_mov_b32 v123, 0x3f803f80
    v_mov_b32 v124, 0x3f803f80
    s_waitcnt lgkmcnt(6)
    v_mfma_f32_32x32x16_bf16 v[64:79], v[168:171], v[48:51], v[64:79]
    ds_read_b64_tr_b16 v[48:49], v42 offset:16384
    ds_read_b64_tr_b16 v[50:51], v42 offset:17408
    v_mov_b32 v125, 0x3f803f80
    v_mov_b32 v152, 0
    v_mov_b32 v153, 0
    v_mov_b32 v154, 0
    v_mov_b32 v155, 0
    s_waitcnt lgkmcnt(6)
    v_mfma_f32_32x32x16_bf16 v[80:95], v[168:171], v[52:55], v[80:95]
    ds_read_b64_tr_b16 v[52:53], v43 offset:16384
    ds_read_b64_tr_b16 v[54:55], v43 offset:17408
    v_lshl_add_u32 v132, v18, 2, v22
    v_mul_u32_u24 v2, 40, v132
    v_add_u32 v2, 70656, v2
    v_mul_u32_u24 v3, 40, v22
    v_add_u32 v3, 71296, v3
    s_waitcnt lgkmcnt(6)
    v_mfma_f32_32x32x16_bf16 v[64:79], v[172:175], v[56:59], v[64:79]
    ds_read_b64_tr_b16 v[56:57], v42 offset:20480
    ds_read_b64_tr_b16 v[58:59], v42 offset:21504
    v_bfe_u32 v133, v1, 4, 1
    v_lshlrev_b32 v4, 4, v133
    v_and_b32 v5, 2, v1
    v_lshl_add_u32 v4, v5, 2, v4
    v_add_u32 v5, v4, v3
    s_waitcnt lgkmcnt(6)
    v_mfma_f32_32x32x16_bf16 v[80:95], v[172:175], v[60:63], v[80:95]
    ds_read_b64_tr_b16 v[60:61], v43 offset:20480
    ds_read_b64_tr_b16 v[62:63], v43 offset:21504
    v_add_u32 v4, v4, v2
    s_mul_i32 s44, s34, 5120
    s_add_u32 s44, s44, 81920
    v_mul_u32_u24 v6, 80, v19
    v_mul_u32_u24 v134, 40, v18
    s_waitcnt lgkmcnt(6)
    v_mfma_f32_32x32x16_bf16 v[64:79], v[176:179], v[48:51], v[64:79]
    ds_read_b64_tr_b16 v[48:49], v42 offset:24576
    ds_read_b64_tr_b16 v[50:51], v42 offset:25600
    v_add3_u32 v6, v6, v134, s44
    v_mul_u32_u24 v132, 80, v132
    v_mov_b32 v7, 0x30082800
    v_mov_b32 v134, 0x40183810
    v_cndmask_b32 v7, v7, v134, s[48:49]
    s_waitcnt lgkmcnt(6)
    v_mfma_f32_32x32x16_bf16 v[80:95], v[176:179], v[52:55], v[80:95]
    ds_read_b64_tr_b16 v[52:53], v43 offset:24576
    ds_read_b64_tr_b16 v[54:55], v43 offset:25600
    v_bfe_u32 v7, v7, v21, 8
    v_add3_u32 v7, v7, v132, s44
    v_mov_b32 v8, 0x48204820
    v_mov_b32 v134, 0x48204820
    v_cndmask_b32 v8, v8, v134, s[48:49]
    s_waitcnt lgkmcnt(6)
    v_mfma_f32_32x32x16_bf16 v[64:79], v[180:183], v[56:59], v[64:79]
    ds_read_b64_tr_b16 v[56:57], v42 offset:28672
    ds_read_b64_tr_b16 v[58:59], v42 offset:29696
    v_bfe_u32 v8, v8, v21, 8
    v_add3_u32 v8, v8, v132, s44
    v_add_u32 v9, s44, v20
    s_mul_i32 s44, s34, 640
    v_add_u32 v10, s44, v20
    s_waitcnt lgkmcnt(6)
    v_mfma_f32_32x32x16_bf16 v[80:95], v[180:183], v[60:63], v[80:95]
    ds_read_b64_tr_b16 v[60:61], v43 offset:28672
    ds_read_b64_tr_b16 v[62:63], v43 offset:29696
    v_add_u32 v11, 81920, v10
    v_lshrrev_b32 v12, 1, v10
    v_add_u32 v12, 67584, v12
    v_add_u32 v13, 67584, v117
    v_mul_u32_u24 v14, 40960, v133
    s_waitcnt vmcnt(0)
    s_barrier
    s_waitcnt lgkmcnt(6)
    v_mfma_f32_32x32x16_bf16 v[64:79], v[184:187], v[48:51], v[64:79]
    ds_read_b64_tr_b16 v[48:49], v42 offset:32768
    ds_read_b64_tr_b16 v[50:51], v42 offset:33792
    v_and_b32 v134, 15, v1
    v_lshl_add_u32 v15, v134, 4, v14
    v_lshl_add_u32 v15, v18, 8, v15
    v_lshl_add_u32 v14, v134, 3, v14
    v_and_b32 v16, 4, v1
    s_waitcnt lgkmcnt(6)
    v_mfma_f32_32x32x16_bf16 v[80:95], v[184:187], v[52:55], v[80:95]
    ds_read_b64_tr_b16 v[52:53], v43 offset:32768
    ds_read_b64_tr_b16 v[54:55], v43 offset:33792
    v_mul_u32_u24 v16, 0x2000, v16
    v_lshl_or_b32 v16, v16, 16, v16
    v_and_b32 v17, 7, v1
    v_lshlrev_b32 v17, 3, v17
    v_mul_u32_u24 v128, 640, v18
    s_waitcnt lgkmcnt(6)
    v_mfma_f32_32x32x16_bf16 v[64:79], v[188:191], v[56:59], v[64:79]
    ds_read_b64_tr_b16 v[56:57], v42 offset:36864
    ds_read_b64_tr_b16 v[58:59], v42 offset:37888
    v_lshl_add_u32 v128, v133, 8, v128
    v_lshl_add_u32 v128, v134, 4, v128
    v_lshrrev_b32 v135, 4, v1
    v_mul_u32_u24 v129, 640, v135
    v_lshl_add_u32 v129, v134, 3, v129
    s_waitcnt lgkmcnt(6)
    v_mfma_f32_32x32x16_bf16 v[80:95], v[188:191], v[60:63], v[80:95]
    ds_read_b64_tr_b16 v[60:61], v43 offset:36864
    ds_read_b64_tr_b16 v[62:63], v43 offset:37888
    v_mul_u32_u24 v131, 1280, v134
    v_lshl_add_u32 v131, v135, 3, v131
    v_mul_u32_u24 v132, 26, v1
    v_lshrrev_b32 v132, 8, v132
    v_mul_u32_u24 v133, 10, v132
    s_waitcnt lgkmcnt(6)
    v_mfma_f32_32x32x16_bf16 v[64:79], v[192:195], v[48:51], v[64:79]
    ds_read_b64_tr_b16 v[48:49], v42 offset:40960
    ds_read_b64_tr_b16 v[50:51], v42 offset:41984
    v_sub_u32 v133, v1, v133
    v_mul_u32_u24 v119, 1280, v132
    v_lshl_add_u32 v119, v133, 4, v119
    v_add_u32 v134, 409520, v119
    v_cmp_lt_u32 vcc, 4, v133
    s_waitcnt lgkmcnt(6)
    v_mfma_f32_32x32x16_bf16 v[80:95], v[192:195], v[52:55], v[80:95]
    ds_read_b64_tr_b16 v[52:53], v43 offset:40960
    ds_read_b64_tr_b16 v[54:55], v43 offset:41984
    v_mov_b32 v0, 0
    s_nop 0
    v_cndmask_b32 v119, v119, v134, vcc
    v_add_u32 v116, 9600, v119
    s_lshl_b32 s91, s35, 2
    s_waitcnt lgkmcnt(6)
    v_mfma_f32_32x32x16_bf16 v[64:79], v[196:199], v[56:59], v[64:79]
    ds_read_b64_tr_b16 v[56:57], v42 offset:45056
    ds_read_b64_tr_b16 v[58:59], v42 offset:46080
    s_and_b32 s44, s34, 3
    s_add_u32 s91, s91, s44
    s_lshl_b32 s91, s91, 4
    s_add_u32 s91, s91, s36
    s_lshl_b32 s91, s91, 1
    s_waitcnt lgkmcnt(6)
    v_mfma_f32_32x32x16_bf16 v[80:95], v[196:199], v[60:63], v[80:95]
    ds_read_b64_tr_b16 v[60:61], v43 offset:45056
    ds_read_b64_tr_b16 v[62:63], v43 offset:46080
    s_lshr_b32 s44, s34, 2
    s_add_u32 s91, s91, s44
    s_lshl_b32 s91, s91, 3
    s_add_u32 s91, s91, 15826944
    s_add_u32 s92, s87, 66560
    buffer_load_dwordx2 v[26:27], v30, s[24:27], s61 offen offset:0 sc1
    buffer_load_dwordx2 v[28:29], v31, s[24:27], s61 offen offset:0 sc1
    s_waitcnt lgkmcnt(6)
    v_mfma_f32_32x32x16_bf16 v[64:79], v[200:203], v[48:51], v[64:79]
    ds_read_b64_tr_b16 v[48:49], v42 offset:49152
    ds_read_b64_tr_b16 v[50:51], v42 offset:50176
    s_mul_i32 s44, s32, 20
    s_add_u32 s45, s44, 19
    s_lshr_b32 s44, s44, 6
    s_lshr_b32 s45, s45, 6
    s_lshl_b32 s44, 0x100401, s44
    s_waitcnt lgkmcnt(6)
    v_mfma_f32_32x32x16_bf16 v[80:95], v[200:203], v[52:55], v[80:95]
    ds_read_b64_tr_b16 v[52:53], v43 offset:49152
    ds_read_b64_tr_b16 v[54:55], v43 offset:50176
    s_lshl_b32 s45, 0x100401, s45
    s_or_b32 s37, s44, s45
    s_waitcnt lgkmcnt(6)
    v_mfma_f32_32x32x16_bf16 v[64:79], v[204:207], v[56:59], v[64:79]
    ds_read_b64_tr_b16 v[56:57], v42 offset:53248
    ds_read_b64_tr_b16 v[58:59], v42 offset:54272
    s_waitcnt lgkmcnt(6)
    v_mfma_f32_32x32x16_bf16 v[80:95], v[204:207], v[60:63], v[80:95]
    ds_read_b64_tr_b16 v[60:61], v43 offset:53248
    ds_read_b64_tr_b16 v[62:63], v43 offset:54272
    s_waitcnt lgkmcnt(6)
    v_mfma_f32_32x32x16_bf16 v[64:79], v[208:211], v[48:51], v[64:79]
    ds_read_b64_tr_b16 v[48:49], v42 offset:57344
    ds_read_b64_tr_b16 v[50:51], v42 offset:58368
    s_waitcnt lgkmcnt(6)
    v_mfma_f32_32x32x16_bf16 v[80:95], v[208:211], v[52:55], v[80:95]
    ds_read_b64_tr_b16 v[52:53], v43 offset:57344
    ds_read_b64_tr_b16 v[54:55], v43 offset:58368
    s_waitcnt lgkmcnt(6)
    v_mfma_f32_32x32x16_bf16 v[64:79], v[212:215], v[56:59], v[64:79]
    ds_read_b64_tr_b16 v[56:57], v42 offset:61440
    ds_read_b64_tr_b16 v[58:59], v42 offset:62464
    s_waitcnt lgkmcnt(6)
    v_mfma_f32_32x32x16_bf16 v[80:95], v[212:215], v[60:63], v[80:95]
    ds_read_b64_tr_b16 v[60:61], v43 offset:61440
    ds_read_b64_tr_b16 v[62:63], v43 offset:62464
    s_waitcnt lgkmcnt(6)
    v_mfma_f32_32x32x16_bf16 v[64:79], v[216:219], v[48:51], v[64:79]
    ds_read_b64_tr_b16 v[48:49], v44 offset:0
    ds_read_b64_tr_b16 v[50:51], v44 offset:1024
    s_waitcnt lgkmcnt(6)
    v_mfma_f32_32x32x16_bf16 v[80:95], v[216:219], v[52:55], v[80:95]
    ds_read_b64_tr_b16 v[52:53], v45 offset:0
    ds_read_b64_tr_b16 v[54:55], v45 offset:1024
    s_mov_b64 exec, 0xff
    ds_write_b128 v120, v[122:125]
    ds_write_b128 v120, v[152:155] offset:16
    s_mov_b64 exec, -1
L_ck_asv:
    s_waitcnt vmcnt(1)
    v_cmp_ne_u64 vcc, v[26:27], v[24:25]
    s_waitcnt vmcnt(0)
    v_cmp_ne_u64 s[66:67], v[28:29], v[24:25]
    s_nop 2
    s_or_b32 s42, vcc_lo, vcc_hi
    s_and_b32 s42, s42, 0x03030303
    s_and_b32 s43, s66, s86
    s_or_b32 s42, s42, s43
    s_cmp_eq_u32 s42, 0
    s_cbranch_scc0 L_sl_asv
L_ok_asv:
    s_waitcnt lgkmcnt(8)
    v_mfma_f32_32x32x16_bf16 v[64:79], v[220:223], v[56:59], v[64:79]
    ds_read_b64_tr_b16 v[56:57], v44 offset:4096
    ds_read_b64_tr_b16 v[58:59], v44 offset:5120
    s_add_u32 m0, s88, 0
    s_add_u32 s58, s57, 0
    buffer_load_dwordx4 v112, s[24:27], s58 offen sc1 lds
    v_mov_b32 v184, v146
    v_mov_b32 v185, v146
    v_mov_b32 v186, v146
    v_mov_b32 v187, v146
    v_mov_b32 v188, v146
    s_waitcnt lgkmcnt(8)
    v_mfma_f32_32x32x16_bf16 v[80:95], v[220:223], v[60:63], v[80:95]
    ds_read_b64_tr_b16 v[60:61], v45 offset:4096
    ds_read_b64_tr_b16 v[62:63], v45 offset:5120
    s_add_u32 m0, s89, 0
    s_nop 0
    buffer_load_dwordx4 v113, s[24:27], s58 offen sc1 lds
    v_mov_b32 v189, v146
    v_mov_b32 v190, v146
    v_mov_b32 v191, v146
    s_waitcnt lgkmcnt(8)
    v_mfma_f32_32x32x16_bf16 v[64:79], v[224:227], v[48:51], v[64:79]
    ds_read_b64_tr_b16 v[48:49], v44 offset:8192
    ds_read_b64_tr_b16 v[50:51], v44 offset:9216
    s_add_u32 m0, s90, 0
    s_nop 0
    buffer_load_dwordx4 v114, s[24:27], s58 offen sc1 lds
    s_waitcnt lgkmcnt(8)
    v_mfma_f32_32x32x16_bf16 v[80:95], v[224:227], v[52:55], v[80:95]
    ds_read_b64_tr_b16 v[52:53], v45 offset:8192
    ds_read_b64_tr_b16 v[54:55], v45 offset:9216
    buffer_load_dwordx2 v[96:97], v117, s[24:27], s84 offen sc1
    buffer_load_dwordx2 v[98:99], v117, s[24:27], s84 offen offset:512 sc1
    s_waitcnt lgkmcnt(6)
    v_mfma_f32_32x32x16_bf16 v[64:79], v[228:231], v[56:59], v[64:79]
    ds_read_b64_tr_b16 v[56:57], v44 offset:12288
    ds_read_b64_tr_b16 v[58:59], v44 offset:13312
    buffer_load_dwordx2 v[100:101], v118, s[24:27], s84 offen sc1
    s_waitcnt lgkmcnt(6)
    v_mfma_f32_32x32x16_bf16 v[80:95], v[228:231], v[60:63], v[80:95]
    ds_read_b64_tr_b16 v[60:61], v45 offset:12288
    ds_read_b64_tr_b16 v[62:63], v45 offset:13312
    buffer_load_dwordx2 v[102:103], v117, s[24:27], s85 offen sc1
    buffer_load_dwordx2 v[104:105], v117, s[24:27], s85 offen offset:512 sc1
    s_waitcnt lgkmcnt(6)
    v_mfma_f32_32x32x16_bf16 v[64:79], v[232:235], v[48:51], v[64:79]
    ds_read_b64_tr_b16 v[48:49], v44 offset:16384
    ds_read_b64_tr_b16 v[50:51], v44 offset:17408
    buffer_load_dwordx2 v[106:107], v118, s[24:27], s85 offen sc1
    s_waitcnt lgkmcnt(6)
    v_mfma_f32_32x32x16_bf16 v[80:95], v[232:235], v[52:55], v[80:95]
    ds_read_b64_tr_b16 v[52:53], v45 offset:16384
    ds_read_b64_tr_b16 v[54:55], v45 offset:17408
    s_add_u32 m0, s88, 22528
    s_add_u32 s58, s57, 81920
    buffer_load_dwordx4 v112, s[24:27], s58 offen sc1 lds
    s_waitcnt lgkmcnt(6)
    v_mfma_f32_32x32x16_bf16 v[64:79], v[236:239], v[56:59], v[64:79]
    ds_read_b64_tr_b16 v[56:57], v44 offset:20480
    ds_read_b64_tr_b16 v[58:59], v44 offset:21504
    s_add_u32 m0, s89, 22528
    s_nop 0
    buffer_load_dwordx4 v113, s[24:27], s58 offen sc1 lds
    s_waitcnt lgkmcnt(6)
    v_mfma_f32_32x32x16_bf16 v[80:95], v[236:239], v[60:63], v[80:95]
    ds_read_b64_tr_b16 v[60:61], v45 offset:20480
    ds_read_b64_tr_b16 v[62:63], v45 offset:21504
    s_add_u32 m0, s90, 22528
    s_nop 0
    buffer_load_dwordx4 v114, s[24:27], s58 offen sc1 lds
    s_waitcnt lgkmcnt(6)
    v_mfma_f32_32x32x16_bf16 v[64:79], v[240:243], v[48:51], v[64:79]
    ds_read_b64_tr_b16 v[48:49], v44 offset:24576
    ds_read_b64_tr_b16 v[50:51], v44 offset:25600
    buffer_load_dwordx2 v[26:27], v30, s[24:27], s61 offen sc1
    s_waitcnt lgkmcnt(6)
    v_mfma_f32_32x32x16_bf16 v[80:95], v[240:243], v[52:55], v[80:95]
    ds_read_b64_tr_b16 v[52:53], v45 offset:24576
    ds_read_b64_tr_b16 v[54:55], v45 offset:25600
    s_waitcnt lgkmcnt(6)
    v_mfma_f32_32x32x16_bf16 v[64:79], v[244:247], v[56:59], v[64:79]
    ds_read_b64_tr_b16 v[56:57], v44 offset:28672
    ds_read_b64_tr_b16 v[58:59], v44 offset:29696
    s_waitcnt lgkmcnt(6)
    v_mfma_f32_32x32x16_bf16 v[80:95], v[244:247], v[60:63], v[80:95]
    ds_read_b64_tr_b16 v[60:61], v45 offset:28672
    ds_read_b64_tr_b16 v[62:63], v45 offset:29696
    s_waitcnt lgkmcnt(6)
    v_mfma_f32_32x32x16_bf16 v[64:79], v[248:251], v[48:51], v[64:79]
    s_waitcnt lgkmcnt(4)
    v_mfma_f32_32x32x16_bf16 v[80:95], v[248:251], v[52:55], v[80:95]
    s_waitcnt lgkmcnt(2)
    v_mfma_f32_32x32x16_bf16 v[64:79], v[252:255], v[56:59], v[64:79]
    s_waitcnt lgkmcnt(0)
    v_mfma_f32_32x32x16_bf16 v[80:95], v[252:255], v[60:63], v[80:95]
    s_nop 10
    v_cvt_pk_bf16_f32 v40, v64, v65
    v_cvt_pk_bf16_f32 v41, v66, v67
    v_cvt_pk_bf16_f32 v42, v68, v69
    v_cvt_pk_bf16_f32 v43, v70, v71
    v_cvt_pk_bf16_f32 v44, v72, v73
    v_cvt_pk_bf16_f32 v45, v74, v75
    v_cvt_pk_bf16_f32 v46, v76, v77
    v_cvt_pk_bf16_f32 v47, v78, v79
    v_cvt_pk_bf16_f32 v48, v80, v81
    v_cvt_pk_bf16_f32 v49, v82, v83
    v_cvt_pk_bf16_f32 v50, v84, v85
    v_cvt_pk_bf16_f32 v51, v86, v87
    v_cvt_pk_bf16_f32 v52, v88, v89
    v_cvt_pk_bf16_f32 v53, v90, v91
    v_cvt_pk_bf16_f32 v54, v92, v93
    v_cvt_pk_bf16_f32 v55, v94, v95
    s_mov_b32 s65, 0
    s_mov_b64 s[38:39], 0
    s_mov_b64 s[46:47], -1
    s_waitcnt vmcnt(0) lgkmcnt(0)
    s_branch L_common
L_gate:
    v_and_b32 v49, 15, v1
    v_lshlrev_b32 v50, 4, v49
    v_lshrrev_b32 v51, 4, v1
    v_mul_u32_u24 v52, 1280, v51
    v_add_u32 v52, v52, v50
    buffer_load_dwordx4 v[64:67], v50, s[20:23], 0 offen offset:0
    buffer_load_dwordx4 v[68:71], v50, s[20:23], 0 offen offset:256
    buffer_load_dwordx4 v[72:75], v50, s[20:23], 0 offen offset:512
    buffer_load_dwordx4 v[76:79], v50, s[20:23], 0 offen offset:768
    buffer_load_dwordx4 v[80:83], v50, s[20:23], 0 offen offset:1024
    s_add_u32 s42, s38, 0
    buffer_load_dwordx4 v[172:175], v52, s[4:7], s42 offen offset:0
    buffer_load_dwordx4 v[176:179], v52, s[4:7], s42 offen offset:256
    buffer_load_dwordx4 v[180:183], v52, s[4:7], s42 offen offset:512
    buffer_load_dwordx4 v[184:187], v52, s[4:7], s42 offen offset:768
    buffer_load_dwordx4 v[188:191], v52, s[4:7], s42 offen offset:1024
    s_add_u32 s42, s38, 5120
    buffer_load_dwordx4 v[192:195], v52, s[4:7], s42 offen offset:0
    buffer_load_dwordx4 v[196:199], v52, s[4:7], s42 offen offset:256
    buffer_load_dwordx4 v[200:203], v52, s[4:7], s42 offen offset:512
    buffer_load_dwordx4 v[204:207], v52, s[4:7], s42 offen offset:768
    buffer_load_dwordx4 v[208:211], v52, s[4:7], s42 offen offset:1024
    s_add_u32 s42, s38, 10240
    buffer_load_dwordx4 v[212:215], v52, s[4:7], s42 offen offset:0
    buffer_load_dwordx4 v[216:219], v52, s[4:7], s42 offen offset:256
    buffer_load_dwordx4 v[220:223], v52, s[4:7], s42 offen offset:512
    buffer_load_dwordx4 v[224:227], v52, s[4:7], s42 offen offset:768
    buffer_load_dwordx4 v[228:231], v52, s[4:7], s42 offen offset:1024
    s_add_u32 s42, s38, 15360
    buffer_load_dwordx4 v[232:235], v52, s[4:7], s42 offen offset:0
    buffer_load_dwordx4 v[236:239], v52, s[4:7], s42 offen offset:256
    buffer_load_dwordx4 v[240:243], v52, s[4:7], s42 offen offset:512
    buffer_load_dwordx4 v[244:247], v52, s[4:7], s42 offen offset:768
    buffer_load_dwordx4 v[248:251], v52, s[4:7], s42 offen offset:1024
    s_lshl_b32 s44, s34, 10
    v_add_u32 v112, s44, v20
    v_add_u32 v113, 8192, v112
    s_lshr_b32 s44, s34, 2
    s_lshl_b32 s44, s44, 13
    s_sub_u32 s44, 8192, s44
    v_add_u32 v114, s44, v113
    v_lshlrev_b32 v117, 3, v1
    v_lshlrev_b32 v130, 3, v19
    v_add_u32 v118, 1024, v130
    v_lshrrev_b32 v120, 2, v19
    v_lshlrev_b32 v120, 2, v120
    v_mov_b32 v121, 0x43120
    v_bfe_u32 v120, v121, v120, 4
    v_lshlrev_b32 v120, 6, v120
    v_lshl_add_u32 v120, v21, 1, v120
    v_mul_u32_u24 v121, 320, v18
    v_add_u32 v115, v120, v121
    v_add_u32 v115, 1280, v115
    v_and_b32 v120, 27, v19
    v_cmp_eq_u32 vcc, 24, v120
    v_mov_b32 v122, 0x3f803f80
    v_mov_b32 v123, 5120
    v_mov_b32 v124, 5136
    v_cndmask_b32 v121, v124, v123, vcc
    v_cndmask_b32 v146, 0, v122, vcc
    s_and_b32 s44, s34, 1
    s_mul_i32 s44, s44, 2560
    v_add_u32 v108, s44, v117
    v_add_u32 v109, s44, v118
    v_cndmask_b32 v109, v109, v123, s[50:51]
    v_add_u32 v110, s44, v115
    v_add_u32 v111, 640, v110
    v_cmp_gt_u32 vcc, 20, v19
    v_mul_u32_u24 v120, 5632, v1
    v_add_u32 v120, 5120, v120
    v_cndmask_b32 v110, v121, v110, vcc
    v_cndmask_b32 v111, v121, v111, vcc
    v_mov_b32 v123, 0x3f803f80
    v_mov_b32 v124, 0x3f803f80
    v_mov_b32 v125, 0x3f803f80
    v_mov_b32 v152, 0
    v_mov_b32 v153, 0
    v_mov_b32 v154, 0
    v_mov_b32 v155, 0
    v_lshl_add_u32 v132, v18, 2, v22
    v_mul_u32_u24 v2, 40, v132
    v_add_u32 v2, 70656, v2
    v_mul_u32_u24 v3, 40, v22
    v_add_u32 v3, 71296, v3
    v_bfe_u32 v133, v1, 4, 1
    v_lshlrev_b32 v4, 4, v133
    v_and_b32 v5, 2, v1
    v_lshl_add_u32 v4, v5, 2, v4
    v_add_u32 v5, v4, v3
    v_add_u32 v4, v4, v2
    s_mul_i32 s44, s34, 5120
    s_add_u32 s44, s44, 81920
    v_mul_u32_u24 v6, 80, v19
    v_mul_u32_u24 v134, 40, v18
    v_add3_u32 v6, v6, v134, s44
    v_mul_u32_u24 v132, 80, v132
    v_mov_b32 v7, 0x30082800
    v_mov_b32 v134, 0x40183810
    v_cndmask_b32 v7, v7, v134, s[48:49]
    v_bfe_u32 v7, v7, v21, 8
    v_add3_u32 v7, v7, v132, s44
    v_mov_b32 v8, 0x48204820
    v_mov_b32 v134, 0x48204820
    v_cndmask_b32 v8, v8, v134, s[48:49]
    v_bfe_u32 v8, v8, v21, 8
    v_add3_u32 v8, v8, v132, s44
    v_add_u32 v9, s44, v20
    s_mul_i32 s44, s34, 640
    v_add_u32 v10, s44, v20
    v_add_u32 v11, 81920, v10
    v_lshrrev_b32 v12, 1, v10
    v_add_u32 v12, 67584, v12
    v_add_u32 v13, 67584, v117
    v_mul_u32_u24 v14, 40960, v133
    v_and_b32 v134, 15, v1
    v_lshl_add_u32 v15, v134, 4, v14
    v_lshl_add_u32 v15, v18, 8, v15
    v_lshl_add_u32 v14, v134, 3, v14
    v_and_b32 v16, 4, v1
    v_mul_u32_u24 v16, 0x2000, v16
    v_lshl_or_b32 v16, v16, 16, v16
    v_and_b32 v17, 7, v1
    v_lshlrev_b32 v17, 3, v17
    v_mul_u32_u24 v128, 640, v18
    v_lshl_add_u32 v128, v133, 8, v128
    v_lshl_add_u32 v128, v134, 4, v128
    v_lshrrev_b32 v135, 4, v1
    v_mul_u32_u24 v129, 640, v135
    v_lshl_add_u32 v129, v134, 3, v129
    v_mul_u32_u24 v131, 1280, v134
    v_lshl_add_u32 v131, v135, 3, v131
    v_mul_u32_u24 v132, 26, v1
    v_lshrrev_b32 v132, 8, v132
    v_mul_u32_u24 v133, 10, v132
    v_sub_u32 v133, v1, v133
    v_mul_u32_u24 v119, 1280, v132
    v_lshl_add_u32 v119, v133, 4, v119
    v_add_u32 v134, 409520, v119
    v_cmp_lt_u32 vcc, 4, v133
    v_mov_b32 v0, 0
    s_nop 0
    v_cndmask_b32 v119, v119, v134, vcc
    v_add_u32 v116, 9600, v119
    s_lshl_b32 s91, s35, 2
    s_and_b32 s44, s34, 3
    s_add_u32 s91, s91, s44
    s_lshl_b32 s91, s91, 4
    s_add_u32 s91, s91, s36
    s_lshl_b32 s91, s91, 1
    s_lshr_b32 s44, s34, 2
    s_add_u32 s91, s91, s44
    s_lshl_b32 s91, s91, 3
    s_add_u32 s91, s91, 15826944
    s_add_u32 s92, s87, 66560
    s_mul_i32 s44, s32, 20
    s_add_u32 s45, s44, 19
    s_lshr_b32 s44, s44, 6
    s_lshr_b32 s45, s45, 6
    s_lshl_b32 s44, 0x100401, s44
    s_lshl_b32 s45, 0x100401, s45
    s_or_b32 s37, s44, s45
    s_mov_b64 exec, 0xff
    ds_write_b128 v120, v[122:125]
    ds_write_b128 v120, v[152:155] offset:16
    s_mov_b64 exec, -1
    v_mov_b32 v56, 0
    s_waitcnt vmcnt(19)
    v_dot2_f32_bf16 v56, v172, v64, v56
    v_dot2_f32_bf16 v56, v173, v65, v56
    v_dot2_f32_bf16 v56, v174, v66, v56
    v_dot2_f32_bf16 v56, v175, v67, v56
    s_waitcnt vmcnt(18)
    v_dot2_f32_bf16 v56, v176, v68, v56
    v_dot2_f32_bf16 v56, v177, v69, v56
    v_dot2_f32_bf16 v56, v178, v70, v56
    v_dot2_f32_bf16 v56, v179, v71, v56
    s_waitcnt vmcnt(17)
    v_dot2_f32_bf16 v56, v180, v72, v56
    v_dot2_f32_bf16 v56, v181, v73, v56
    v_dot2_f32_bf16 v56, v182, v74, v56
    v_dot2_f32_bf16 v56, v183, v75, v56
    s_waitcnt vmcnt(16)
    v_dot2_f32_bf16 v56, v184, v76, v56
    v_dot2_f32_bf16 v56, v185, v77, v56
    v_dot2_f32_bf16 v56, v186, v78, v56
    v_dot2_f32_bf16 v56, v187, v79, v56
    s_waitcnt vmcnt(15)
    v_dot2_f32_bf16 v56, v188, v80, v56
    v_dot2_f32_bf16 v56, v189, v81, v56
    v_dot2_f32_bf16 v56, v190, v82, v56
    v_dot2_f32_bf16 v56, v191, v83, v56
    v_mov_b32 v57, 0
    s_waitcnt vmcnt(14)
    v_dot2_f32_bf16 v57, v192, v64, v57
    v_dot2_f32_bf16 v57, v193, v65, v57
    v_dot2_f32_bf16 v57, v194, v66, v57
    v_dot2_f32_bf16 v57, v195, v67, v57
    s_waitcnt vmcnt(13)
    v_dot2_f32_bf16 v57, v196, v68, v57
    v_dot2_f32_bf16 v57, v197, v69, v57
    v_dot2_f32_bf16 v57, v198, v70, v57
    v_dot2_f32_bf16 v57, v199, v71, v57
    s_waitcnt vmcnt(12)
    v_dot2_f32_bf16 v57, v200, v72, v57
    v_dot2_f32_bf16 v57, v201, v73, v57
    v_dot2_f32_bf16 v57, v202, v74, v57
    v_dot2_f32_bf16 v57, v203, v75, v57
    s_waitcnt vmcnt(11)
    v_dot2_f32_bf16 v57, v204, v76, v57
    v_dot2_f32_bf16 v57, v205, v77, v57
    v_dot2_f32_bf16 v57, v206, v78, v57
    v_dot2_f32_bf16 v57, v207, v79, v57
    s_waitcnt vmcnt(10)
    v_dot2_f32_bf16 v57, v208, v80, v57
    v_dot2_f32_bf16 v57, v209, v81, v57
    v_dot2_f32_bf16 v57, v210, v82, v57
    v_dot2_f32_bf16 v57, v211, v83, v57
    v_mov_b32 v58, 0
    s_waitcnt vmcnt(9)
    v_dot2_f32_bf16 v58, v212, v64, v58
    v_dot2_f32_bf16 v58, v213, v65, v58
    v_dot2_f32_bf16 v58, v214, v66, v58
    v_dot2_f32_bf16 v58, v215, v67, v58
    s_waitcnt vmcnt(8)
    v_dot2_f32_bf16 v58, v216, v68, v58
    v_dot2_f32_bf16 v58, v217, v69, v58
    v_dot2_f32_bf16 v58, v218, v70, v58
    v_dot2_f32_bf16 v58, v219, v71, v58
    s_waitcnt vmcnt(7)
    v_dot2_f32_bf16 v58, v220, v72, v58
    v_dot2_f32_bf16 v58, v221, v73, v58
    v_dot2_f32_bf16 v58, v222, v74, v58
    v_dot2_f32_bf16 v58, v223, v75, v58
    s_waitcnt vmcnt(6)
    v_dot2_f32_bf16 v58, v224, v76, v58
    v_dot2_f32_bf16 v58, v225, v77, v58
    v_dot2_f32_bf16 v58, v226, v78, v58
    v_dot2_f32_bf16 v58, v227, v79, v58
    s_waitcnt vmcnt(5)
    v_dot2_f32_bf16 v58, v228, v80, v58
    v_dot2_f32_bf16 v58, v229, v81, v58
    v_dot2_f32_bf16 v58, v230, v82, v58
    v_dot2_f32_bf16 v58, v231, v83, v58
    v_mov_b32 v59, 0
    s_waitcnt vmcnt(4)
    v_dot2_f32_bf16 v59, v232, v64, v59
    v_dot2_f32_bf16 v59, v233, v65, v59
    v_dot2_f32_bf16 v59, v234, v66, v59
    v_dot2_f32_bf16 v59, v235, v67, v59
    s_waitcnt vmcnt(3)
    v_dot2_f32_bf16 v59, v236, v68, v59
    v_dot2_f32_bf16 v59, v237, v69, v59
    v_dot2_f32_bf16 v59, v238, v70, v59
    v_dot2_f32_bf16 v59, v239, v71, v59
    s_waitcnt vmcnt(2)
    v_dot2_f32_bf16 v59, v240, v72, v59
    v_dot2_f32_bf16 v59, v241, v73, v59
    v_dot2_f32_bf16 v59, v242, v74, v59
    v_dot2_f32_bf16 v59, v243, v75, v59
    s_waitcnt vmcnt(1)
    v_dot2_f32_bf16 v59, v244, v76, v59
    v_dot2_f32_bf16 v59, v245, v77, v59
    v_dot2_f32_bf16 v59, v246, v78, v59
    v_dot2_f32_bf16 v59, v247, v79, v59
    s_waitcnt vmcnt(0)
    v_dot2_f32_bf16 v59, v248, v80, v59
    v_dot2_f32_bf16 v59, v249, v81, v59
    v_dot2_f32_bf16 v59, v250, v82, v59
    v_dot2_f32_bf16 v59, v251, v83, v59
    v_add_f32 v56, v56, v56 row_ror:8
    v_add_f32 v57, v57, v57 row_ror:8
    v_add_f32 v58, v58, v58 row_ror:8
    v_add_f32 v59, v59, v59 row_ror:8
    v_add_f32 v56, v56, v56 row_ror:4
    v_add_f32 v57, v57, v57 row_ror:4
    v_add_f32 v58, v58, v58 row_ror:4
    v_add_f32 v59, v59, v59 row_ror:4
    v_add_f32 v56, v56, v56 row_ror:2
    v_add_f32 v57, v57, v57 row_ror:2
    v_add_f32 v58, v58, v58 row_ror:2
    v_add_f32 v59, v59, v59 row_ror:2
    v_add_f32 v56, v56, v56 row_ror:1
    v_add_f32 v57, v57, v57 row_ror:1
    v_add_f32 v58, v58, v58 row_ror:1
    v_add_f32 v59, v59, v59 row_ror:1
    v_cmp_eq_u32 vcc, 1, v49
    s_nop 1
    v_cndmask_b32 v56, v56, v57, vcc
    v_cmp_eq_u32 vcc, 2, v49
    s_nop 1
    v_cndmask_b32 v56, v56, v58, vcc
    v_cmp_eq_u32 vcc, 3, v49
    s_nop 1
    v_cndmask_b32 v56, v56, v59, vcc
    v_mul_f32 v56, s52, v56
    v_exp_f32 v56, -v56
    s_nop 0
    v_add_f32 v56, 1.0, v56
    v_rcp_f32 v56, v56
    v_lshl_add_u32 v53, v49, 2, v51
    v_lshlrev_b32 v53, 3, v53
    s_lshl_b32 s42, s35, 3
    s_add_u32 s42, s42, s34
    s_lshl_b32 s42, s42, 7
    s_add_u32 s42, s42, 15761408
    v_cmp_gt_u32 vcc, 4, v49
    s_nop 3
    s_mov_b64 exec, vcc
    buffer_store_dword v56, v53, s[24:27], s42 offen sc1
    s_mov_b64 exec, -1
    s_waitcnt vmcnt(0)
    s_barrier
    v_mov_b32 v46, 0
    buffer_load_dwordx2 v[24:25], v46, s[28:31], 0 offen sc1
    v_mov_b32 v184, v146
    v_mov_b32 v185, v146
    v_mov_b32 v186, v146
    v_mov_b32 v187, v146
    v_mov_b32 v188, v146
    v_mov_b32 v189, v146
    v_mov_b32 v190, v146
    v_mov_b32 v191, v146
L_ck_nong:
    s_waitcnt vmcnt(0)
    v_cmp_ne_u32 vcc, 0, v24
    v_cmp_ne_u32 s[66:67], 0, v25
    s_nop 3
    s_and_b64 vcc, vcc, s[66:67]
    s_cbranch_scc0 L_sl_nong
L_ok_nong:
    s_cmp_lg_u32 s34, 0
    s_cbranch_scc1 L_fbg
    s_mov_b64 exec, 1
    buffer_store_dwordx2 v[24:25], v46, s[24:27], s56 offen offset:0 sc1
    s_mov_b64 exec, -1
L_fbg:
    s_cmp_lg_u32 s34, 0
    s_cbranch_scc1 L_gw
    buffer_load_dwordx2 v[26:27], v30, s[24:27], s61 offen offset:0 sc1
    buffer_load_dwordx2 v[28:29], v31, s[24:27], s61 offen offset:0 sc1
L_ck_asg0:
    s_waitcnt vmcnt(1)
    v_cmp_ne_u64 vcc, v[26:27], v[24:25]
    s_waitcnt vmcnt(0)
    v_cmp_ne_u64 s[66:67], v[28:29], v[24:25]
    s_nop 2
    s_or_b32 s42, vcc_lo, vcc_hi
    s_and_b32 s42, s42, 0x03030303
    s_and_b32 s43, s66, s86
    s_or_b32 s42, s42, s43
    s_cmp_eq_u32 s42, 0
    s_cbranch_scc0 L_sl_asg0
L_ok_asg0:
L_gw:
    s_barrier
    buffer_load_dwordx2 v[26:27], v30, s[24:27], s61 offen offset:0 sc1
    buffer_load_dwordx2 v[28:29], v31, s[24:27], s61 offen offset:0 sc1
L_ck_asg:
    s_waitcnt vmcnt(1)
    v_cmp_ne_u64 vcc, v[26:27], v[24:25]
    s_waitcnt vmcnt(0)
    v_cmp_ne_u64 s[66:67], v[28:29], v[24:25]
    s_nop 2
    s_or_b32 s42, vcc_lo, vcc_hi
    s_and_b32 s42, s42, 0x03030303
    s_and_b32 s43, s66, s86
    s_or_b32 s42, s42, s43
    s_cmp_eq_u32 s42, 0
    s_cbranch_scc0 L_sl_asg
L_ok_asg:
    s_add_u32 m0, s88, 0
    s_add_u32 s58, s57, 0
    buffer_load_dwordx4 v112, s[24:27], s58 offen sc1 lds
    s_add_u32 m0, s89, 0
    s_nop 0
    buffer_load_dwordx4 v113, s[24:27], s58 offen sc1 lds
    s_add_u32 m0, s90, 0
    s_nop 0
    buffer_load_dwordx4 v114, s[24:27], s58 offen sc1 lds
    buffer_load_dwordx2 v[96:97], v117, s[24:27], s84 offen sc1
    buffer_load_dwordx2 v[98:99], v117, s[24:27], s84 offen offset:512 sc1
    buffer_load_dwordx2 v[100:101], v118, s[24:27], s84 offen sc1
    buffer_load_dwordx2 v[102:103], v117, s[24:27], s85 offen sc1
    buffer_load_dwordx2 v[104:105], v117, s[24:27], s85 offen offset:512 sc1
    buffer_load_dwordx2 v[106:107], v118, s[24:27], s85 offen sc1
    s_add_u32 m0, s88, 22528
    s_add_u32 s58, s57, 81920
    buffer_load_dwordx4 v112, s[24:27], s58 offen sc1 lds
    s_add_u32 m0, s89, 22528
    s_nop 0
    buffer_load_dwordx4 v113, s[24:27], s58 offen sc1 lds
    s_add_u32 m0, s90, 22528
    s_nop 0
    buffer_load_dwordx4 v114, s[24:27], s58 offen sc1 lds
    buffer_load_dwordx2 v[26:27], v30, s[24:27], s61 offen sc1
    s_mov_b32 s64, 0
    s_mov_b32 s65, 0
    s_mov_b64 s[38:39], 0
    s_mov_b64 s[46:47], 0
    s_waitcnt vmcnt(0) lgkmcnt(0)
    s_branch L_common
L_code_end:
.section .rodata,"a"
.p2align 6
.amdhsa_kernel gated_mix__linear_kernel_hedgehog__softmax_full_mha__prompt_kernel
  .amdhsa_next_free_vgpr 256
  .amdhsa_next_free_sgpr 102
  .amdhsa_accum_offset 256
  .amdhsa_group_segment_fixed_size 0
  .amdhsa_kernarg_size 88
  .amdhsa_user_sgpr_count 2
  .amdhsa_user_sgpr_kernarg_segment_ptr 1
  .amdhsa_system_sgpr_workgroup_id_x 1
.end_amdhsa_kernel
```
